```python
import torch

def _softmax(x, axis=-1):
    return torch.softmax(x, dim=axis)
def _gelu(x):
    return torch.nn.functional.gelu(x, approximate="tanh")
def _silu(x):
    return torch.nn.functional.silu(x)
def _sigmoid(x):
    return torch.sigmoid(x)
def _layernorm(x, axis=-1, eps=1e-5):
    m = x.mean(dim=axis, keepdim=True)
    v = x.var(dim=axis, keepdim=True, unbiased=False)
    return (x - m) / torch.sqrt(v + eps)
def _scatter_add(tgt, idx, src, axis=0):
    return tgt.clone().index_add_(axis, idx, src)
def _segment_sum(src, seg, n):
    out = torch.zeros((n,) + src.shape[1:], dtype=src.dtype)
    return out.index_add_(0, seg, src)
def _pad(x, pw):
    flat = tuple(v for pair in reversed(pw) for v in pair)
    return torch.nn.functional.pad(x, flat)

kernel_name = 'parallel_sum__grouped_kv_mqa__glu_gated_bilinear__prompt'

def setup_inputs():

    _w = (lambda a: (lambda t: t.to(torch.bfloat16) if t.is_floating_point() else t)(torch.as_tensor(a)))
    def _A_setup():
        B, S, D, H = 1, 2048, 448, 16
        Dh = D // H
        return {
            "x": _w((lambda *s: torch.randn(*s, dtype=torch.bfloat16) * 0.05)(B, S, D)),
            "wq": _w((lambda *s: torch.randn(*s, dtype=torch.bfloat16) * 0.05)(D, H * Dh)),
            "wk": _w((lambda *s: torch.randn(*s, dtype=torch.bfloat16) * 0.05)(D, Dh)),
            "wv": _w((lambda *s: torch.randn(*s, dtype=torch.bfloat16) * 0.05)(D, Dh)),
            "wo": _w((lambda *s: torch.randn(*s, dtype=torch.bfloat16) * 0.05)(H * Dh, D)),
        }
    _A_in = _A_setup()

    def _B_setup():
        B, S, D, F = 1, 2048, 448, 1792
        return {
            "x": _w((lambda *s: torch.randn(*s, dtype=torch.bfloat16) * 0.05)(B, S, D)),
            "w_gate": _w((lambda *s: torch.randn(*s, dtype=torch.bfloat16) * 0.4)(D, F) * (D ** -0.5)),
            "w_up": _w((lambda *s: torch.randn(*s, dtype=torch.bfloat16) * 0.4)(D, F) * (D ** -0.5)),
            "w_down": _w((lambda *s: torch.randn(*s, dtype=torch.bfloat16) * 0.4)(F, D) * (F ** -0.5)),
        }
    _B_in = _B_setup()

    return {
        "A_x": _A_in["x"],
        "A_wq": _A_in["wq"],
        "A_wk": _A_in["wk"],
        "A_wv": _A_in["wv"],
        "A_wo": _A_in["wo"],
        "B_x": _B_in["x"],
        "B_w_gate": _B_in["w_gate"],
        "B_w_up": _B_in["w_up"],
        "B_w_down": _B_in["w_down"],
    }

def reference(A_x, A_wq, A_wk, A_wv, A_wo, B_x, B_w_gate, B_w_up, B_w_down):
    def _A_ref(x, wq, wk, wv, wo):
        B, S, D = x.shape
        H = 16
        Dh = D // H
        q = (lambda x, *d: x.permute(*d))((x @ wq).reshape(B, S, H, Dh), 0, 2, 1, 3)
        k = x @ wk
        v = x @ wv
        scores = torch.einsum("bhqd,bkd->bhqk", q, k) * (Dh ** -0.5)
        p = _softmax(scores, axis=-1)
        o = torch.einsum("bhqk,bkd->bhqd", p, v)
        return (lambda x, *d: x.permute(*d))(o, 0, 2, 1, 3).reshape(B, S, H * Dh) @ wo

    def _B_ref(x, w_gate, w_up, w_down):
        g = torch.einsum("bsd,df->bsf", x, w_gate)
        u = torch.einsum("bsd,df->bsf", x, w_up)
        h = g * u
        return torch.einsum("bsf,fd->bsd", h, w_down)

    x = A_x
    xn = _layernorm(x, axis=-1)
    return x + _A_ref(xn, A_wq, A_wk, A_wv, A_wo) + _B_ref(xn, B_w_gate, B_w_up, B_w_down)
```

```asm
; @launch grid=(256,1,1) block=(512,1,1) lds=163840
.amdgcn_target "amdgcn-amd-amdhsa--gfx950"
.text
.p2align 12
.fill 832, 4, 0xbf800000
.globl parallel_sum__grouped_kv_mqa__glu_gated_bilinear__prompt_kernel
.p2align 8
.type parallel_sum__grouped_kv_mqa__glu_gated_bilinear__prompt_kernel,@function
parallel_sum__grouped_kv_mqa__glu_gated_bilinear__prompt_kernel:
    s_cmp_ge_u32 s2, 256
    s_cbranch_scc1 F_end
    s_load_dwordx2 s[4:5], s[0:1], 0
    s_load_dwordx2 s[16:17], s[0:1], 88
    s_getpc_b64 s[28:29]
F_pc:
    s_and_b32 s30, s2, -8
    s_lshl_b32 s30, s30, 8
    v_lshl_add_u32 v3, v0, 2, s30
    v_min_u32 v3, F_last-F_pc, v3
    s_and_b32 s28, s28, -256
    v_add_co_u32 v12, vcc, s28, v3
    v_mov_b32 v13, s29
    v_lshrrev_b32 v3, 6, v0
    v_addc_co_u32 v13, vcc, 0, v13, vcc
    v_readfirstlane_b32 s92, v3
    global_load_dword v10, v[12:13], off
    v_and_b32 v1, 63, v0
    s_and_b32 s30, s2, 6
    s_lshl_b32 s30, s30, 1
    s_bfe_u32 s31, s2, 0x20003
    s_add_u32 s90, s30, s31
    s_and_b32 s3, s2, 1
    s_lshr_b32 s91, s2, 5
    s_lshr_b32 s94, s92, 2
    s_and_b32 s93, s92, 3
    s_mov_b32 s6, 1835008
    s_mov_b32 s7, 0x20000
    s_cmp_eq_u32 s91, 7
    s_cbranch_scc0 F_heavy
F_light:
    s_lshl3_add_u32 s28, s94, 16
    s_load_dwordx2 s[8:9], s[0:1], s28
    v_lshlrev_b32 v2, 4, v1
    s_mov_b32 s10, 25088
    s_mov_b32 s11, 0x20000
    s_lshl_b32 s29, s90, 7
    s_lshl_b32 s30, s92, 3
    s_add_u32 s29, s29, s30
    s_lshl_b32 s30, s3, 6
    s_add_u32 s29, s29, s30
    v_lshrrev_b32 v3, 3, v1
    v_add_u32 v3, s29, v3
    v_mul_u32_u24 v3, 896, v3
    v_and_b32 v4, 7, v1
    v_lshrrev_b32 v5, 4, v1
    v_xor_b32 v4, v4, v5
    s_and_b32 s28, s92, 1
    s_lshl_b32 s28, s28, 2
    v_xor_b32 v4, s28, v4
    v_lshl_add_u32 v30, v4, 4, v3
    s_lshl_b32 s28, s3, 13
    s_lshl_b32 s97, s92, 10
    s_add_u32 s97, s97, s28
    s_xor_b32 s31, s28, 0x2000
    s_mul_i32 s29, s92, 896
    s_add_u32 s59, s31, s29
    s_mul_i32 s29, s93, 896
    v_add_u32 v29, s29, v2
    s_and_b32 s100, s90, 3
    s_mul_i32 s100, s100, 2
    s_waitcnt lgkmcnt(0)
    s_add_u32 m0, s59, 0
    s_mul_i32 s56, s100, 3584
    s_mov_b32 exec_hi, 0xffffff
    buffer_load_dwordx4 v29, s[8:11], s56 offen lds
    s_mov_b32 exec_hi, -1
    s_add_u32 m0, s97, 0
    s_lshl_b32 s56, s100, 7
    buffer_load_dwordx4 v30, s[4:7], s56 offen lds
    s_add_u32 s100, s100, 1
    s_cmp_eq_u32 s100, 7
    s_cselect_b32 s100, 0, s100
    s_add_u32 m0, s59, 16384
    s_mul_i32 s56, s100, 3584
    s_mov_b32 exec_hi, 0xffffff
    buffer_load_dwordx4 v29, s[8:11], s56 offen lds
    s_mov_b32 exec_hi, -1
    s_add_u32 m0, s97, 16384
    s_lshl_b32 s56, s100, 7
    buffer_load_dwordx4 v30, s[4:7], s56 offen lds
    s_add_u32 s100, s100, 1
    s_cmp_eq_u32 s100, 7
    s_cselect_b32 s100, 0, s100
    s_branch F_l2
F_ret:
    s_setpc_b64 s[28:29]
F_heavy:
    s_mul_i32 s95, s3, 7
    s_add_u32 s95, s95, s91
    s_cmp_eq_u32 s94, 0
    s_cbranch_scc1 F_g0
    s_load_dwordx2 s[8:9], s[0:1], 48
    s_load_dwordx2 s[12:13], s[0:1], 56
    s_load_dwordx2 s[20:21], s[0:1], 8
    s_bitcmp1_b32 s2, 2
    s_cselect_b32 s100, 106055936, 0
    s_cselect_b32 s30, 80365824, 0
    s_xor_b32 s100, s100, 224609280
    s_xor_b32 s30, s30, 162031744
    s_bitcmp1_b32 s2, 1
    s_cselect_b32 s100, s30, s100
    s_brev_b32 s28, s93
    s_lshr_b32 s28, s28, 19
    s_lshl_b32 s29, s31, 13
    s_add_u32 s48, s28, s29
    s_lshl_b32 s28, s92, 1
    v_xor_b32 v6, s28, v1
    v_and_b32 v6, 3, v6
    v_bfe_u32 v3, v1, 2, 2
    v_mul_u32_u24 v3, 3584, v3
    v_lshrrev_b32 v5, 4, v1
    v_lshl_add_u32 v3, v5, 6, v3
    v_lshl_add_u32 v3, v6, 4, v3
    s_lshl_b32 s28, s95, 8
    v_add_u32 v3, s28, v3
    s_and_b32 s28, s91, 3
    s_lshl2_add_u32 s28, s28, s93
    s_lshl_b32 s52, s28, 10
    s_lshl_b32 s28, s92, 2
    v_xor_b32 v4, v1, v5
    v_xor_b32 v4, s28, v4
    v_and_b32 v4, 7, v4
    v_lshrrev_b32 v5, 3, v1
    v_mul_u32_u24 v5, 896, v5
    v_lshl_add_u32 v4, v4, 4, v5
    s_mul_i32 s28, s90, 114688
    v_add_u32 v4, s28, v4
    s_xor_b32 s49, s48, 8192
    s_xor_b32 s53, s52, 4096
    s_xor_b32 s50, s48, 16384
    s_xor_b32 s54, s52, 8192
    s_xor_b32 s51, s48, 24576
    s_xor_b32 s55, s52, 12288
    v_mad_u32_u24 v226, s48, 7, v3
    v_mad_u32_u24 v230, s52, 7, v4
    v_mad_u32_u24 v227, s49, 7, v3
    v_mad_u32_u24 v231, s53, 7, v4
    v_mad_u32_u24 v228, s50, 7, v3
    v_mad_u32_u24 v232, s54, 7, v4
    v_mad_u32_u24 v229, s51, 7, v3
    v_mad_u32_u24 v233, s55, 7, v4
    s_and_b32 s29, s29, 0x4000
    s_xor_b32 s48, s48, s29
    s_xor_b32 s49, s49, s29
    s_xor_b32 s50, s50, s29
    s_xor_b32 s51, s51, s29
    s_lshl3_add_u32 s101, s3, s91
    s_mul_i32 s28, s101, 56
    s_and_b32 s28, s28, -16
    s_xor_b32 s29, s93, s31
    s_lshl_b32 s98, s29, 10
    s_mul_i32 s29, s98, 14
    s_add_u32 s28, s28, s29
    v_lshrrev_b32 v3, 2, v1
    v_mul_u32_u24 v3, 896, v3
    v_and_b32 v4, 3, v1
    v_lshl_add_u32 v3, v4, 4, v3
    v_add_u32 v234, s28, v3
    s_mov_b32 s10, 1605632
    s_mov_b32 s11, 0x20000
    s_mov_b32 s14, 1605632
    s_mov_b32 s15, 0x20000
    s_mov_b32 s22, 401408
    s_mov_b32 s23, 0x20000
    s_waitcnt lgkmcnt(0)
    s_and_b32 s58, s100, 0x380
    s_mul_i32 s56, s58, 1792
    s_lshr_b32 s100, s100, 3
    s_add_u32 m0, s48, 0
    s_nop 0
    buffer_load_dwordx4 v226, s[8:11], s56 offen lds
    s_add_u32 m0, s52, 98304
    s_nop 0
    buffer_load_dwordx4 v230, s[4:7], s58 offen lds
    s_add_u32 m0, s48, 1024
    s_nop 0
    buffer_load_dwordx4 v226, s[12:15], s56 offen lds
    s_add_u32 m0, s49, 0
    s_nop 0
    buffer_load_dwordx4 v227, s[8:11], s56 offen lds
    s_add_u32 m0, s53, 98304
    s_nop 0
    buffer_load_dwordx4 v231, s[4:7], s58 offen lds
    s_add_u32 m0, s49, 1024
    s_nop 0
    buffer_load_dwordx4 v227, s[12:15], s56 offen lds
    s_add_u32 m0, s54, 98304
    s_nop 0
    buffer_load_dwordx4 v232, s[4:7], s58 offen lds
    s_add_u32 m0, s55, 98304
    s_nop 0
    buffer_load_dwordx4 v233, s[4:7], s58 offen lds
    s_branch F_a1
F_g0:
    s_lshl1_add_u32 s30, s90, s3
    s_mul_i32 s30, s30, 7
    s_add_u32 s30, s30, s91
    s_lshl2_add_u32 s30, s30, s92
    s_lshl_b32 s30, s30, 11
    v_lshlrev_b32 v50, 7, v1
    s_mov_b64 exec, 0xffff
    s_waitcnt lgkmcnt(0)
    buffer_load_dword v51, v50, s[4:7], s30 offen
    s_mov_b64 exec, -1
    s_branch F_g1
F_l2:
    s_bitcmp1_b32 s90, 0
    s_cselect_b32 s28, 56, 48
    s_cmp_lt_u32 s90, 14
    s_cselect_b32 s28, s28, 8
    s_load_dwordx2 s[12:13], s[0:1], s28
    s_load_dwordx2 s[20:21], s[0:1], 8
    s_load_dwordx2 s[24:25], s[0:1], 80
    s_load_dwordx2 s[36:37], s[0:1], 32
    s_mov_b32 s22, 401408
    s_mov_b32 s23, 0x20000
    s_mov_b32 s18, 16777216
    s_mov_b32 s19, 0x20000
    s_mov_b32 s26, 256
    s_mov_b32 s27, 0x20000
    s_mov_b32 s38, 401408
    s_mov_b32 s39, 0x20000
    s_lshl_b32 s28, s94, 1
    s_and_b32 s29, s92, 1
    s_add_u32 s28, s28, s29
    s_lshl_b32 s99, s90, 2
    s_add_u32 s99, s99, s28
    s_lshl3_add_u32 s101, s3, s91
    s_mul_i32 s28, s101, 56
    s_and_b32 s28, s28, -16
    s_mul_i32 s29, s92, 7168
    s_add_u32 s28, s28, s29
    v_lshrrev_b32 v3, 2, v1
    v_mul_u32_u24 v3, 896, v3
    v_and_b32 v6, 3, v1
    v_lshl_add_u32 v3, v6, 4, v3
    v_add_u32 v28, s28, v3
    s_lshl_b32 s98, s92, 9
    s_cmp_lt_u32 s90, 14
    s_cselect_b32 s96, 4, 1
    s_mul_i32 s96, s96, 896
    s_mul_i32 s28, s3, 7
    s_lshr_b32 s29, s90, 1
    s_add_u32 s28, s28, s29
    s_and_b32 s29, s90, 1
    s_lshl_b32 s30, s3, 1
    s_add_u32 s30, s30, s29
    s_mul_i32 s29, s29, 14
    s_cmp_lt_u32 s90, 14
    s_cselect_b32 s28, s28, s30
    s_cselect_b32 s29, s29, 28
    s_add_u32 s95, s28, s29
    s_lshl_b32 s28, s28, 8
    s_mul_i32 s29, s92, 4
    v_lshrrev_b32 v3, 4, v1
    v_add_u32 v3, s29, v3
    v_mul_u32_u24 v3, s96, v3
    v_and_b32 v4, 15, v1
    v_lshl_add_u32 v3, v4, 4, v3
    v_add_u32 v15, s28, v3
    s_mul_i32 s14, s96, 448
    s_mov_b32 s15, 0x20000
    s_lshl_b32 s96, s96, 5
    s_lshl_b32 s49, s95, 10
    s_add_u32 s49, s49, 2392064
    v_mov_b32 v24, -1
    v_mov_b32 v25, -1
    v_mov_b32 v26, -1
    v_mov_b32 v27, -1
    s_mul_i32 s40, s99, 147456
    s_lshr_b32 s29, s93, 1
    s_lshl1_add_u32 s28, s101, s29
    s_lshl_b32 s28, s28, 10
    s_add_u32 s40, s40, s28
    s_add_u32 s40, s40, 3260416
    s_mul_i32 s28, s90, 7168
    s_add_u32 s28, s28, 2490368
    s_mul_i32 s29, s92, 896
    s_add_u32 s28, s28, s29
    v_lshl_add_u32 v20, v1, 7, s28
    s_lshl_b32 s29, s92, 7
    s_add_u32 s51, s49, s29
    v_mov_b32 v21, 0
    s_lshl_b32 s28, s92, 8
    s_add_u32 s28, s28, 159744
    v_lshl_add_u32 v8, v1, 2, s28
    v_and_b32 v9, 3, v1
    v_lshlrev_b32 v9, 6, v9
    v_add_lshl_u32 v9, v9, v1, 2
    v_add_u32 v9, 159744, v9
    v_lshrrev_b32 v3, 5, v1
    v_bfe_u32 v4, v1, 2, 2
    v_lshl_add_u32 v5, v3, 3, v4
    v_bfe_u32 v6, v1, 4, 1
    v_and_b32 v4, 3, v1
    v_lshl_add_u32 v6, v6, 2, v4
    v_min_u32 v6, 6, v6
    v_lshlrev_b32 v6, 3, v6
    v_bfe_u32 v4, v1, 1, 3
    v_xor_b32 v4, v3, v4
    v_and_b32 v3, 31, v1
    v_lshlrev_b32 v14, 2, v3
    v_lshlrev_b32 v3, 7, v3
    v_lshl_add_u32 v40, v4, 4, v3
    v_mul_u32_u24 v3, 56, v5
    v_add_u32 v3, v3, v6
    s_and_b32 s28, s93, 1
    s_mul_i32 s28, s28, 3584
    s_add_u32 s30, s28, s31
    s_mul_i32 s28, s93, 896
    s_xor_b32 s29, s93, 1
    s_mul_i32 s29, s29, 896
    s_add_u32 s28, s28, s30
    s_add_u32 s29, s29, s30
    v_add_u32 v32, s28, v3
    v_add_u32 v34, s29, v3
    v_add_u32 v33, 0x10000, v32
    v_add_u32 v35, 0x10000, v34
    s_lshl_b32 s28, s3, 1
    s_add_u32 s28, s28, s94
    s_lshl_b32 s52, s90, 2
    s_add_u32 s52, s52, s28
    s_lshl_b32 s28, s28, 12
    s_lshl_b32 s29, s93, 5
    s_add_u32 s28, s28, s29
    v_xor_b32 v36, s28, v40
    v_xor_b32 v37, 0x10000, v36
    v_xor_b32 v38, 0x20, v36
    v_xor_b32 v39, 0x10020, v36
    v_lshrrev_b32 v3, 2, v1
    v_lshrrev_b32 v4, 4, v1
    v_xor_b32 v3, v3, v4
    v_and_b32 v3, 1, v3
    v_cmp_eq_u32 vcc, 0, v3
    v_mov_b32 v4, 0x3f803f80
    s_mov_b32 s50, 0xffff0000
    s_lshl_b32 s28, s94, 10
    s_add_u32 s28, s28, 143360
    v_lshl_add_u32 v44, v14, 3, s28
    s_lshl_b32 s28, s93, 3
    v_add_u32 v45, s28, v44
    s_and_b32 s28, s93, 1
    s_lshl_b32 s28, s28, 10
    s_add_u32 s28, s28, 145408
    v_add_u32 v46, s28, v2
    s_lshr_b32 s28, s92, 1
    s_lshl_b32 s28, s28, 2
    v_add_u32 v47, s28, v46
    s_lshl_b32 s28, s92, 11
    s_add_u32 s28, s28, 147456
    v_add_u32 v48, s28, v2
    v_xor_b32 v49, 0x1000, v48
    s_lshl_b32 s28, s92, 7
    s_add_u32 s28, s28, s31
    s_add_u32 s28, s28, 23552
    v_add_u32 v50, s28, v14
    v_lshrrev_b32 v3, 5, v1
    v_lshl_add_u32 v51, v3, 4, s28
    v_cndmask_b32 v228, 0, v4, vcc
    v_cndmask_b32 v229, 0, v4, vcc
    v_cndmask_b32 v230, 0, v4, vcc
    v_cndmask_b32 v231, 0, v4, vcc
    v_mov_b32 v232, 0
    v_mov_b32 v233, 0
    v_mov_b32 v234, 0
    v_mov_b32 v235, 0
    v_mov_b32 v220, 0
    v_mov_b32 v221, 0
    v_mov_b32 v222, 0
    v_mov_b32 v223, 0
    v_and_b32 v3, 15, v1
    v_and_b32 v5, 1, v1
    v_lshlrev_b32 v5, 4, v5
    v_mov_b32 v6, 0x3f80
    v_lshlrev_b32 v5, v5, v6
    v_lshrrev_b32 v3, 1, v3
    v_cmp_eq_u32 vcc, 0, v3
    s_nop 1
    v_cndmask_b32 v200, 0, v5, vcc
    v_cmp_eq_u32 vcc, 1, v3
    s_nop 1
    v_cndmask_b32 v201, 0, v5, vcc
    v_cmp_eq_u32 vcc, 2, v3
    s_nop 1
    v_cndmask_b32 v202, 0, v5, vcc
    v_cmp_eq_u32 vcc, 3, v3
    s_nop 1
    v_cndmask_b32 v203, 0, v5, vcc
    s_waitcnt lgkmcnt(0)
    s_barrier
    s_add_u32 m0, s59, 32768
    s_mul_i32 s56, s100, 3584
    s_mov_b32 exec_hi, 0xffffff
    buffer_load_dwordx4 v29, s[8:11], s56 offen lds
    s_mov_b32 exec_hi, -1
    s_add_u32 m0, s97, 32768
    s_lshl_b32 s56, s100, 7
    buffer_load_dwordx4 v30, s[4:7], s56 offen lds
    s_add_u32 s100, s100, 1
    s_cmp_eq_u32 s100, 7
    s_cselect_b32 s100, 0, s100
    s_add_u32 m0, s59, 49152
    s_mul_i32 s56, s100, 3584
    s_mov_b32 exec_hi, 0xffffff
    buffer_load_dwordx4 v29, s[8:11], s56 offen lds
    s_mov_b32 exec_hi, -1
    s_add_u32 m0, s97, 49152
    s_lshl_b32 s56, s100, 7
    buffer_load_dwordx4 v30, s[4:7], s56 offen lds
    s_add_u32 s100, s100, 1
    s_cmp_eq_u32 s100, 7
    s_cselect_b32 s100, 0, s100
    s_mov_b64 exec, 0
    s_cmp_eq_u32 s93, 1
    s_cbranch_scc1 F_cll0_1
    s_cmp_eq_u32 s93, 2
    s_cbranch_scc1 F_cll0_2
    s_cmp_eq_u32 s93, 3
    s_cbranch_scc1 F_cll0_3
    s_call_b64 s[28:29], F_pgR_1
    s_branch F_cll0
F_cll0_1:
    s_call_b64 s[28:29], F_pgL3_0
    s_branch F_cll0
F_cll0_2:
    s_call_b64 s[28:29], F_pgL3_1
    s_branch F_cll0
F_cll0_3:
    s_call_b64 s[28:29], F_pgL3_2
F_cll0:
    s_mov_b64 exec, -1
    s_branch F_l3
F_a1:
    s_load_dwordx2 s[24:25], s[0:1], 80
    s_load_dwordx2 s[44:45], s[0:1], 72
    s_load_dwordx2 s[32:33], s[0:1], 64
    s_mov_b32 s34, 1605632
    s_mov_b32 s35, 0x20000
    s_mov_b32 s18, 16777216
    s_mov_b32 s19, 0x20000
    s_mov_b32 s26, 256
    s_mov_b32 s27, 0x20000
    s_mov_b32 s46, 1835008
    s_mov_b32 s47, 0x20000
    v_lshlrev_b32 v2, 4, v1
    s_lshl_b32 s28, s92, 8
    s_add_u32 s28, s28, 159744
    v_lshl_add_u32 v8, v1, 2, s28
    v_and_b32 v9, 3, v1
    v_lshlrev_b32 v9, 6, v9
    v_add_lshl_u32 v9, v9, v1, 2
    v_add_u32 v9, 159744, v9
    v_mov_b32 v7, 0
    ds_write_b32 v8, v7
    v_and_b32 v3, 31, v1
    v_lshrrev_b32 v4, 5, v1
    v_bfe_u32 v5, v1, 1, 3
    v_xor_b32 v5, v4, v5
    v_lshlrev_b32 v5, 4, v5
    v_lshl_add_u32 v5, v3, 7, v5
    s_lshl_b32 s28, s93, 12
    s_add_u32 s28, s28, 98304
    v_add_u32 v236, s28, v5
    v_xor_b32 v237, 0x20, v236
    v_xor_b32 v238, 0x40, v236
    v_xor_b32 v239, 0x60, v236
    s_lshl_b32 s28, s93, 7
    s_add_u32 s28, s28, 161792
    v_lshl_add_u32 v250, v3, 2, s28
    s_and_b32 s29, s93, 1
    s_lshl_b32 s28, s29, 8
    s_add_u32 s28, s28, 161792
    v_lshl_add_u32 v251, v3, 2, s28
    s_lshl_b32 s28, s29, 14
    s_add_u32 s30, s28, 9728
    v_lshl_add_u32 v15, v3, 4, s30
    s_lshr_b32 s30, s93, 1
    s_lshl_b32 s40, s30, 13
    s_add_u32 s28, s28, s40
    v_add_u32 v14, s28, v2
    s_lshl_b32 s28, s93, 11
    v_add_u32 v11, s28, v2
    v_add_u32 v245, 139264, v11
    v_add_u32 v246, 139264, v2
    s_lshl1_add_u32 s29, s90, s29
    s_mul_i32 s40, s29, 294912
    s_lshl_b32 s28, s101, 11
    s_add_u32 s40, s40, s28
    s_add_u32 s40, s40, 3260416
    s_mov_b32 s42, -1
    s_sub_u32 s43, s30, 1
    s_lshl_b32 s28, s93, 16
    s_add_u32 s28, s28, 2097152
    v_add_u32 v0, s28, v2
    s_lshl1_add_u32 s41, s90, s91
    s_and_b32 s41, s41, 7
    s_lshl_b32 s41, s41, 13
    v_lshrrev_b32 v4, 5, v1
    v_and_b32 v3, 31, v1
    v_lshlrev_b32 v3, 5, v3
    v_add_u32 v249, 162304, v3
    s_lshl_b32 s28, s93, 3
    v_lshl_add_u32 v3, v4, 2, s28
    v_add_u32 v248, v249, v3
    v_bfe_u32 v5, v1, 2, 2
    v_lshl_add_u32 v5, v4, 3, v5
    v_bfe_u32 v3, v1, 4, 1
    v_and_b32 v4, 3, v1
    v_lshl_add_u32 v3, v3, 2, v4
    v_min_u32 v3, 6, v3
    v_lshlrev_b32 v3, 3, v3
    v_lshl_add_u32 v3, v5, 6, v3
    s_and_b32 s28, s101, 1
    s_lshl3_add_u32 s28, s28, 147456
    v_add_u32 v244, s28, v3
    v_add_u32 v247, s98, v244
    v_mov_b32 v220, 0
    v_mov_b32 v221, 0
    v_and_b32 v224, 31, v1
    v_lshlrev_b32 v224, 3, v224
    v_mov_b32 v216, -1
    v_mov_b32 v217, -1
    v_mov_b32 v218, -1
    v_mov_b32 v219, -1
    s_add_u32 m0, s98, 147456
    s_mul_i32 s59, s58, 448
    buffer_load_dwordx4 v234, s[20:23], s59 offen lds
    s_add_u32 m0, s50, 0
    s_nop 0
    buffer_load_dwordx4 v228, s[8:11], s56 offen lds
    s_add_u32 m0, s50, 1024
    s_nop 0
    buffer_load_dwordx4 v228, s[12:15], s56 offen lds
    s_add_u32 m0, s51, 0
    s_nop 0
    buffer_load_dwordx4 v229, s[8:11], s56 offen lds
    s_add_u32 m0, s51, 1024
    s_nop 0
    buffer_load_dwordx4 v229, s[12:15], s56 offen lds
    s_and_b32 s58, s100, 0x380
    s_mul_i32 s56, s58, 1792
    s_lshr_b32 s100, s100, 3
    s_add_u32 m0, s48, 32768
    s_nop 0
    buffer_load_dwordx4 v226, s[8:11], s56 offen lds
    s_add_u32 m0, s52, 114688
    s_nop 0
    buffer_load_dwordx4 v230, s[4:7], s58 offen lds
    s_add_u32 m0, s48, 33792
    s_nop 0
    buffer_load_dwordx4 v226, s[12:15], s56 offen lds
    s_waitcnt vmcnt(8)
    s_barrier
    s_add_u32 m0, s98, 151552
    s_mul_i32 s59, s58, 448
    buffer_load_dwordx4 v234, s[20:23], s59 offen lds
    s_add_u32 m0, s49, 32768
    s_nop 0
    buffer_load_dwordx4 v227, s[8:11], s56 offen lds
    s_add_u32 m0, s53, 114688
    s_nop 0
    buffer_load_dwordx4 v231, s[4:7], s58 offen lds
    s_add_u32 m0, s49, 33792
    s_nop 0
    buffer_load_dwordx4 v227, s[12:15], s56 offen lds
    s_add_u32 m0, s50, 32768
    s_nop 0
    buffer_load_dwordx4 v228, s[8:11], s56 offen lds
    s_add_u32 m0, s54, 114688
    s_nop 0
    buffer_load_dwordx4 v232, s[4:7], s58 offen lds
    s_add_u32 m0, s50, 33792
    s_nop 0
    buffer_load_dwordx4 v228, s[12:15], s56 offen lds
    s_add_u32 m0, s51, 32768
    s_nop 0
    buffer_load_dwordx4 v229, s[8:11], s56 offen lds
    s_setprio 3
    s_waitcnt vmcnt(11) lgkmcnt(0)
    s_barrier
    s_add_u32 m0, s55, 114688
    s_nop 0
    buffer_load_dwordx4 v233, s[4:7], s58 offen lds
    s_add_u32 m0, s51, 33792
    s_nop 0
    buffer_load_dwordx4 v229, s[12:15], s56 offen lds
    s_and_b32 s58, s100, 0x380
    s_mul_i32 s56, s58, 1792
    s_lshr_b32 s100, s100, 3
    s_add_u32 m0, s48, 65536
    s_nop 0
    buffer_load_dwordx4 v226, s[8:11], s56 offen lds
    s_add_u32 m0, s52, 131072
    s_nop 0
    buffer_load_dwordx4 v230, s[4:7], s58 offen lds
    ds_read_b128 v[160:163], v236 offset:0
    ds_read_b64_tr_b16 v[176:177], v244 offset:0
    ds_read_b64_tr_b16 v[178:179], v244 offset:256
    ds_read_b128 v[164:167], v237 offset:0
    ds_read_b64_tr_b16 v[180:181], v244 offset:1024
    ds_read_b64_tr_b16 v[182:183], v244 offset:1280
    ds_read_b128 v[168:171], v238 offset:0
    ds_read_b64_tr_b16 v[184:185], v244 offset:2048
    ds_read_b64_tr_b16 v[186:187], v244 offset:2304
    ds_read_b128 v[172:175], v239 offset:0
    ds_read_b64_tr_b16 v[188:189], v244 offset:3072
    ds_read_b64_tr_b16 v[190:191], v244 offset:3328
    ds_read_b64_tr_b16 v[208:209], v247 offset:0
    ds_read_b64_tr_b16 v[210:211], v247 offset:256
    s_add_u32 m0, s48, 66560
    s_nop 0
    buffer_load_dwordx4 v226, s[12:15], s56 offen lds
    s_add_u32 m0, s98, 155648
    s_mul_i32 s59, s58, 448
    buffer_load_dwordx4 v234, s[20:23], s59 offen lds
    s_add_u32 m0, s49, 65536
    s_nop 0
    buffer_load_dwordx4 v227, s[8:11], s56 offen lds
    s_waitcnt lgkmcnt(11)
    v_mfma_f32_32x32x16_bf16 v[192:207], v[176:179], v[160:163], 0
    s_waitcnt lgkmcnt(8)
    v_mfma_f32_32x32x16_bf16 v[192:207], v[180:183], v[164:167], v[192:207]
    s_waitcnt lgkmcnt(5)
    v_mfma_f32_32x32x16_bf16 v[192:207], v[184:187], v[168:171], v[192:207]
    s_waitcnt lgkmcnt(2)
    v_mfma_f32_32x32x16_bf16 v[192:207], v[188:191], v[172:175], v[192:207]
    s_waitcnt lgkmcnt(0)
    v_lshlrev_b32 v3, 16, v208
    v_and_b32 v4, 0xffff0000, v208
    v_add_f32 v220, v220, v3
    v_add_f32 v221, v221, v4
    v_lshlrev_b32 v3, 16, v209
    v_and_b32 v4, 0xffff0000, v209
    v_add_f32 v220, v220, v3
    v_add_f32 v221, v221, v4
    v_lshlrev_b32 v3, 16, v210
    v_and_b32 v4, 0xffff0000, v210
    v_add_f32 v220, v220, v3
    v_add_f32 v221, v221, v4
    v_lshlrev_b32 v3, 16, v211
    v_and_b32 v4, 0xffff0000, v211
    v_add_f32 v220, v220, v3
    v_add_f32 v221, v221, v4
    s_add_u32 m0, s53, 131072
    s_nop 0
    buffer_load_dwordx4 v231, s[4:7], s58 offen lds
    s_add_u32 m0, s49, 66560
    s_nop 0
    buffer_load_dwordx4 v227, s[12:15], s56 offen lds
    s_add_u32 m0, s50, 65536
    s_nop 0
    buffer_load_dwordx4 v228, s[8:11], s56 offen lds
    s_add_u32 m0, s54, 131072
    s_nop 0
    buffer_load_dwordx4 v232, s[4:7], s58 offen lds
    s_add_u32 m0, s50, 66560
    s_nop 0
    buffer_load_dwordx4 v228, s[12:15], s56 offen lds
    s_waitcnt vmcnt(10)
    s_barrier
    s_add_u32 m0, s51, 65536
    s_nop 0
    buffer_load_dwordx4 v229, s[8:11], s56 offen lds
    s_add_u32 m0, s55, 131072
    s_nop 0
    buffer_load_dwordx4 v233, s[4:7], s58 offen lds
    s_add_u32 m0, s51, 66560
    s_nop 0
    buffer_load_dwordx4 v229, s[12:15], s56 offen lds
    s_and_b32 s58, s100, 0x380
    s_mul_i32 s56, s58, 1792
    s_lshr_b32 s100, s100, 3
    s_add_u32 m0, s48, 0
    s_nop 0
    buffer_load_dwordx4 v226, s[8:11], s56 offen lds
    ds_read_b128 v[160:163], v236 offset:16384
    ds_read_b64_tr_b16 v[176:177], v244 offset:4096
    ds_read_b64_tr_b16 v[178:179], v244 offset:4352
    ds_read_b128 v[164:167], v237 offset:16384
    ds_read_b64_tr_b16 v[180:181], v244 offset:5120
    ds_read_b64_tr_b16 v[182:183], v244 offset:5376
    ds_read_b128 v[168:171], v238 offset:16384
    ds_read_b64_tr_b16 v[184:185], v244 offset:6144
    ds_read_b64_tr_b16 v[186:187], v244 offset:6400
    ds_read_b128 v[172:175], v239 offset:16384
    ds_read_b64_tr_b16 v[188:189], v244 offset:7168
    ds_read_b64_tr_b16 v[190:191], v244 offset:7424
    ds_read_b64_tr_b16 v[208:209], v247 offset:4096
    ds_read_b64_tr_b16 v[210:211], v247 offset:4352
    s_add_u32 m0, s52, 98304
    s_nop 0
    buffer_load_dwordx4 v230, s[4:7], s58 offen lds
    s_add_u32 m0, s48, 1024
    s_nop 0
    buffer_load_dwordx4 v226, s[12:15], s56 offen lds
    s_add_u32 m0, s98, 147456
    s_mul_i32 s59, s58, 448
    buffer_load_dwordx4 v234, s[20:23], s59 offen lds
    s_add_u32 m0, s49, 0
    s_nop 0
    buffer_load_dwordx4 v227, s[8:11], s56 offen lds
    s_add_u32 m0, s53, 98304
    s_nop 0
    buffer_load_dwordx4 v231, s[4:7], s58 offen lds
    s_waitcnt lgkmcnt(11)
    v_mfma_f32_32x32x16_bf16 v[192:207], v[176:179], v[160:163], v[192:207]
    s_waitcnt lgkmcnt(8)
    v_mfma_f32_32x32x16_bf16 v[192:207], v[180:183], v[164:167], v[192:207]
    s_waitcnt lgkmcnt(5)
    v_mfma_f32_32x32x16_bf16 v[192:207], v[184:187], v[168:171], v[192:207]
    s_waitcnt lgkmcnt(2)
    v_mfma_f32_32x32x16_bf16 v[192:207], v[188:191], v[172:175], v[192:207]
    s_waitcnt lgkmcnt(0)
    v_lshlrev_b32 v3, 16, v208
    v_and_b32 v4, 0xffff0000, v208
    v_add_f32 v220, v220, v3
    v_add_f32 v221, v221, v4
    v_lshlrev_b32 v3, 16, v209
    v_and_b32 v4, 0xffff0000, v209
    v_add_f32 v220, v220, v3
    v_add_f32 v221, v221, v4
    v_lshlrev_b32 v3, 16, v210
    v_and_b32 v4, 0xffff0000, v210
    v_add_f32 v220, v220, v3
    v_add_f32 v221, v221, v4
    v_lshlrev_b32 v3, 16, v211
    v_and_b32 v4, 0xffff0000, v211
    v_add_f32 v220, v220, v3
    v_add_f32 v221, v221, v4
    s_add_u32 m0, s49, 1024
    s_nop 0
    buffer_load_dwordx4 v227, s[12:15], s56 offen lds
    s_add_u32 m0, s50, 0
    s_nop 0
    buffer_load_dwordx4 v228, s[8:11], s56 offen lds
    s_add_u32 m0, s54, 98304
    s_nop 0
    buffer_load_dwordx4 v232, s[4:7], s58 offen lds
    s_add_u32 m0, s50, 1024
    s_nop 0
    buffer_load_dwordx4 v228, s[12:15], s56 offen lds
    s_add_u32 m0, s51, 0
    s_nop 0
    buffer_load_dwordx4 v229, s[8:11], s56 offen lds
    s_waitcnt vmcnt(11)
    s_barrier
    s_add_u32 m0, s55, 98304
    s_nop 0
    buffer_load_dwordx4 v233, s[4:7], s58 offen lds
    s_add_u32 m0, s51, 1024
    s_nop 0
    buffer_load_dwordx4 v229, s[12:15], s56 offen lds
    s_and_b32 s58, s100, 0x380
    s_mul_i32 s56, s58, 1792
    s_lshr_b32 s100, s100, 3
    s_add_u32 m0, s48, 32768
    s_nop 0
    buffer_load_dwordx4 v226, s[8:11], s56 offen lds
    s_add_u32 m0, s52, 114688
    s_nop 0
    buffer_load_dwordx4 v230, s[4:7], s58 offen lds
    ds_read_b128 v[160:163], v236 offset:32768
    ds_read_b64_tr_b16 v[176:177], v244 offset:8192
    ds_read_b64_tr_b16 v[178:179], v244 offset:8448
    ds_read_b128 v[164:167], v237 offset:32768
    ds_read_b64_tr_b16 v[180:181], v244 offset:9216
    ds_read_b64_tr_b16 v[182:183], v244 offset:9472
    ds_read_b128 v[168:171], v238 offset:32768
    ds_read_b64_tr_b16 v[184:185], v244 offset:10240
    ds_read_b64_tr_b16 v[186:187], v244 offset:10496
    ds_read_b128 v[172:175], v239 offset:32768
    ds_read_b64_tr_b16 v[188:189], v244 offset:11264
    ds_read_b64_tr_b16 v[190:191], v244 offset:11520
    ds_read_b64_tr_b16 v[208:209], v247 offset:8192
    ds_read_b64_tr_b16 v[210:211], v247 offset:8448
    s_add_u32 m0, s48, 33792
    s_nop 0
    buffer_load_dwordx4 v226, s[12:15], s56 offen lds
    s_add_u32 m0, s98, 151552
    s_mul_i32 s59, s58, 448
    buffer_load_dwordx4 v234, s[20:23], s59 offen lds
    s_add_u32 m0, s49, 32768
    s_nop 0
    buffer_load_dwordx4 v227, s[8:11], s56 offen lds
    s_add_u32 m0, s53, 114688
    s_nop 0
    buffer_load_dwordx4 v231, s[4:7], s58 offen lds
    s_add_u32 m0, s49, 33792
    s_nop 0
    buffer_load_dwordx4 v227, s[12:15], s56 offen lds
    s_waitcnt lgkmcnt(11)
    v_mfma_f32_32x32x16_bf16 v[192:207], v[176:179], v[160:163], v[192:207]
    s_waitcnt lgkmcnt(8)
    v_mfma_f32_32x32x16_bf16 v[192:207], v[180:183], v[164:167], v[192:207]
    s_waitcnt lgkmcnt(5)
    v_mfma_f32_32x32x16_bf16 v[192:207], v[184:187], v[168:171], v[192:207]
    s_waitcnt lgkmcnt(2)
    v_mfma_f32_32x32x16_bf16 v[192:207], v[188:191], v[172:175], v[192:207]
    s_waitcnt lgkmcnt(0)
    v_lshlrev_b32 v3, 16, v208
    v_and_b32 v4, 0xffff0000, v208
    v_add_f32 v220, v220, v3
    v_add_f32 v221, v221, v4
    v_lshlrev_b32 v3, 16, v209
    v_and_b32 v4, 0xffff0000, v209
    v_add_f32 v220, v220, v3
    v_add_f32 v221, v221, v4
    v_lshlrev_b32 v3, 16, v210
    v_and_b32 v4, 0xffff0000, v210
    v_add_f32 v220, v220, v3
    v_add_f32 v221, v221, v4
    v_lshlrev_b32 v3, 16, v211
    v_and_b32 v4, 0xffff0000, v211
    v_add_f32 v220, v220, v3
    v_add_f32 v221, v221, v4
    s_add_u32 m0, s50, 32768
    s_nop 0
    buffer_load_dwordx4 v228, s[8:11], s56 offen lds
    s_add_u32 m0, s54, 114688
    s_nop 0
    buffer_load_dwordx4 v232, s[4:7], s58 offen lds
    s_add_u32 m0, s50, 33792
    s_nop 0
    buffer_load_dwordx4 v228, s[12:15], s56 offen lds
    s_add_u32 m0, s51, 32768
    s_nop 0
    buffer_load_dwordx4 v229, s[8:11], s56 offen lds
    s_add_u32 m0, s55, 114688
    s_nop 0
    buffer_load_dwordx4 v233, s[4:7], s58 offen lds
    s_waitcnt vmcnt(12)
    s_barrier
    s_add_u32 m0, s51, 33792
    s_nop 0
    buffer_load_dwordx4 v229, s[12:15], s56 offen lds
    s_and_b32 s58, s100, 0x380
    s_mul_i32 s56, s58, 1792
    s_lshr_b32 s100, s100, 3
    s_add_u32 m0, s48, 65536
    s_nop 0
    buffer_load_dwordx4 v226, s[8:11], s56 offen lds
    s_add_u32 m0, s52, 131072
    s_nop 0
    buffer_load_dwordx4 v230, s[4:7], s58 offen lds
    s_add_u32 m0, s48, 66560
    s_nop 0
    buffer_load_dwordx4 v226, s[12:15], s56 offen lds
    ds_read_b128 v[160:163], v236 offset:0
    ds_read_b64_tr_b16 v[176:177], v244 offset:0
    ds_read_b64_tr_b16 v[178:179], v244 offset:256
    ds_read_b128 v[164:167], v237 offset:0
    ds_read_b64_tr_b16 v[180:181], v244 offset:1024
    ds_read_b64_tr_b16 v[182:183], v244 offset:1280
    ds_read_b128 v[168:171], v238 offset:0
    ds_read_b64_tr_b16 v[184:185], v244 offset:2048
    ds_read_b64_tr_b16 v[186:187], v244 offset:2304
    ds_read_b128 v[172:175], v239 offset:0
    ds_read_b64_tr_b16 v[188:189], v244 offset:3072
    ds_read_b64_tr_b16 v[190:191], v244 offset:3328
    ds_read_b64_tr_b16 v[208:209], v247 offset:0
    ds_read_b64_tr_b16 v[210:211], v247 offset:256
    s_add_u32 m0, s98, 155648
    s_mul_i32 s59, s58, 448
    buffer_load_dwordx4 v234, s[20:23], s59 offen lds
    s_add_u32 m0, s49, 65536
    s_nop 0
    buffer_load_dwordx4 v227, s[8:11], s56 offen lds
    s_add_u32 m0, s53, 131072
    s_nop 0
    buffer_load_dwordx4 v231, s[4:7], s58 offen lds
    s_add_u32 m0, s49, 66560
    s_nop 0
    buffer_load_dwordx4 v227, s[12:15], s56 offen lds
    s_add_u32 m0, s50, 65536
    s_nop 0
    buffer_load_dwordx4 v228, s[8:11], s56 offen lds
    s_waitcnt lgkmcnt(11)
    v_mfma_f32_32x32x16_bf16 v[192:207], v[176:179], v[160:163], v[192:207]
    s_waitcnt lgkmcnt(8)
    v_mfma_f32_32x32x16_bf16 v[192:207], v[180:183], v[164:167], v[192:207]
    s_waitcnt lgkmcnt(5)
    v_mfma_f32_32x32x16_bf16 v[192:207], v[184:187], v[168:171], v[192:207]
    s_waitcnt lgkmcnt(2)
    v_mfma_f32_32x32x16_bf16 v[192:207], v[188:191], v[172:175], v[192:207]
    s_waitcnt lgkmcnt(0)
    v_lshlrev_b32 v3, 16, v208
    v_and_b32 v4, 0xffff0000, v208
    v_add_f32 v220, v220, v3
    v_add_f32 v221, v221, v4
    v_lshlrev_b32 v3, 16, v209
    v_and_b32 v4, 0xffff0000, v209
    v_add_f32 v220, v220, v3
    v_add_f32 v221, v221, v4
    v_lshlrev_b32 v3, 16, v210
    v_and_b32 v4, 0xffff0000, v210
    v_add_f32 v220, v220, v3
    v_add_f32 v221, v221, v4
    v_lshlrev_b32 v3, 16, v211
    v_and_b32 v4, 0xffff0000, v211
    v_add_f32 v220, v220, v3
    v_add_f32 v221, v221, v4
    s_add_u32 m0, s54, 131072
    s_nop 0
    buffer_load_dwordx4 v232, s[4:7], s58 offen lds
    s_add_u32 m0, s50, 66560
    s_nop 0
    buffer_load_dwordx4 v228, s[12:15], s56 offen lds
    s_add_u32 m0, s51, 65536
    s_nop 0
    buffer_load_dwordx4 v229, s[8:11], s56 offen lds
    s_add_u32 m0, s55, 131072
    s_nop 0
    buffer_load_dwordx4 v233, s[4:7], s58 offen lds
    s_add_u32 m0, s51, 66560
    s_nop 0
    buffer_load_dwordx4 v229, s[12:15], s56 offen lds
    s_waitcnt vmcnt(13)
    s_barrier
    s_and_b32 s58, s100, 0x380
    s_mul_i32 s56, s58, 1792
    s_lshr_b32 s100, s100, 3
    s_add_u32 m0, s48, 0
    s_nop 0
    buffer_load_dwordx4 v226, s[8:11], s56 offen lds
    s_add_u32 m0, s52, 98304
    s_nop 0
    buffer_load_dwordx4 v230, s[4:7], s58 offen lds
    s_add_u32 m0, s48, 1024
    s_nop 0
    buffer_load_dwordx4 v226, s[12:15], s56 offen lds
    s_add_u32 m0, s98, 147456
    s_mul_i32 s59, s58, 448
    buffer_load_dwordx4 v234, s[20:23], s59 offen lds
    ds_read_b128 v[160:163], v236 offset:16384
    ds_read_b64_tr_b16 v[176:177], v244 offset:4096
    ds_read_b64_tr_b16 v[178:179], v244 offset:4352
    ds_read_b128 v[164:167], v237 offset:16384
    ds_read_b64_tr_b16 v[180:181], v244 offset:5120
    ds_read_b64_tr_b16 v[182:183], v244 offset:5376
    ds_read_b128 v[168:171], v238 offset:16384
    ds_read_b64_tr_b16 v[184:185], v244 offset:6144
    ds_read_b64_tr_b16 v[186:187], v244 offset:6400
    ds_read_b128 v[172:175], v239 offset:16384
    ds_read_b64_tr_b16 v[188:189], v244 offset:7168
    ds_read_b64_tr_b16 v[190:191], v244 offset:7424
    ds_read_b64_tr_b16 v[208:209], v247 offset:4096
    ds_read_b64_tr_b16 v[210:211], v247 offset:4352
    s_add_u32 m0, s49, 0
    s_nop 0
    buffer_load_dwordx4 v227, s[8:11], s56 offen lds
    s_add_u32 m0, s53, 98304
    s_nop 0
    buffer_load_dwordx4 v231, s[4:7], s58 offen lds
    s_add_u32 m0, s49, 1024
    s_nop 0
    buffer_load_dwordx4 v227, s[12:15], s56 offen lds
    s_add_u32 m0, s50, 0
    s_nop 0
    buffer_load_dwordx4 v228, s[8:11], s56 offen lds
    s_waitcnt lgkmcnt(11)
    v_mfma_f32_32x32x16_bf16 v[192:207], v[176:179], v[160:163], v[192:207]
    s_waitcnt lgkmcnt(8)
    v_mfma_f32_32x32x16_bf16 v[192:207], v[180:183], v[164:167], v[192:207]
    s_waitcnt lgkmcnt(5)
    v_mfma_f32_32x32x16_bf16 v[192:207], v[184:187], v[168:171], v[192:207]
    s_waitcnt lgkmcnt(2)
    v_mfma_f32_32x32x16_bf16 v[192:207], v[188:191], v[172:175], v[192:207]
    s_waitcnt lgkmcnt(0)
    v_lshlrev_b32 v3, 16, v208
    v_and_b32 v4, 0xffff0000, v208
    v_add_f32 v220, v220, v3
    v_add_f32 v221, v221, v4
    v_lshlrev_b32 v3, 16, v209
    v_and_b32 v4, 0xffff0000, v209
    v_add_f32 v220, v220, v3
    v_add_f32 v221, v221, v4
    v_lshlrev_b32 v3, 16, v210
    v_and_b32 v4, 0xffff0000, v210
    v_add_f32 v220, v220, v3
    v_add_f32 v221, v221, v4
    v_lshlrev_b32 v3, 16, v211
    v_and_b32 v4, 0xffff0000, v211
    v_add_f32 v220, v220, v3
    v_add_f32 v221, v221, v4
    s_add_u32 m0, s54, 98304
    s_nop 0
    buffer_load_dwordx4 v232, s[4:7], s58 offen lds
    s_add_u32 m0, s50, 1024
    s_nop 0
    buffer_load_dwordx4 v228, s[12:15], s56 offen lds
    s_add_u32 m0, s51, 0
    s_nop 0
    buffer_load_dwordx4 v229, s[8:11], s56 offen lds
    buffer_load_dword v10, v224, s[24:27], 0 offen sc1
    s_add_u32 m0, s55, 98304
    s_nop 0
    buffer_load_dwordx4 v233, s[4:7], s58 offen lds
    s_add_u32 m0, s51, 1024
    s_nop 0
    buffer_load_dwordx4 v229, s[12:15], s56 offen lds
    s_lshr_b32 s29, s93, 1
    s_lshl_b32 s29, s29, 10
    s_add_u32 s29, s29, s40
    s_add_u32 s28, s29, 0
    buffer_store_dwordx4 v[216:219], v2, s[16:19], s28 offen sc1
    s_add_u32 s28, s29, 147456
    buffer_store_dwordx4 v[216:219], v2, s[16:19], s28 offen sc1
    s_waitcnt vmcnt(16)
    s_barrier
    ds_read_b128 v[160:163], v236 offset:32768
    ds_read_b64_tr_b16 v[176:177], v244 offset:8192
    ds_read_b64_tr_b16 v[178:179], v244 offset:8448
    ds_read_b128 v[164:167], v237 offset:32768
    ds_read_b64_tr_b16 v[180:181], v244 offset:9216
    ds_read_b64_tr_b16 v[182:183], v244 offset:9472
    ds_read_b128 v[168:171], v238 offset:32768
    ds_read_b64_tr_b16 v[184:185], v244 offset:10240
    ds_read_b64_tr_b16 v[186:187], v244 offset:10496
    ds_read_b128 v[172:175], v239 offset:32768
    ds_read_b64_tr_b16 v[188:189], v244 offset:11264
    ds_read_b64_tr_b16 v[190:191], v244 offset:11520
    ds_read_b64_tr_b16 v[208:209], v247 offset:8192
    ds_read_b64_tr_b16 v[210:211], v247 offset:8448
    s_waitcnt vmcnt(4)
    v_cmp_ne_u32 vcc, 1, v10
    s_cbranch_vccnz F_spin1
F_go:
    s_lshl2_add_u32 s28, s90, s93
    s_lshl_b32 s28, s28, 9
    s_add_u32 s28, s28, 2457600
    v_lshlrev_b32 v224, 1, v224
    buffer_load_dwordx4 v[216:219], v224, s[16:19], s28 offen sc1
    s_mov_b32 s29, 2359296
    v_lshlrev_b32 v224, 3, v1
    buffer_load_dwordx2 v[224:225], v224, s[16:19], s29 offen sc1
    buffer_load_dwordx4 v[16:19], v0, s[16:19], s41 offen offset:0 sc1
    buffer_load_dwordx4 v[20:23], v0, s[16:19], s41 offen offset:1024 sc1
    buffer_load_dwordx4 v[24:27], v0, s[16:19], s41 offen offset:2048 sc1
    buffer_load_dwordx4 v[28:31], v0, s[16:19], s41 offen offset:3072 sc1
    s_add_u32 s41, s41, 4096
    s_and_b32 s41, s41, 0xffff
    s_waitcnt lgkmcnt(11)
    v_mfma_f32_32x32x16_bf16 v[192:207], v[176:179], v[160:163], v[192:207]
    s_waitcnt lgkmcnt(8)
    v_mfma_f32_32x32x16_bf16 v[192:207], v[180:183], v[164:167], v[192:207]
    s_waitcnt lgkmcnt(5)
    v_mfma_f32_32x32x16_bf16 v[192:207], v[184:187], v[168:171], v[192:207]
    s_waitcnt lgkmcnt(2)
    v_mfma_f32_32x32x16_bf16 v[192:207], v[188:191], v[172:175], v[192:207]
    s_waitcnt lgkmcnt(0)
    v_lshlrev_b32 v3, 16, v208
    v_and_b32 v4, 0xffff0000, v208
    v_add_f32 v220, v220, v3
    v_add_f32 v221, v221, v4
    v_lshlrev_b32 v3, 16, v209
    v_and_b32 v4, 0xffff0000, v209
    v_add_f32 v220, v220, v3
    v_add_f32 v221, v221, v4
    v_lshlrev_b32 v3, 16, v210
    v_and_b32 v4, 0xffff0000, v210
    v_add_f32 v220, v220, v3
    v_add_f32 v221, v221, v4
    v_lshlrev_b32 v3, 16, v211
    v_and_b32 v4, 0xffff0000, v211
    v_add_f32 v220, v220, v3
    v_add_f32 v221, v221, v4
    s_waitcnt vmcnt(8)
    ds_read_b64_tr_b16 v[208:209], v247 offset:0
    ds_read_b64_tr_b16 v[210:211], v247 offset:256
    s_waitcnt lgkmcnt(0)
    v_lshlrev_b32 v3, 16, v208
    v_and_b32 v4, 0xffff0000, v208
    v_add_f32 v220, v220, v3
    v_add_f32 v221, v221, v4
    v_lshlrev_b32 v3, 16, v209
    v_and_b32 v4, 0xffff0000, v209
    v_add_f32 v220, v220, v3
    v_add_f32 v221, v221, v4
    v_lshlrev_b32 v3, 16, v210
    v_and_b32 v4, 0xffff0000, v210
    v_add_f32 v220, v220, v3
    v_add_f32 v221, v221, v4
    v_lshlrev_b32 v3, 16, v211
    v_and_b32 v4, 0xffff0000, v211
    v_add_f32 v220, v220, v3
    v_add_f32 v221, v221, v4
    v_add_f32 v220, v220, v221
    ds_write_b32 v248, v220
    buffer_load_dwordx4 v[32:35], v0, s[16:19], s41 offen offset:0 sc1
    buffer_load_dwordx4 v[36:39], v0, s[16:19], s41 offen offset:1024 sc1
    buffer_load_dwordx4 v[40:43], v0, s[16:19], s41 offen offset:2048 sc1
    buffer_load_dwordx4 v[44:47], v0, s[16:19], s41 offen offset:3072 sc1
    s_add_u32 s41, s41, 4096
    s_and_b32 s41, s41, 0xffff
    buffer_load_dwordx4 v[48:51], v0, s[16:19], s41 offen offset:0 sc1
    buffer_load_dwordx4 v[52:55], v0, s[16:19], s41 offen offset:1024 sc1
    buffer_load_dwordx4 v[56:59], v0, s[16:19], s41 offen offset:2048 sc1
    buffer_load_dwordx4 v[60:63], v0, s[16:19], s41 offen offset:3072 sc1
    s_add_u32 s41, s41, 4096
    s_and_b32 s41, s41, 0xffff
    s_waitcnt vmcnt(14) lgkmcnt(0)
    s_barrier
    ds_read_b128 v[160:163], v236 offset:0
    ds_read_b64_tr_b16 v[176:177], v244 offset:0
    ds_read_b64_tr_b16 v[178:179], v244 offset:256
    ds_read_b128 v[164:167], v237 offset:0
    ds_read_b64_tr_b16 v[180:181], v244 offset:1024
    ds_read_b64_tr_b16 v[182:183], v244 offset:1280
    ds_read_b128 v[168:171], v238 offset:0
    ds_read_b64_tr_b16 v[184:185], v244 offset:2048
    ds_read_b64_tr_b16 v[186:187], v244 offset:2304
    ds_read_b128 v[172:175], v239 offset:0
    ds_read_b64_tr_b16 v[188:189], v244 offset:3072
    ds_read_b64_tr_b16 v[190:191], v244 offset:3328
    ds_read_b128 v[208:211], v249 offset:0
    ds_read_b128 v[212:215], v249 offset:16
    s_waitcnt lgkmcnt(11)
    v_mfma_f32_32x32x16_bf16 v[192:207], v[176:179], v[160:163], v[192:207]
    s_waitcnt lgkmcnt(8)
    v_mfma_f32_32x32x16_bf16 v[192:207], v[180:183], v[164:167], v[192:207]
    s_waitcnt lgkmcnt(5)
    v_mfma_f32_32x32x16_bf16 v[192:207], v[184:187], v[168:171], v[192:207]
    s_waitcnt lgkmcnt(2)
    v_mfma_f32_32x32x16_bf16 v[192:207], v[188:191], v[172:175], v[192:207]
    s_branch F_qfin
F_g1:
F_pgG1_0:
    s_cbranch_execz F_ret
    s_load_dwordx2 s[32:33], s[0:1], 64
    s_load_dwordx2 s[36:37], s[0:1], 32
    s_load_dwordx2 s[44:45], s[0:1], 72
    s_mov_b32 s18, 16777216
    s_mov_b32 s19, 0x20000
    s_mov_b32 s34, 1605632
    s_mov_b32 s35, 0x20000
    s_mov_b32 s38, 401408
    s_mov_b32 s39, 0x20000
    s_mov_b32 s46, 1835008
    s_mov_b32 s47, 0x20000
    s_mov_b64 exec, 0
    s_cmp_eq_u32 s93, 1
    s_cbranch_scc1 F_clg0_1
    s_cmp_eq_u32 s93, 2
    s_cbranch_scc1 F_clg0_2
    s_cmp_eq_u32 s93, 3
    s_cbranch_scc1 F_clg0_3
    s_call_b64 s[28:29], F_pgG1_1
    s_call_b64 s[28:29], F_pgG1_5
    s_call_b64 s[28:29], F_pgR_0
    s_call_b64 s[28:29], F_pgA2_2
    s_call_b64 s[28:29], F_pgA2_6
    s_call_b64 s[28:29], F_pgA2_10
    s_branch F_clg0
F_clg0_1:
    s_call_b64 s[28:29], F_pgG1_2
    s_call_b64 s[28:29], F_pgG1_6
    s_call_b64 s[28:29], F_pgR_1
    s_call_b64 s[28:29], F_pgA2_3
    s_call_b64 s[28:29], F_pgA2_7
    s_call_b64 s[28:29], F_pgA2_11
    s_branch F_clg0
F_clg0_2:
    s_call_b64 s[28:29], F_pgG1_3
    s_call_b64 s[28:29], F_pgG1_7
    s_call_b64 s[28:29], F_pgA2_0
    s_call_b64 s[28:29], F_pgA2_4
    s_call_b64 s[28:29], F_pgA2_8
    s_call_b64 s[28:29], F_pgA2_12
    s_branch F_clg0
F_clg0_3:
    s_call_b64 s[28:29], F_pgG1_4
    s_call_b64 s[28:29], F_pgG1_8
    s_call_b64 s[28:29], F_pgA2_1
    s_call_b64 s[28:29], F_pgA2_5
    s_call_b64 s[28:29], F_pgA2_9
    s_call_b64 s[28:29], F_pgA2_13
F_clg0:
    s_mov_b64 exec, -1
    v_lshlrev_b32 v2, 4, v1
    s_lshl_b32 s28, s92, 8
    s_add_u32 s28, s28, 159744
    v_lshl_add_u32 v8, v1, 2, s28
    v_and_b32 v9, 3, v1
    v_lshlrev_b32 v9, 6, v9
    v_add_lshl_u32 v9, v9, v1, 2
    v_add_u32 v9, 159744, v9
    v_mov_b32 v7, 0
    ds_write_b32 v8, v7
    v_lshrrev_b32 v3, 4, v1
    v_bfe_u32 v4, v1, 2, 2
    v_and_b32 v5, 3, v1
    v_lshlrev_b32 v6, 6, v4
    v_lshl_add_u32 v6, v5, 3, v6
    v_lshl_add_u32 v6, v3, 12, v6
    v_and_b32 v4, 16, v1
    v_lshlrev_b32 v4, 1, v4
    s_lshl_b32 s28, s93, 8
    v_add3_u32 v40, v6, v4, s28
    v_xor_b32 v41, 32, v40
    v_add_u32 v42, 0x10000, v40
    v_add_u32 v43, 0x10000, v41
    v_and_b32 v4, 15, v1
    v_bfe_u32 v5, v1, 1, 3
    v_xor_b32 v5, v5, v3
    v_lshlrev_b32 v5, 4, v5
    v_lshl_add_u32 v5, v4, 7, v5
    s_and_b32 s29, s90, 2
    s_lshl_b32 s29, s29, 5
    v_xor_b32 v5, s29, v5
    v_add_u32 v44, 98304, v5
    v_xor_b32 v45, 64, v44
    v_lshrrev_b32 v5, 5, v1
    v_lshl_add_u32 v4, v5, 4, v4
    v_lshl_add_u32 v4, v4, 3, s28
    v_and_b32 v3, 1, v3
    v_mul_u32_u24 v3, 14336, v3
    v_add_u32 v46, v3, v4
    s_lshl1_add_u32 s28, s90, s3
    s_mul_i32 s98, s28, 294912
    s_and_b32 s31, s92, 1
    s_lshl_b32 s29, s31, 10
    s_add_u32 s98, s98, s29
    s_add_u32 s98, s98, 3145728
    s_lshl_b32 s29, s93, 11
    s_add_u32 s53, s98, s29
    s_add_u32 s97, s53, 57344
    s_mul_i32 s29, s3, 57344
    s_add_u32 s53, s53, s29
    s_sub_u32 s97, s97, s29
    s_lshl_b32 s31, s31, 4
    v_and_or_b32 v48, v1, 15, s31
    s_lshl_b32 s29, s3, 8
    s_add_u32 s29, s29, 161792
    v_lshl_add_u32 v18, v48, 2, s29
    s_lshl_b32 s28, s28, 6
    v_add_u32 v3, s28, v48
    v_mul_u32_u24 v3, 896, v3
    v_lshl_add_u32 v3, v5, 4, v3
    v_bfe_u32 v6, v1, 4, 1
    v_lshl_add_u32 v3, v6, 5, v3
    s_lshl_b32 s30, s91, 7
    s_lshr_b32 s28, s93, 1
    s_lshl_b32 s29, s28, 6
    s_add_u32 s29, s29, s30
    v_add_u32 v15, s29, v3
    v_bfe_u32 v4, v1, 2, 2
    v_lshl_add_u32 v3, v5, 2, v4
    v_mul_u32_u24 v3, 896, v3
    v_lshl_add_u32 v3, v6, 6, v3
    v_lshlrev_b32 v16, 1, v5
    v_xor_b32 v16, v16, v1
    v_and_b32 v16, 3, v16
    v_lshl_add_u32 v3, v16, 4, v3
    v_add_u32 v14, s30, v3
    v_lshrrev_b32 v3, 4, v1
    v_lshlrev_b32 v3, 9, v3
    v_lshl_add_u32 v3, v4, 6, v3
    v_lshl_add_u32 v3, v6, 5, v3
    v_and_b32 v4, 3, v1
    v_lshl_add_u32 v3, v4, 3, v3
    s_lshl_b32 s49, s93, 11
    s_add_u32 s49, s49, 32768
    s_lshl_b32 s28, s28, 8
    s_add_u32 s28, s28, s49
    v_add_u32 v20, s28, v3
    v_xor_b32 v21, 0x20, v20
    v_xor_b32 v22, 0x100, v20
    v_xor_b32 v23, 0x120, v20
    v_add_u32 v24, 57344, v20
    v_add_u32 v25, 57344, v21
    v_add_u32 v26, 57344, v22
    v_add_u32 v27, 57344, v23
    v_add_u32 v28, s49, v2
    v_xor_b32 v29, 0x800, v28
    v_xor_b32 v30, 0x1000, v28
    v_xor_b32 v31, 0x1800, v28
    s_mul_i32 s51, s93, 28672
    s_add_u32 s96, s51, 802816
    s_mul_i32 s29, s3, 802816
    s_add_u32 s51, s51, s29
    s_sub_u32 s96, s96, s29
    s_lshr_b32 s28, s90, 2
    s_mul_i32 s28, s28, 2
    s_and_b32 s29, s90, 3
    s_mul_i32 s29, s29, 0
    s_add_u32 s28, s28, s29
    s_mul_i32 s29, s91, 0
    s_add_u32 s28, s28, s29
    s_mul_i32 s29, s28, 37
    s_lshr_b32 s29, s29, 8
    s_mul_i32 s29, s29, 7
    s_sub_u32 s28, s28, s29
    s_mul_i32 s10, s28, 114688
    s_lshl_b32 s11, s28, 13
    s_mul_i32 s8, s91, 114688
    s_lshl_b32 s9, s91, 13
    s_mov_b32 s50, s8
    s_cmp_gt_u32 s28, s91
    s_subb_u32 s29, s28, 0
    s_cmp_eq_u32 s29, 6
    s_cselect_b32 s29, 0, s29
    s_mul_i32 s12, s29, 114688
    s_lshl_b32 s52, s29, 13
    s_add_u32 s29, s29, 5
    v_add_u32 v4, s29, v1
    v_mul_u32_u24 v3, 43, v4
    v_lshrrev_b32 v3, 8, v3
    v_mul_u32_u24 v3, 6, v3
    v_sub_u32 v17, v4, v3
    v_cmp_le_u32 vcc, s91, v17
    s_nop 1
    v_addc_co_u32 v17, vcc, 0, v17, vcc
    v_min_u32 v3, 13, v1
    v_cmp_lt_u32 vcc, 6, v3
    v_add_u32 v3, s28, v3
    v_mul_u32_u24 v4, 37, v3
    v_lshrrev_b32 v4, 8, v4
    v_mul_u32_u24 v4, 7, v4
    v_sub_u32 v3, v3, v4
    v_cndmask_b32 v3, v17, v3, vcc
    v_cndmask_b32 v4, 0, 1, vcc
    v_xor_b32 v4, s3, v4
    v_mad_u32_u24 v3, v4, 7, v3
    s_lshl_b32 s29, s93, 7
    v_lshl_add_u32 v16, v3, 9, s29
    s_mul_i32 s28, s90, 7168
F_pgG1_1:
    s_cbranch_execz F_ret
    s_add_u32 s28, s28, 2490368
    s_mov_b32 s40, s28
    v_mov_b32 v17, 0
    s_mov_b32 s42, -1
    s_lshr_b32 s28, s90, 2
    s_mov_b32 s100, 106181136
    s_cmp_eq_u32 s28, 1
    s_cselect_b32 s100, 88482051, s100
    s_cmp_eq_u32 s28, 2
    s_cselect_b32 s100, 73732146, s100
    s_cmp_eq_u32 s28, 3
    s_cselect_b32 s100, 106169121, s100
    s_lshl_b32 s28, s91, 2
    s_lshr_b32 s100, s100, s28
    s_and_b32 s100, s100, 7
    s_and_b32 s28, s93, 2
    s_lshl_b32 s28, s28, 1
    v_lshrrev_b32 v3, 5, v1
    v_or_b32 v3, s28, v3
    v_bfe_u32 v4, v1, 1, 3
    v_xor_b32 v3, v3, v4
    v_lshlrev_b32 v4, 7, v48
    v_lshl_add_u32 v3, v3, 4, v4
    v_lshl_add_u32 v3, v6, 3, v3
    s_lshl_b32 s28, s3, 13
    s_add_u32 s28, s28, 98304
    v_add_u32 v48, s28, v3
    v_xor_b32 v49, 32, v48
    s_lshl_b32 s99, s93, 16
    s_add_u32 s99, s99, 2097152
    s_lshl1_add_u32 s41, s90, s91
    s_lshl_b32 s41, s41, 13
    s_add_u32 s41, s41, 28672
    s_and_b32 s41, s41, 0xffff
    s_lshl_b32 s28, s93, 11
    s_lshl_b32 s29, s95, 13
    s_add_u32 s28, s28, s29
    s_mul_i32 s29, s90, 589824
    s_add_u32 s28, s28, s29
    s_add_u32 s56, s28, 3145728
    s_lshl_b32 s28, s95, 10
    s_add_u32 s57, s28, 2392064
    s_lshl_b32 s28, s90, 11
    s_add_u32 s58, s28, 2457600
    s_and_b32 s29, s93, 1
    s_lshl1_add_u32 s29, s90, s29
    s_mul_i32 s29, s29, 294912
    s_lshl3_add_u32 s28, s3, s91
    s_lshr_b32 s30, s93, 1
    s_lshl1_add_u32 s28, s28, s30
    s_lshl_b32 s28, s28, 10
    s_add_u32 s28, s28, s29
    s_add_u32 s59, s28, 3260416
    s_waitcnt lgkmcnt(0)
    s_barrier
    ds_read_b64_tr_b16 v[56:57], v40 offset:0
    ds_read_b64_tr_b16 v[58:59], v40 offset:2048
    ds_read_b128 v[88:91], v44 offset:0
    ds_read_b64_tr_b16 v[60:61], v40 offset:1024
    ds_read_b64_tr_b16 v[62:63], v40 offset:3072
    ds_read_b64_tr_b16 v[64:65], v41 offset:0
    ds_read_b64_tr_b16 v[66:67], v41 offset:2048
    ds_read_b64_tr_b16 v[68:69], v41 offset:1024
    ds_read_b64_tr_b16 v[70:71], v41 offset:3072
    ds_read_b128 v[92:95], v44 offset:2048
    ds_read_b128 v[96:99], v44 offset:4096
    ds_read_b128 v[100:103], v44 offset:6144
    s_waitcnt lgkmcnt(9)
    v_mfma_f32_16x16x32_bf16 v[120:123], v[56:59], v[88:91], 0
    ds_read_b128 v[104:107], v44 offset:8192
    s_waitcnt lgkmcnt(8)
    v_mfma_f32_16x16x32_bf16 v[136:139], v[60:63], v[88:91], 0
    s_waitcnt lgkmcnt(6)
    v_mfma_f32_16x16x32_bf16 v[152:155], v[64:67], v[88:91], 0
    s_waitcnt lgkmcnt(4)
    v_mfma_f32_16x16x32_bf16 v[168:171], v[68:71], v[88:91], 0
    s_waitcnt lgkmcnt(3)
    v_mfma_f32_16x16x32_bf16 v[124:127], v[56:59], v[92:95], 0
    ds_read_b128 v[108:111], v44 offset:10240
    v_mfma_f32_16x16x32_bf16 v[140:143], v[60:63], v[92:95], 0
    v_mfma_f32_16x16x32_bf16 v[156:159], v[64:67], v[92:95], 0
    v_mfma_f32_16x16x32_bf16 v[172:175], v[68:71], v[92:95], 0
    s_waitcnt lgkmcnt(3)
    v_mfma_f32_16x16x32_bf16 v[128:131], v[56:59], v[96:99], 0
    ds_read_b128 v[112:115], v44 offset:12288
    v_mfma_f32_16x16x32_bf16 v[144:147], v[60:63], v[96:99], 0
F_pgG1_2:
    s_cbranch_execz F_ret
    v_mfma_f32_16x16x32_bf16 v[160:163], v[64:67], v[96:99], 0
    v_mfma_f32_16x16x32_bf16 v[176:179], v[68:71], v[96:99], 0
    s_waitcnt lgkmcnt(3)
    v_mfma_f32_16x16x32_bf16 v[132:135], v[56:59], v[100:103], 0
    ds_read_b128 v[116:119], v44 offset:14336
    v_mfma_f32_16x16x32_bf16 v[148:151], v[60:63], v[100:103], 0
    v_mfma_f32_16x16x32_bf16 v[164:167], v[64:67], v[100:103], 0
    v_mfma_f32_16x16x32_bf16 v[180:183], v[68:71], v[100:103], 0
    s_waitcnt lgkmcnt(3)
    v_mfma_f32_16x16x32_bf16 v[184:187], v[56:59], v[104:107], 0
    ds_read_b128 v[88:91], v45 offset:0
    v_mfma_f32_16x16x32_bf16 v[200:203], v[60:63], v[104:107], 0
    s_cmp_eq_u32 s100, 0
    v_mfma_f32_16x16x32_bf16 v[216:219], v[64:67], v[104:107], 0
    s_cbranch_scc0 F_xr0
    ds_read_b64 v[32:33], v48 offset:0
    ds_read_b64 v[34:35], v49 offset:0
    ds_read_b64 v[36:37], v48 offset:4096
    ds_read_b64 v[38:39], v49 offset:4096
F_xr0:
    v_mfma_f32_16x16x32_bf16 v[232:235], v[68:71], v[104:107], 0
    s_waitcnt lgkmcnt(3)
    v_mfma_f32_16x16x32_bf16 v[188:191], v[56:59], v[108:111], 0
    ds_read_b128 v[92:95], v45 offset:2048
    v_mfma_f32_16x16x32_bf16 v[204:207], v[60:63], v[108:111], 0
    v_mfma_f32_16x16x32_bf16 v[220:223], v[64:67], v[108:111], 0
    v_mfma_f32_16x16x32_bf16 v[236:239], v[68:71], v[108:111], 0
    s_waitcnt lgkmcnt(3)
    v_mfma_f32_16x16x32_bf16 v[192:195], v[56:59], v[112:115], 0
    ds_read_b128 v[96:99], v45 offset:4096
    v_mfma_f32_16x16x32_bf16 v[208:211], v[60:63], v[112:115], 0
    v_mfma_f32_16x16x32_bf16 v[224:227], v[64:67], v[112:115], 0
    v_mfma_f32_16x16x32_bf16 v[240:243], v[68:71], v[112:115], 0
    s_waitcnt lgkmcnt(3)
    v_mfma_f32_16x16x32_bf16 v[196:199], v[56:59], v[116:119], 0
    ds_read_b128 v[100:103], v45 offset:6144
    v_mfma_f32_16x16x32_bf16 v[212:215], v[60:63], v[116:119], 0
    v_mfma_f32_16x16x32_bf16 v[228:231], v[64:67], v[116:119], 0
    v_mfma_f32_16x16x32_bf16 v[244:247], v[68:71], v[116:119], 0
    s_mov_b64 exec, 0
    s_cmp_eq_u32 s93, 1
    s_cbranch_scc1 F_clg3_1
    s_cmp_eq_u32 s93, 2
    s_cbranch_scc1 F_clg3_2
    s_cmp_eq_u32 s93, 3
    s_cbranch_scc1 F_clg3_3
    s_call_b64 s[28:29], F_pgG2_0
    s_branch F_clg3
F_clg3_1:
    s_call_b64 s[28:29], F_pgG2_1
    s_branch F_clg3
F_clg3_2:
    s_call_b64 s[28:29], F_pgG2_2
    s_branch F_clg3
F_clg3_3:
    s_call_b64 s[28:29], F_pgG2_3
F_clg3:
    s_mov_b64 exec, -1
    s_barrier
    ds_read_b64_tr_b16 v[72:73], v40 offset:16384
    ds_read_b64_tr_b16 v[74:75], v40 offset:18432
    ds_read_b64_tr_b16 v[76:77], v40 offset:17408
    ds_read_b64_tr_b16 v[78:79], v40 offset:19456
    ds_read_b64_tr_b16 v[80:81], v41 offset:16384
    ds_read_b64_tr_b16 v[82:83], v41 offset:18432
    ds_read_b64_tr_b16 v[84:85], v41 offset:17408
    ds_read_b64_tr_b16 v[86:87], v41 offset:19456
    s_waitcnt lgkmcnt(6)
    v_mfma_f32_16x16x32_bf16 v[120:123], v[72:75], v[88:91], v[120:123]
    ds_read_b128 v[104:107], v45 offset:8192
    s_waitcnt lgkmcnt(5)
    v_mfma_f32_16x16x32_bf16 v[136:139], v[76:79], v[88:91], v[136:139]
    s_waitcnt lgkmcnt(3)
    v_mfma_f32_16x16x32_bf16 v[152:155], v[80:83], v[88:91], v[152:155]
    ds_read_b128 v[108:111], v45 offset:10240
    s_waitcnt lgkmcnt(2)
    v_mfma_f32_16x16x32_bf16 v[168:171], v[84:87], v[88:91], v[168:171]
    v_mfma_f32_16x16x32_bf16 v[124:127], v[72:75], v[92:95], v[124:127]
    ds_read_b128 v[112:115], v45 offset:12288
    v_mfma_f32_16x16x32_bf16 v[140:143], v[76:79], v[92:95], v[140:143]
    v_mfma_f32_16x16x32_bf16 v[156:159], v[80:83], v[92:95], v[156:159]
    ds_read_b128 v[116:119], v45 offset:14336
    v_mfma_f32_16x16x32_bf16 v[172:175], v[84:87], v[92:95], v[172:175]
    v_mfma_f32_16x16x32_bf16 v[128:131], v[72:75], v[96:99], v[128:131]
    v_mfma_f32_16x16x32_bf16 v[144:147], v[76:79], v[96:99], v[144:147]
    v_mfma_f32_16x16x32_bf16 v[160:163], v[80:83], v[96:99], v[160:163]
    v_mfma_f32_16x16x32_bf16 v[176:179], v[84:87], v[96:99], v[176:179]
    s_waitcnt lgkmcnt(0)
    s_mov_b64 exec, 0
    s_cmp_eq_u32 s93, 1
    s_cbranch_scc1 F_clg4_1
    s_cmp_eq_u32 s93, 2
    s_cbranch_scc1 F_clg4_2
    s_cmp_eq_u32 s93, 3
    s_cbranch_scc1 F_clg4_3
    s_call_b64 s[28:29], F_pgG2_4
    s_call_b64 s[28:29], F_pgG2_8
    s_branch F_clg4
F_clg4_1:
    s_call_b64 s[28:29], F_pgG2_5
    s_branch F_clg4
F_clg4_2:
    s_call_b64 s[28:29], F_pgG2_6
    s_branch F_clg4
F_clg4_3:
    s_call_b64 s[28:29], F_pgG2_7
F_clg4:
    s_mov_b64 exec, -1
    s_barrier
    v_mfma_f32_16x16x32_bf16 v[132:135], v[72:75], v[100:103], v[132:135]
    ds_read_b64_tr_b16 v[56:57], v40 offset:32768
    v_mfma_f32_16x16x32_bf16 v[148:151], v[76:79], v[100:103], v[148:151]
    ds_read_b64_tr_b16 v[58:59], v40 offset:34816
    v_mfma_f32_16x16x32_bf16 v[164:167], v[80:83], v[100:103], v[164:167]
    v_mfma_f32_16x16x32_bf16 v[180:183], v[84:87], v[100:103], v[180:183]
    ds_read_b128 v[88:91], v44 offset:16384
    v_mfma_f32_16x16x32_bf16 v[184:187], v[72:75], v[104:107], v[184:187]
    ds_read_b64_tr_b16 v[60:61], v40 offset:33792
    v_mfma_f32_16x16x32_bf16 v[200:203], v[76:79], v[104:107], v[200:203]
    v_mfma_f32_16x16x32_bf16 v[216:219], v[80:83], v[104:107], v[216:219]
    ds_read_b64_tr_b16 v[62:63], v40 offset:35840
    v_mfma_f32_16x16x32_bf16 v[232:235], v[84:87], v[104:107], v[232:235]
    ds_read_b64_tr_b16 v[64:65], v41 offset:32768
    v_mfma_f32_16x16x32_bf16 v[188:191], v[72:75], v[108:111], v[188:191]
    v_mfma_f32_16x16x32_bf16 v[204:207], v[76:79], v[108:111], v[204:207]
    ds_read_b64_tr_b16 v[66:67], v41 offset:34816
    v_mfma_f32_16x16x32_bf16 v[220:223], v[80:83], v[108:111], v[220:223]
    ds_read_b64_tr_b16 v[68:69], v41 offset:33792
    v_mfma_f32_16x16x32_bf16 v[236:239], v[84:87], v[108:111], v[236:239]
    v_mfma_f32_16x16x32_bf16 v[192:195], v[72:75], v[112:115], v[192:195]
    ds_read_b64_tr_b16 v[70:71], v41 offset:35840
    v_mfma_f32_16x16x32_bf16 v[208:211], v[76:79], v[112:115], v[208:211]
    ds_read_b128 v[92:95], v44 offset:18432
    v_mfma_f32_16x16x32_bf16 v[224:227], v[80:83], v[112:115], v[224:227]
    v_mfma_f32_16x16x32_bf16 v[240:243], v[84:87], v[112:115], v[240:243]
    ds_read_b128 v[96:99], v44 offset:20480
    v_mfma_f32_16x16x32_bf16 v[196:199], v[72:75], v[116:119], v[196:199]
    ds_read_b128 v[100:103], v44 offset:22528
    v_mfma_f32_16x16x32_bf16 v[212:215], v[76:79], v[116:119], v[212:215]
    v_mfma_f32_16x16x32_bf16 v[228:231], v[80:83], v[116:119], v[228:231]
    v_mfma_f32_16x16x32_bf16 v[244:247], v[84:87], v[116:119], v[244:247]
    s_waitcnt lgkmcnt(9)
    v_mfma_f32_16x16x32_bf16 v[120:123], v[56:59], v[88:91], v[120:123]
    ds_read_b128 v[104:107], v44 offset:24576
    s_waitcnt lgkmcnt(8)
    v_mfma_f32_16x16x32_bf16 v[136:139], v[60:63], v[88:91], v[136:139]
    ds_read_b64_tr_b16 v[72:73], v40 offset:49152
    s_waitcnt lgkmcnt(7)
    v_mfma_f32_16x16x32_bf16 v[152:155], v[64:67], v[88:91], v[152:155]
    ds_read_b64_tr_b16 v[74:75], v40 offset:51200
    s_waitcnt lgkmcnt(6)
    v_mfma_f32_16x16x32_bf16 v[168:171], v[68:71], v[88:91], v[168:171]
    s_waitcnt lgkmcnt(5)
    v_mfma_f32_16x16x32_bf16 v[124:127], v[56:59], v[92:95], v[124:127]
    ds_read_b128 v[108:111], v44 offset:26624
    v_mfma_f32_16x16x32_bf16 v[140:143], v[60:63], v[92:95], v[140:143]
    ds_read_b64_tr_b16 v[76:77], v40 offset:50176
    v_mfma_f32_16x16x32_bf16 v[156:159], v[64:67], v[92:95], v[156:159]
    ds_read_b64_tr_b16 v[78:79], v40 offset:52224
    v_mfma_f32_16x16x32_bf16 v[172:175], v[68:71], v[92:95], v[172:175]
    s_waitcnt lgkmcnt(7)
    v_mfma_f32_16x16x32_bf16 v[128:131], v[56:59], v[96:99], v[128:131]
    ds_read_b128 v[112:115], v44 offset:28672
    v_mfma_f32_16x16x32_bf16 v[144:147], v[60:63], v[96:99], v[144:147]
    ds_read_b64_tr_b16 v[80:81], v41 offset:49152
    v_mfma_f32_16x16x32_bf16 v[160:163], v[64:67], v[96:99], v[160:163]
    ds_read_b64_tr_b16 v[82:83], v41 offset:51200
    v_mfma_f32_16x16x32_bf16 v[176:179], v[68:71], v[96:99], v[176:179]
    s_waitcnt lgkmcnt(9)
    v_mfma_f32_16x16x32_bf16 v[132:135], v[56:59], v[100:103], v[132:135]
F_pgG1_3:
    s_cbranch_execz F_ret
    ds_read_b128 v[116:119], v44 offset:30720
    v_mfma_f32_16x16x32_bf16 v[148:151], v[60:63], v[100:103], v[148:151]
    ds_read_b64_tr_b16 v[84:85], v41 offset:50176
    v_mfma_f32_16x16x32_bf16 v[164:167], v[64:67], v[100:103], v[164:167]
    ds_read_b64_tr_b16 v[86:87], v41 offset:52224
    v_mfma_f32_16x16x32_bf16 v[180:183], v[68:71], v[100:103], v[180:183]
    s_waitcnt lgkmcnt(11)
    v_mfma_f32_16x16x32_bf16 v[184:187], v[56:59], v[104:107], v[184:187]
    ds_read_b128 v[88:91], v45 offset:16384
    v_mfma_f32_16x16x32_bf16 v[200:203], v[60:63], v[104:107], v[200:203]
    s_cmp_eq_u32 s100, 1
    v_mfma_f32_16x16x32_bf16 v[216:219], v[64:67], v[104:107], v[216:219]
    s_cbranch_scc0 F_xr2
    ds_read_b64 v[32:33], v48 offset:16384
    ds_read_b64 v[34:35], v49 offset:16384
    ds_read_b64 v[36:37], v48 offset:20480
    ds_read_b64 v[38:39], v49 offset:20480
F_xr2:
    v_mfma_f32_16x16x32_bf16 v[232:235], v[68:71], v[104:107], v[232:235]
    s_waitcnt lgkmcnt(9)
    v_mfma_f32_16x16x32_bf16 v[188:191], v[56:59], v[108:111], v[188:191]
    ds_read_b128 v[92:95], v45 offset:18432
    v_mfma_f32_16x16x32_bf16 v[204:207], v[60:63], v[108:111], v[204:207]
    v_mfma_f32_16x16x32_bf16 v[220:223], v[64:67], v[108:111], v[220:223]
    v_mfma_f32_16x16x32_bf16 v[236:239], v[68:71], v[108:111], v[236:239]
    s_waitcnt lgkmcnt(7)
    v_mfma_f32_16x16x32_bf16 v[192:195], v[56:59], v[112:115], v[192:195]
    ds_read_b128 v[96:99], v45 offset:20480
    v_mfma_f32_16x16x32_bf16 v[208:211], v[60:63], v[112:115], v[208:211]
    v_mfma_f32_16x16x32_bf16 v[224:227], v[64:67], v[112:115], v[224:227]
    v_mfma_f32_16x16x32_bf16 v[240:243], v[68:71], v[112:115], v[240:243]
    s_waitcnt lgkmcnt(5)
    v_mfma_f32_16x16x32_bf16 v[196:199], v[56:59], v[116:119], v[196:199]
    ds_read_b128 v[100:103], v45 offset:22528
    v_mfma_f32_16x16x32_bf16 v[212:215], v[60:63], v[116:119], v[212:215]
    v_mfma_f32_16x16x32_bf16 v[228:231], v[64:67], v[116:119], v[228:231]
    v_mfma_f32_16x16x32_bf16 v[244:247], v[68:71], v[116:119], v[244:247]
    s_waitcnt lgkmcnt(3)
    v_mfma_f32_16x16x32_bf16 v[120:123], v[72:75], v[88:91], v[120:123]
    ds_read_b128 v[104:107], v45 offset:24576
    v_mfma_f32_16x16x32_bf16 v[136:139], v[76:79], v[88:91], v[136:139]
    v_mfma_f32_16x16x32_bf16 v[152:155], v[80:83], v[88:91], v[152:155]
    ds_read_b128 v[108:111], v45 offset:26624
    v_mfma_f32_16x16x32_bf16 v[168:171], v[84:87], v[88:91], v[168:171]
    s_waitcnt lgkmcnt(4)
    v_mfma_f32_16x16x32_bf16 v[124:127], v[72:75], v[92:95], v[124:127]
    ds_read_b128 v[112:115], v45 offset:28672
    v_mfma_f32_16x16x32_bf16 v[140:143], v[76:79], v[92:95], v[140:143]
    v_mfma_f32_16x16x32_bf16 v[156:159], v[80:83], v[92:95], v[156:159]
    ds_read_b128 v[116:119], v45 offset:30720
    v_mfma_f32_16x16x32_bf16 v[172:175], v[84:87], v[92:95], v[172:175]
    s_waitcnt lgkmcnt(5)
    v_mfma_f32_16x16x32_bf16 v[128:131], v[72:75], v[96:99], v[128:131]
    v_mfma_f32_16x16x32_bf16 v[144:147], v[76:79], v[96:99], v[144:147]
    v_mfma_f32_16x16x32_bf16 v[160:163], v[80:83], v[96:99], v[160:163]
    v_mfma_f32_16x16x32_bf16 v[176:179], v[84:87], v[96:99], v[176:179]
    s_waitcnt lgkmcnt(0)
    s_barrier
    v_mfma_f32_16x16x32_bf16 v[132:135], v[72:75], v[100:103], v[132:135]
    ds_read_b64_tr_b16 v[56:57], v42 offset:0
    v_mfma_f32_16x16x32_bf16 v[148:151], v[76:79], v[100:103], v[148:151]
    ds_read_b64_tr_b16 v[58:59], v42 offset:2048
    v_mfma_f32_16x16x32_bf16 v[164:167], v[80:83], v[100:103], v[164:167]
    v_mfma_f32_16x16x32_bf16 v[180:183], v[84:87], v[100:103], v[180:183]
    ds_read_b128 v[88:91], v44 offset:32768
    v_mfma_f32_16x16x32_bf16 v[184:187], v[72:75], v[104:107], v[184:187]
    ds_read_b64_tr_b16 v[60:61], v42 offset:1024
    v_mfma_f32_16x16x32_bf16 v[200:203], v[76:79], v[104:107], v[200:203]
    v_mfma_f32_16x16x32_bf16 v[216:219], v[80:83], v[104:107], v[216:219]
    ds_read_b64_tr_b16 v[62:63], v42 offset:3072
    v_mfma_f32_16x16x32_bf16 v[232:235], v[84:87], v[104:107], v[232:235]
    ds_read_b64_tr_b16 v[64:65], v43 offset:0
    v_mfma_f32_16x16x32_bf16 v[188:191], v[72:75], v[108:111], v[188:191]
    v_mfma_f32_16x16x32_bf16 v[204:207], v[76:79], v[108:111], v[204:207]
    ds_read_b64_tr_b16 v[66:67], v43 offset:2048
    v_mfma_f32_16x16x32_bf16 v[220:223], v[80:83], v[108:111], v[220:223]
    ds_read_b64_tr_b16 v[68:69], v43 offset:1024
    v_mfma_f32_16x16x32_bf16 v[236:239], v[84:87], v[108:111], v[236:239]
    v_mfma_f32_16x16x32_bf16 v[192:195], v[72:75], v[112:115], v[192:195]
    ds_read_b64_tr_b16 v[70:71], v43 offset:3072
    v_mfma_f32_16x16x32_bf16 v[208:211], v[76:79], v[112:115], v[208:211]
    ds_read_b128 v[92:95], v44 offset:34816
    v_mfma_f32_16x16x32_bf16 v[224:227], v[80:83], v[112:115], v[224:227]
    v_mfma_f32_16x16x32_bf16 v[240:243], v[84:87], v[112:115], v[240:243]
    ds_read_b128 v[96:99], v44 offset:36864
    v_mfma_f32_16x16x32_bf16 v[196:199], v[72:75], v[116:119], v[196:199]
    ds_read_b128 v[100:103], v44 offset:38912
    v_mfma_f32_16x16x32_bf16 v[212:215], v[76:79], v[116:119], v[212:215]
    v_mfma_f32_16x16x32_bf16 v[228:231], v[80:83], v[116:119], v[228:231]
    v_mfma_f32_16x16x32_bf16 v[244:247], v[84:87], v[116:119], v[244:247]
    s_waitcnt lgkmcnt(9)
    v_mfma_f32_16x16x32_bf16 v[120:123], v[56:59], v[88:91], v[120:123]
    ds_read_b128 v[104:107], v44 offset:40960
    s_waitcnt lgkmcnt(8)
    v_mfma_f32_16x16x32_bf16 v[136:139], v[60:63], v[88:91], v[136:139]
    ds_read_b64_tr_b16 v[72:73], v42 offset:16384
    s_waitcnt lgkmcnt(7)
    v_mfma_f32_16x16x32_bf16 v[152:155], v[64:67], v[88:91], v[152:155]
    ds_read_b64_tr_b16 v[74:75], v42 offset:18432
    s_waitcnt lgkmcnt(6)
    v_mfma_f32_16x16x32_bf16 v[168:171], v[68:71], v[88:91], v[168:171]
    s_waitcnt lgkmcnt(5)
    v_mfma_f32_16x16x32_bf16 v[124:127], v[56:59], v[92:95], v[124:127]
    ds_read_b128 v[108:111], v44 offset:43008
    v_mfma_f32_16x16x32_bf16 v[140:143], v[60:63], v[92:95], v[140:143]
    ds_read_b64_tr_b16 v[76:77], v42 offset:17408
    v_mfma_f32_16x16x32_bf16 v[156:159], v[64:67], v[92:95], v[156:159]
    ds_read_b64_tr_b16 v[78:79], v42 offset:19456
    v_mfma_f32_16x16x32_bf16 v[172:175], v[68:71], v[92:95], v[172:175]
    s_waitcnt lgkmcnt(7)
    v_mfma_f32_16x16x32_bf16 v[128:131], v[56:59], v[96:99], v[128:131]
    ds_read_b128 v[112:115], v44 offset:45056
    v_mfma_f32_16x16x32_bf16 v[144:147], v[60:63], v[96:99], v[144:147]
    ds_read_b64_tr_b16 v[80:81], v43 offset:16384
    v_mfma_f32_16x16x32_bf16 v[160:163], v[64:67], v[96:99], v[160:163]
    ds_read_b64_tr_b16 v[82:83], v43 offset:18432
    v_mfma_f32_16x16x32_bf16 v[176:179], v[68:71], v[96:99], v[176:179]
    s_waitcnt lgkmcnt(9)
    v_mfma_f32_16x16x32_bf16 v[132:135], v[56:59], v[100:103], v[132:135]
    ds_read_b128 v[116:119], v44 offset:47104
    v_mfma_f32_16x16x32_bf16 v[148:151], v[60:63], v[100:103], v[148:151]
    ds_read_b64_tr_b16 v[84:85], v43 offset:17408
    v_mfma_f32_16x16x32_bf16 v[164:167], v[64:67], v[100:103], v[164:167]
    ds_read_b64_tr_b16 v[86:87], v43 offset:19456
    v_mfma_f32_16x16x32_bf16 v[180:183], v[68:71], v[100:103], v[180:183]
    s_waitcnt lgkmcnt(11)
    v_mfma_f32_16x16x32_bf16 v[184:187], v[56:59], v[104:107], v[184:187]
    ds_read_b128 v[88:91], v45 offset:32768
    v_mfma_f32_16x16x32_bf16 v[200:203], v[60:63], v[104:107], v[200:203]
    s_cmp_eq_u32 s100, 2
    v_mfma_f32_16x16x32_bf16 v[216:219], v[64:67], v[104:107], v[216:219]
    s_cbranch_scc0 F_xr4
    ds_read_b64 v[32:33], v48 offset:32768
    ds_read_b64 v[34:35], v49 offset:32768
    ds_read_b64 v[36:37], v48 offset:36864
    ds_read_b64 v[38:39], v49 offset:36864
F_xr4:
    v_mfma_f32_16x16x32_bf16 v[232:235], v[68:71], v[104:107], v[232:235]
    s_waitcnt lgkmcnt(9)
    v_mfma_f32_16x16x32_bf16 v[188:191], v[56:59], v[108:111], v[188:191]
    ds_read_b128 v[92:95], v45 offset:34816
    v_mfma_f32_16x16x32_bf16 v[204:207], v[60:63], v[108:111], v[204:207]
    v_mfma_f32_16x16x32_bf16 v[220:223], v[64:67], v[108:111], v[220:223]
    v_mfma_f32_16x16x32_bf16 v[236:239], v[68:71], v[108:111], v[236:239]
    s_waitcnt lgkmcnt(7)
    v_mfma_f32_16x16x32_bf16 v[192:195], v[56:59], v[112:115], v[192:195]
    ds_read_b128 v[96:99], v45 offset:36864
    v_mfma_f32_16x16x32_bf16 v[208:211], v[60:63], v[112:115], v[208:211]
F_pgG1_4:
    s_cbranch_execz F_ret
    v_mfma_f32_16x16x32_bf16 v[224:227], v[64:67], v[112:115], v[224:227]
    v_mfma_f32_16x16x32_bf16 v[240:243], v[68:71], v[112:115], v[240:243]
    s_waitcnt lgkmcnt(5)
    v_mfma_f32_16x16x32_bf16 v[196:199], v[56:59], v[116:119], v[196:199]
    ds_read_b128 v[100:103], v45 offset:38912
    v_mfma_f32_16x16x32_bf16 v[212:215], v[60:63], v[116:119], v[212:215]
    v_mfma_f32_16x16x32_bf16 v[228:231], v[64:67], v[116:119], v[228:231]
    v_mfma_f32_16x16x32_bf16 v[244:247], v[68:71], v[116:119], v[244:247]
    s_waitcnt lgkmcnt(3)
    v_mfma_f32_16x16x32_bf16 v[120:123], v[72:75], v[88:91], v[120:123]
    ds_read_b128 v[104:107], v45 offset:40960
    v_mfma_f32_16x16x32_bf16 v[136:139], v[76:79], v[88:91], v[136:139]
    v_mfma_f32_16x16x32_bf16 v[152:155], v[80:83], v[88:91], v[152:155]
    ds_read_b128 v[108:111], v45 offset:43008
    v_mfma_f32_16x16x32_bf16 v[168:171], v[84:87], v[88:91], v[168:171]
    s_waitcnt lgkmcnt(4)
    v_mfma_f32_16x16x32_bf16 v[124:127], v[72:75], v[92:95], v[124:127]
    ds_read_b128 v[112:115], v45 offset:45056
    v_mfma_f32_16x16x32_bf16 v[140:143], v[76:79], v[92:95], v[140:143]
    v_mfma_f32_16x16x32_bf16 v[156:159], v[80:83], v[92:95], v[156:159]
    ds_read_b128 v[116:119], v45 offset:47104
    v_mfma_f32_16x16x32_bf16 v[172:175], v[84:87], v[92:95], v[172:175]
    s_waitcnt lgkmcnt(5)
    v_mfma_f32_16x16x32_bf16 v[128:131], v[72:75], v[96:99], v[128:131]
    v_mfma_f32_16x16x32_bf16 v[144:147], v[76:79], v[96:99], v[144:147]
    v_mfma_f32_16x16x32_bf16 v[160:163], v[80:83], v[96:99], v[160:163]
    v_mfma_f32_16x16x32_bf16 v[176:179], v[84:87], v[96:99], v[176:179]
    s_waitcnt lgkmcnt(0)
    s_barrier
    v_mfma_f32_16x16x32_bf16 v[132:135], v[72:75], v[100:103], v[132:135]
    ds_read_b64_tr_b16 v[56:57], v40 offset:0
    v_mfma_f32_16x16x32_bf16 v[148:151], v[76:79], v[100:103], v[148:151]
    ds_read_b64_tr_b16 v[58:59], v40 offset:2048
    v_mfma_f32_16x16x32_bf16 v[164:167], v[80:83], v[100:103], v[164:167]
    v_mfma_f32_16x16x32_bf16 v[180:183], v[84:87], v[100:103], v[180:183]
    ds_read_b128 v[88:91], v44 offset:0
    v_mfma_f32_16x16x32_bf16 v[184:187], v[72:75], v[104:107], v[184:187]
    ds_read_b64_tr_b16 v[60:61], v40 offset:1024
    v_mfma_f32_16x16x32_bf16 v[200:203], v[76:79], v[104:107], v[200:203]
    v_mfma_f32_16x16x32_bf16 v[216:219], v[80:83], v[104:107], v[216:219]
    ds_read_b64_tr_b16 v[62:63], v40 offset:3072
    v_mfma_f32_16x16x32_bf16 v[232:235], v[84:87], v[104:107], v[232:235]
    ds_read_b64_tr_b16 v[64:65], v41 offset:0
    v_mfma_f32_16x16x32_bf16 v[188:191], v[72:75], v[108:111], v[188:191]
    v_mfma_f32_16x16x32_bf16 v[204:207], v[76:79], v[108:111], v[204:207]
    ds_read_b64_tr_b16 v[66:67], v41 offset:2048
    v_mfma_f32_16x16x32_bf16 v[220:223], v[80:83], v[108:111], v[220:223]
    ds_read_b64_tr_b16 v[68:69], v41 offset:1024
    v_mfma_f32_16x16x32_bf16 v[236:239], v[84:87], v[108:111], v[236:239]
    v_mfma_f32_16x16x32_bf16 v[192:195], v[72:75], v[112:115], v[192:195]
    ds_read_b64_tr_b16 v[70:71], v41 offset:3072
    v_mfma_f32_16x16x32_bf16 v[208:211], v[76:79], v[112:115], v[208:211]
    ds_read_b128 v[92:95], v44 offset:2048
    v_mfma_f32_16x16x32_bf16 v[224:227], v[80:83], v[112:115], v[224:227]
    v_mfma_f32_16x16x32_bf16 v[240:243], v[84:87], v[112:115], v[240:243]
    ds_read_b128 v[96:99], v44 offset:4096
    v_mfma_f32_16x16x32_bf16 v[196:199], v[72:75], v[116:119], v[196:199]
    ds_read_b128 v[100:103], v44 offset:6144
    v_mfma_f32_16x16x32_bf16 v[212:215], v[76:79], v[116:119], v[212:215]
    v_mfma_f32_16x16x32_bf16 v[228:231], v[80:83], v[116:119], v[228:231]
    v_mfma_f32_16x16x32_bf16 v[244:247], v[84:87], v[116:119], v[244:247]
    s_waitcnt lgkmcnt(9)
    v_mfma_f32_16x16x32_bf16 v[120:123], v[56:59], v[88:91], v[120:123]
    ds_read_b128 v[104:107], v44 offset:8192
    s_waitcnt lgkmcnt(8)
    v_mfma_f32_16x16x32_bf16 v[136:139], v[60:63], v[88:91], v[136:139]
    ds_read_b64_tr_b16 v[72:73], v40 offset:16384
    s_waitcnt lgkmcnt(7)
    v_mfma_f32_16x16x32_bf16 v[152:155], v[64:67], v[88:91], v[152:155]
    ds_read_b64_tr_b16 v[74:75], v40 offset:18432
    s_waitcnt lgkmcnt(6)
    v_mfma_f32_16x16x32_bf16 v[168:171], v[68:71], v[88:91], v[168:171]
    s_waitcnt lgkmcnt(5)
    v_mfma_f32_16x16x32_bf16 v[124:127], v[56:59], v[92:95], v[124:127]
    ds_read_b128 v[108:111], v44 offset:10240
    v_mfma_f32_16x16x32_bf16 v[140:143], v[60:63], v[92:95], v[140:143]
    ds_read_b64_tr_b16 v[76:77], v40 offset:17408
    v_mfma_f32_16x16x32_bf16 v[156:159], v[64:67], v[92:95], v[156:159]
    ds_read_b64_tr_b16 v[78:79], v40 offset:19456
    v_mfma_f32_16x16x32_bf16 v[172:175], v[68:71], v[92:95], v[172:175]
    s_waitcnt lgkmcnt(7)
    v_mfma_f32_16x16x32_bf16 v[128:131], v[56:59], v[96:99], v[128:131]
    ds_read_b128 v[112:115], v44 offset:12288
    v_mfma_f32_16x16x32_bf16 v[144:147], v[60:63], v[96:99], v[144:147]
    ds_read_b64_tr_b16 v[80:81], v41 offset:16384
    v_mfma_f32_16x16x32_bf16 v[160:163], v[64:67], v[96:99], v[160:163]
    ds_read_b64_tr_b16 v[82:83], v41 offset:18432
    v_mfma_f32_16x16x32_bf16 v[176:179], v[68:71], v[96:99], v[176:179]
    s_waitcnt lgkmcnt(9)
    v_mfma_f32_16x16x32_bf16 v[132:135], v[56:59], v[100:103], v[132:135]
    ds_read_b128 v[116:119], v44 offset:14336
    v_mfma_f32_16x16x32_bf16 v[148:151], v[60:63], v[100:103], v[148:151]
    ds_read_b64_tr_b16 v[84:85], v41 offset:17408
    v_mfma_f32_16x16x32_bf16 v[164:167], v[64:67], v[100:103], v[164:167]
    ds_read_b64_tr_b16 v[86:87], v41 offset:19456
    v_mfma_f32_16x16x32_bf16 v[180:183], v[68:71], v[100:103], v[180:183]
    s_waitcnt lgkmcnt(11)
    v_mfma_f32_16x16x32_bf16 v[184:187], v[56:59], v[104:107], v[184:187]
    ds_read_b128 v[88:91], v45 offset:0
    v_mfma_f32_16x16x32_bf16 v[200:203], v[60:63], v[104:107], v[200:203]
    s_cmp_eq_u32 s100, 3
    v_mfma_f32_16x16x32_bf16 v[216:219], v[64:67], v[104:107], v[216:219]
    s_cbranch_scc0 F_xr6
    ds_read_b64 v[32:33], v48 offset:0
    ds_read_b64 v[34:35], v49 offset:0
    ds_read_b64 v[36:37], v48 offset:4096
    ds_read_b64 v[38:39], v49 offset:4096
F_xr6:
    v_mfma_f32_16x16x32_bf16 v[232:235], v[68:71], v[104:107], v[232:235]
    s_waitcnt lgkmcnt(9)
    v_mfma_f32_16x16x32_bf16 v[188:191], v[56:59], v[108:111], v[188:191]
    ds_read_b128 v[92:95], v45 offset:2048
    v_mfma_f32_16x16x32_bf16 v[204:207], v[60:63], v[108:111], v[204:207]
    v_mfma_f32_16x16x32_bf16 v[220:223], v[64:67], v[108:111], v[220:223]
    v_mfma_f32_16x16x32_bf16 v[236:239], v[68:71], v[108:111], v[236:239]
    s_waitcnt lgkmcnt(7)
    v_mfma_f32_16x16x32_bf16 v[192:195], v[56:59], v[112:115], v[192:195]
    ds_read_b128 v[96:99], v45 offset:4096
    v_mfma_f32_16x16x32_bf16 v[208:211], v[60:63], v[112:115], v[208:211]
    v_mfma_f32_16x16x32_bf16 v[224:227], v[64:67], v[112:115], v[224:227]
    v_mfma_f32_16x16x32_bf16 v[240:243], v[68:71], v[112:115], v[240:243]
    s_waitcnt lgkmcnt(5)
    v_mfma_f32_16x16x32_bf16 v[196:199], v[56:59], v[116:119], v[196:199]
    ds_read_b128 v[100:103], v45 offset:6144
    v_mfma_f32_16x16x32_bf16 v[212:215], v[60:63], v[116:119], v[212:215]
    v_mfma_f32_16x16x32_bf16 v[228:231], v[64:67], v[116:119], v[228:231]
    v_mfma_f32_16x16x32_bf16 v[244:247], v[68:71], v[116:119], v[244:247]
    s_waitcnt lgkmcnt(3)
    v_mfma_f32_16x16x32_bf16 v[120:123], v[72:75], v[88:91], v[120:123]
    ds_read_b128 v[104:107], v45 offset:8192
    v_mfma_f32_16x16x32_bf16 v[136:139], v[76:79], v[88:91], v[136:139]
    v_mfma_f32_16x16x32_bf16 v[152:155], v[80:83], v[88:91], v[152:155]
    ds_read_b128 v[108:111], v45 offset:10240
    v_mfma_f32_16x16x32_bf16 v[168:171], v[84:87], v[88:91], v[168:171]
    s_waitcnt lgkmcnt(4)
    v_mfma_f32_16x16x32_bf16 v[124:127], v[72:75], v[92:95], v[124:127]
    ds_read_b128 v[112:115], v45 offset:12288
    v_mfma_f32_16x16x32_bf16 v[140:143], v[76:79], v[92:95], v[140:143]
    v_mfma_f32_16x16x32_bf16 v[156:159], v[80:83], v[92:95], v[156:159]
    ds_read_b128 v[116:119], v45 offset:14336
    v_mfma_f32_16x16x32_bf16 v[172:175], v[84:87], v[92:95], v[172:175]
    s_waitcnt lgkmcnt(5)
    v_mfma_f32_16x16x32_bf16 v[128:131], v[72:75], v[96:99], v[128:131]
    v_mfma_f32_16x16x32_bf16 v[144:147], v[76:79], v[96:99], v[144:147]
    v_mfma_f32_16x16x32_bf16 v[160:163], v[80:83], v[96:99], v[160:163]
    v_mfma_f32_16x16x32_bf16 v[176:179], v[84:87], v[96:99], v[176:179]
    s_waitcnt lgkmcnt(0)
    s_barrier
    v_mfma_f32_16x16x32_bf16 v[132:135], v[72:75], v[100:103], v[132:135]
F_pgG1_5:
    s_cbranch_execz F_ret
    ds_read_b64_tr_b16 v[56:57], v40 offset:32768
    v_mfma_f32_16x16x32_bf16 v[148:151], v[76:79], v[100:103], v[148:151]
    ds_read_b64_tr_b16 v[58:59], v40 offset:34816
    v_mfma_f32_16x16x32_bf16 v[164:167], v[80:83], v[100:103], v[164:167]
    v_mfma_f32_16x16x32_bf16 v[180:183], v[84:87], v[100:103], v[180:183]
    ds_read_b128 v[88:91], v44 offset:16384
    v_mfma_f32_16x16x32_bf16 v[184:187], v[72:75], v[104:107], v[184:187]
    ds_read_b64_tr_b16 v[60:61], v40 offset:33792
    v_mfma_f32_16x16x32_bf16 v[200:203], v[76:79], v[104:107], v[200:203]
    v_mfma_f32_16x16x32_bf16 v[216:219], v[80:83], v[104:107], v[216:219]
    ds_read_b64_tr_b16 v[62:63], v40 offset:35840
    v_mfma_f32_16x16x32_bf16 v[232:235], v[84:87], v[104:107], v[232:235]
    ds_read_b64_tr_b16 v[64:65], v41 offset:32768
    v_mfma_f32_16x16x32_bf16 v[188:191], v[72:75], v[108:111], v[188:191]
    v_mfma_f32_16x16x32_bf16 v[204:207], v[76:79], v[108:111], v[204:207]
    ds_read_b64_tr_b16 v[66:67], v41 offset:34816
    v_mfma_f32_16x16x32_bf16 v[220:223], v[80:83], v[108:111], v[220:223]
    ds_read_b64_tr_b16 v[68:69], v41 offset:33792
    v_mfma_f32_16x16x32_bf16 v[236:239], v[84:87], v[108:111], v[236:239]
    v_mfma_f32_16x16x32_bf16 v[192:195], v[72:75], v[112:115], v[192:195]
    ds_read_b64_tr_b16 v[70:71], v41 offset:35840
    v_mfma_f32_16x16x32_bf16 v[208:211], v[76:79], v[112:115], v[208:211]
    ds_read_b128 v[92:95], v44 offset:18432
    v_mfma_f32_16x16x32_bf16 v[224:227], v[80:83], v[112:115], v[224:227]
    v_mfma_f32_16x16x32_bf16 v[240:243], v[84:87], v[112:115], v[240:243]
    ds_read_b128 v[96:99], v44 offset:20480
    v_mfma_f32_16x16x32_bf16 v[196:199], v[72:75], v[116:119], v[196:199]
    ds_read_b128 v[100:103], v44 offset:22528
    v_mfma_f32_16x16x32_bf16 v[212:215], v[76:79], v[116:119], v[212:215]
    v_mfma_f32_16x16x32_bf16 v[228:231], v[80:83], v[116:119], v[228:231]
    v_mfma_f32_16x16x32_bf16 v[244:247], v[84:87], v[116:119], v[244:247]
    s_waitcnt lgkmcnt(9)
    v_mfma_f32_16x16x32_bf16 v[120:123], v[56:59], v[88:91], v[120:123]
    ds_read_b128 v[104:107], v44 offset:24576
    s_waitcnt lgkmcnt(8)
    v_mfma_f32_16x16x32_bf16 v[136:139], v[60:63], v[88:91], v[136:139]
    ds_read_b64_tr_b16 v[72:73], v40 offset:49152
    s_waitcnt lgkmcnt(7)
    v_mfma_f32_16x16x32_bf16 v[152:155], v[64:67], v[88:91], v[152:155]
    ds_read_b64_tr_b16 v[74:75], v40 offset:51200
    s_waitcnt lgkmcnt(6)
    v_mfma_f32_16x16x32_bf16 v[168:171], v[68:71], v[88:91], v[168:171]
    s_waitcnt lgkmcnt(5)
    v_mfma_f32_16x16x32_bf16 v[124:127], v[56:59], v[92:95], v[124:127]
    ds_read_b128 v[108:111], v44 offset:26624
    v_mfma_f32_16x16x32_bf16 v[140:143], v[60:63], v[92:95], v[140:143]
    ds_read_b64_tr_b16 v[76:77], v40 offset:50176
    v_mfma_f32_16x16x32_bf16 v[156:159], v[64:67], v[92:95], v[156:159]
    ds_read_b64_tr_b16 v[78:79], v40 offset:52224
    v_mfma_f32_16x16x32_bf16 v[172:175], v[68:71], v[92:95], v[172:175]
    s_waitcnt lgkmcnt(7)
    v_mfma_f32_16x16x32_bf16 v[128:131], v[56:59], v[96:99], v[128:131]
    ds_read_b128 v[112:115], v44 offset:28672
    v_mfma_f32_16x16x32_bf16 v[144:147], v[60:63], v[96:99], v[144:147]
    ds_read_b64_tr_b16 v[80:81], v41 offset:49152
    v_mfma_f32_16x16x32_bf16 v[160:163], v[64:67], v[96:99], v[160:163]
    ds_read_b64_tr_b16 v[82:83], v41 offset:51200
    v_mfma_f32_16x16x32_bf16 v[176:179], v[68:71], v[96:99], v[176:179]
    s_waitcnt lgkmcnt(9)
    v_mfma_f32_16x16x32_bf16 v[132:135], v[56:59], v[100:103], v[132:135]
    ds_read_b128 v[116:119], v44 offset:30720
    v_mfma_f32_16x16x32_bf16 v[148:151], v[60:63], v[100:103], v[148:151]
    ds_read_b64_tr_b16 v[84:85], v41 offset:50176
    v_mfma_f32_16x16x32_bf16 v[164:167], v[64:67], v[100:103], v[164:167]
    ds_read_b64_tr_b16 v[86:87], v41 offset:52224
    v_mfma_f32_16x16x32_bf16 v[180:183], v[68:71], v[100:103], v[180:183]
    s_waitcnt lgkmcnt(11)
    v_mfma_f32_16x16x32_bf16 v[184:187], v[56:59], v[104:107], v[184:187]
    ds_read_b128 v[88:91], v45 offset:16384
    v_mfma_f32_16x16x32_bf16 v[200:203], v[60:63], v[104:107], v[200:203]
    s_cmp_eq_u32 s100, 4
    v_mfma_f32_16x16x32_bf16 v[216:219], v[64:67], v[104:107], v[216:219]
    s_cbranch_scc0 F_xr8
    ds_read_b64 v[32:33], v48 offset:16384
    ds_read_b64 v[34:35], v49 offset:16384
    ds_read_b64 v[36:37], v48 offset:20480
    ds_read_b64 v[38:39], v49 offset:20480
F_xr8:
    v_mfma_f32_16x16x32_bf16 v[232:235], v[68:71], v[104:107], v[232:235]
    s_waitcnt lgkmcnt(9)
    v_mfma_f32_16x16x32_bf16 v[188:191], v[56:59], v[108:111], v[188:191]
    ds_read_b128 v[92:95], v45 offset:18432
    v_mfma_f32_16x16x32_bf16 v[204:207], v[60:63], v[108:111], v[204:207]
    v_mfma_f32_16x16x32_bf16 v[220:223], v[64:67], v[108:111], v[220:223]
    v_mfma_f32_16x16x32_bf16 v[236:239], v[68:71], v[108:111], v[236:239]
    s_waitcnt lgkmcnt(7)
    v_mfma_f32_16x16x32_bf16 v[192:195], v[56:59], v[112:115], v[192:195]
    ds_read_b128 v[96:99], v45 offset:20480
    v_mfma_f32_16x16x32_bf16 v[208:211], v[60:63], v[112:115], v[208:211]
    v_mfma_f32_16x16x32_bf16 v[224:227], v[64:67], v[112:115], v[224:227]
    v_mfma_f32_16x16x32_bf16 v[240:243], v[68:71], v[112:115], v[240:243]
    s_waitcnt lgkmcnt(5)
    v_mfma_f32_16x16x32_bf16 v[196:199], v[56:59], v[116:119], v[196:199]
    ds_read_b128 v[100:103], v45 offset:22528
    v_mfma_f32_16x16x32_bf16 v[212:215], v[60:63], v[116:119], v[212:215]
    v_mfma_f32_16x16x32_bf16 v[228:231], v[64:67], v[116:119], v[228:231]
    v_mfma_f32_16x16x32_bf16 v[244:247], v[68:71], v[116:119], v[244:247]
    s_waitcnt lgkmcnt(3)
    v_mfma_f32_16x16x32_bf16 v[120:123], v[72:75], v[88:91], v[120:123]
    ds_read_b128 v[104:107], v45 offset:24576
    v_mfma_f32_16x16x32_bf16 v[136:139], v[76:79], v[88:91], v[136:139]
    v_mfma_f32_16x16x32_bf16 v[152:155], v[80:83], v[88:91], v[152:155]
    ds_read_b128 v[108:111], v45 offset:26624
    v_mfma_f32_16x16x32_bf16 v[168:171], v[84:87], v[88:91], v[168:171]
    s_waitcnt lgkmcnt(4)
    v_mfma_f32_16x16x32_bf16 v[124:127], v[72:75], v[92:95], v[124:127]
    ds_read_b128 v[112:115], v45 offset:28672
    v_mfma_f32_16x16x32_bf16 v[140:143], v[76:79], v[92:95], v[140:143]
    v_mfma_f32_16x16x32_bf16 v[156:159], v[80:83], v[92:95], v[156:159]
    ds_read_b128 v[116:119], v45 offset:30720
    v_mfma_f32_16x16x32_bf16 v[172:175], v[84:87], v[92:95], v[172:175]
    s_waitcnt lgkmcnt(5)
    v_mfma_f32_16x16x32_bf16 v[128:131], v[72:75], v[96:99], v[128:131]
F_pgG1_6:
    s_cbranch_execz F_ret
    v_mfma_f32_16x16x32_bf16 v[144:147], v[76:79], v[96:99], v[144:147]
    v_mfma_f32_16x16x32_bf16 v[160:163], v[80:83], v[96:99], v[160:163]
    v_mfma_f32_16x16x32_bf16 v[176:179], v[84:87], v[96:99], v[176:179]
    s_waitcnt lgkmcnt(0)
    s_barrier
    v_mfma_f32_16x16x32_bf16 v[132:135], v[72:75], v[100:103], v[132:135]
    ds_read_b64_tr_b16 v[56:57], v42 offset:0
    v_mfma_f32_16x16x32_bf16 v[148:151], v[76:79], v[100:103], v[148:151]
    ds_read_b64_tr_b16 v[58:59], v42 offset:2048
    v_mfma_f32_16x16x32_bf16 v[164:167], v[80:83], v[100:103], v[164:167]
    v_mfma_f32_16x16x32_bf16 v[180:183], v[84:87], v[100:103], v[180:183]
    ds_read_b128 v[88:91], v44 offset:32768
    v_mfma_f32_16x16x32_bf16 v[184:187], v[72:75], v[104:107], v[184:187]
    ds_read_b64_tr_b16 v[60:61], v42 offset:1024
    v_mfma_f32_16x16x32_bf16 v[200:203], v[76:79], v[104:107], v[200:203]
    v_mfma_f32_16x16x32_bf16 v[216:219], v[80:83], v[104:107], v[216:219]
    ds_read_b64_tr_b16 v[62:63], v42 offset:3072
    v_mfma_f32_16x16x32_bf16 v[232:235], v[84:87], v[104:107], v[232:235]
    ds_read_b64_tr_b16 v[64:65], v43 offset:0
    v_mfma_f32_16x16x32_bf16 v[188:191], v[72:75], v[108:111], v[188:191]
    v_mfma_f32_16x16x32_bf16 v[204:207], v[76:79], v[108:111], v[204:207]
    ds_read_b64_tr_b16 v[66:67], v43 offset:2048
    v_mfma_f32_16x16x32_bf16 v[220:223], v[80:83], v[108:111], v[220:223]
    ds_read_b64_tr_b16 v[68:69], v43 offset:1024
    v_mfma_f32_16x16x32_bf16 v[236:239], v[84:87], v[108:111], v[236:239]
    v_mfma_f32_16x16x32_bf16 v[192:195], v[72:75], v[112:115], v[192:195]
    ds_read_b64_tr_b16 v[70:71], v43 offset:3072
    v_mfma_f32_16x16x32_bf16 v[208:211], v[76:79], v[112:115], v[208:211]
    ds_read_b128 v[92:95], v44 offset:34816
    v_mfma_f32_16x16x32_bf16 v[224:227], v[80:83], v[112:115], v[224:227]
    v_mfma_f32_16x16x32_bf16 v[240:243], v[84:87], v[112:115], v[240:243]
    ds_read_b128 v[96:99], v44 offset:36864
    v_mfma_f32_16x16x32_bf16 v[196:199], v[72:75], v[116:119], v[196:199]
    ds_read_b128 v[100:103], v44 offset:38912
    v_mfma_f32_16x16x32_bf16 v[212:215], v[76:79], v[116:119], v[212:215]
    v_mfma_f32_16x16x32_bf16 v[228:231], v[80:83], v[116:119], v[228:231]
    v_mfma_f32_16x16x32_bf16 v[244:247], v[84:87], v[116:119], v[244:247]
    s_waitcnt lgkmcnt(9)
    v_mfma_f32_16x16x32_bf16 v[120:123], v[56:59], v[88:91], v[120:123]
    ds_read_b128 v[104:107], v44 offset:40960
    s_waitcnt lgkmcnt(8)
    v_mfma_f32_16x16x32_bf16 v[136:139], v[60:63], v[88:91], v[136:139]
    ds_read_b64_tr_b16 v[72:73], v42 offset:16384
    s_waitcnt lgkmcnt(7)
    v_mfma_f32_16x16x32_bf16 v[152:155], v[64:67], v[88:91], v[152:155]
    ds_read_b64_tr_b16 v[74:75], v42 offset:18432
    s_waitcnt lgkmcnt(6)
    v_mfma_f32_16x16x32_bf16 v[168:171], v[68:71], v[88:91], v[168:171]
    s_waitcnt lgkmcnt(5)
    v_mfma_f32_16x16x32_bf16 v[124:127], v[56:59], v[92:95], v[124:127]
    ds_read_b128 v[108:111], v44 offset:43008
    v_mfma_f32_16x16x32_bf16 v[140:143], v[60:63], v[92:95], v[140:143]
    ds_read_b64_tr_b16 v[76:77], v42 offset:17408
    v_mfma_f32_16x16x32_bf16 v[156:159], v[64:67], v[92:95], v[156:159]
    ds_read_b64_tr_b16 v[78:79], v42 offset:19456
    v_mfma_f32_16x16x32_bf16 v[172:175], v[68:71], v[92:95], v[172:175]
    s_waitcnt lgkmcnt(7)
    v_mfma_f32_16x16x32_bf16 v[128:131], v[56:59], v[96:99], v[128:131]
    ds_read_b128 v[112:115], v44 offset:45056
    v_mfma_f32_16x16x32_bf16 v[144:147], v[60:63], v[96:99], v[144:147]
    ds_read_b64_tr_b16 v[80:81], v43 offset:16384
    v_mfma_f32_16x16x32_bf16 v[160:163], v[64:67], v[96:99], v[160:163]
    ds_read_b64_tr_b16 v[82:83], v43 offset:18432
    v_mfma_f32_16x16x32_bf16 v[176:179], v[68:71], v[96:99], v[176:179]
    s_waitcnt lgkmcnt(9)
    v_mfma_f32_16x16x32_bf16 v[132:135], v[56:59], v[100:103], v[132:135]
    ds_read_b128 v[116:119], v44 offset:47104
    v_mfma_f32_16x16x32_bf16 v[148:151], v[60:63], v[100:103], v[148:151]
    ds_read_b64_tr_b16 v[84:85], v43 offset:17408
    v_mfma_f32_16x16x32_bf16 v[164:167], v[64:67], v[100:103], v[164:167]
    ds_read_b64_tr_b16 v[86:87], v43 offset:19456
    v_mfma_f32_16x16x32_bf16 v[180:183], v[68:71], v[100:103], v[180:183]
    s_waitcnt lgkmcnt(11)
    v_mfma_f32_16x16x32_bf16 v[184:187], v[56:59], v[104:107], v[184:187]
    ds_read_b128 v[88:91], v45 offset:32768
    v_mfma_f32_16x16x32_bf16 v[200:203], v[60:63], v[104:107], v[200:203]
    s_cmp_eq_u32 s100, 5
    v_mfma_f32_16x16x32_bf16 v[216:219], v[64:67], v[104:107], v[216:219]
    s_cbranch_scc0 F_xr10
    ds_read_b64 v[32:33], v48 offset:32768
    ds_read_b64 v[34:35], v49 offset:32768
    ds_read_b64 v[36:37], v48 offset:36864
    ds_read_b64 v[38:39], v49 offset:36864
F_xr10:
    v_mfma_f32_16x16x32_bf16 v[232:235], v[68:71], v[104:107], v[232:235]
    s_waitcnt lgkmcnt(9)
    v_mfma_f32_16x16x32_bf16 v[188:191], v[56:59], v[108:111], v[188:191]
    ds_read_b128 v[92:95], v45 offset:34816
    v_mfma_f32_16x16x32_bf16 v[204:207], v[60:63], v[108:111], v[204:207]
    v_mfma_f32_16x16x32_bf16 v[220:223], v[64:67], v[108:111], v[220:223]
    v_mfma_f32_16x16x32_bf16 v[236:239], v[68:71], v[108:111], v[236:239]
    s_waitcnt lgkmcnt(7)
    v_mfma_f32_16x16x32_bf16 v[192:195], v[56:59], v[112:115], v[192:195]
    ds_read_b128 v[96:99], v45 offset:36864
    v_mfma_f32_16x16x32_bf16 v[208:211], v[60:63], v[112:115], v[208:211]
    v_mfma_f32_16x16x32_bf16 v[224:227], v[64:67], v[112:115], v[224:227]
    v_mfma_f32_16x16x32_bf16 v[240:243], v[68:71], v[112:115], v[240:243]
    s_waitcnt lgkmcnt(5)
    v_mfma_f32_16x16x32_bf16 v[196:199], v[56:59], v[116:119], v[196:199]
    ds_read_b128 v[100:103], v45 offset:38912
    v_mfma_f32_16x16x32_bf16 v[212:215], v[60:63], v[116:119], v[212:215]
    v_mfma_f32_16x16x32_bf16 v[228:231], v[64:67], v[116:119], v[228:231]
    v_mfma_f32_16x16x32_bf16 v[244:247], v[68:71], v[116:119], v[244:247]
    s_waitcnt lgkmcnt(3)
    v_mfma_f32_16x16x32_bf16 v[120:123], v[72:75], v[88:91], v[120:123]
    ds_read_b128 v[104:107], v45 offset:40960
    v_mfma_f32_16x16x32_bf16 v[136:139], v[76:79], v[88:91], v[136:139]
    v_mfma_f32_16x16x32_bf16 v[152:155], v[80:83], v[88:91], v[152:155]
    ds_read_b128 v[108:111], v45 offset:43008
    v_mfma_f32_16x16x32_bf16 v[168:171], v[84:87], v[88:91], v[168:171]
    s_waitcnt lgkmcnt(4)
    v_mfma_f32_16x16x32_bf16 v[124:127], v[72:75], v[92:95], v[124:127]
    ds_read_b128 v[112:115], v45 offset:45056
    v_mfma_f32_16x16x32_bf16 v[140:143], v[76:79], v[92:95], v[140:143]
    v_mfma_f32_16x16x32_bf16 v[156:159], v[80:83], v[92:95], v[156:159]
    ds_read_b128 v[116:119], v45 offset:47104
    v_mfma_f32_16x16x32_bf16 v[172:175], v[84:87], v[92:95], v[172:175]
    s_waitcnt lgkmcnt(5)
    v_mfma_f32_16x16x32_bf16 v[128:131], v[72:75], v[96:99], v[128:131]
    v_mfma_f32_16x16x32_bf16 v[144:147], v[76:79], v[96:99], v[144:147]
    v_mfma_f32_16x16x32_bf16 v[160:163], v[80:83], v[96:99], v[160:163]
    v_mfma_f32_16x16x32_bf16 v[176:179], v[84:87], v[96:99], v[176:179]
    s_waitcnt lgkmcnt(0)
    s_barrier
    v_mfma_f32_16x16x32_bf16 v[132:135], v[72:75], v[100:103], v[132:135]
    ds_read_b64_tr_b16 v[56:57], v40 offset:0
    buffer_load_dwordx2 v[52:53], v2, s[16:19], s58 offen sc1
    v_mfma_f32_16x16x32_bf16 v[148:151], v[76:79], v[100:103], v[148:151]
    ds_read_b64_tr_b16 v[58:59], v40 offset:2048
    buffer_load_dwordx2 v[54:55], v2, s[16:19], s58 offen offset:1024 sc1
    v_mfma_f32_16x16x32_bf16 v[164:167], v[80:83], v[100:103], v[164:167]
    buffer_load_dwordx2 v[50:51], v46, s[16:19], s57 offen sc1
    v_mfma_f32_16x16x32_bf16 v[180:183], v[84:87], v[100:103], v[180:183]
    ds_read_b128 v[88:91], v44 offset:0
    v_mfma_f32_16x16x32_bf16 v[184:187], v[72:75], v[104:107], v[184:187]
    ds_read_b64_tr_b16 v[60:61], v40 offset:1024
    v_mfma_f32_16x16x32_bf16 v[200:203], v[76:79], v[104:107], v[200:203]
    v_mfma_f32_16x16x32_bf16 v[216:219], v[80:83], v[104:107], v[216:219]
    ds_read_b64_tr_b16 v[62:63], v40 offset:3072
    v_mfma_f32_16x16x32_bf16 v[232:235], v[84:87], v[104:107], v[232:235]
    ds_read_b64_tr_b16 v[64:65], v41 offset:0
    v_mfma_f32_16x16x32_bf16 v[188:191], v[72:75], v[108:111], v[188:191]
    v_mfma_f32_16x16x32_bf16 v[204:207], v[76:79], v[108:111], v[204:207]
    ds_read_b64_tr_b16 v[66:67], v41 offset:2048
    v_mfma_f32_16x16x32_bf16 v[220:223], v[80:83], v[108:111], v[220:223]
    ds_read_b64_tr_b16 v[68:69], v41 offset:1024
    v_mfma_f32_16x16x32_bf16 v[236:239], v[84:87], v[108:111], v[236:239]
F_pgG1_7:
    s_cbranch_execz F_ret
    v_mfma_f32_16x16x32_bf16 v[192:195], v[72:75], v[112:115], v[192:195]
    ds_read_b64_tr_b16 v[70:71], v41 offset:3072
    v_mfma_f32_16x16x32_bf16 v[208:211], v[76:79], v[112:115], v[208:211]
    ds_read_b128 v[92:95], v44 offset:2048
    v_mfma_f32_16x16x32_bf16 v[224:227], v[80:83], v[112:115], v[224:227]
    v_mfma_f32_16x16x32_bf16 v[240:243], v[84:87], v[112:115], v[240:243]
    ds_read_b128 v[96:99], v44 offset:4096
    v_mfma_f32_16x16x32_bf16 v[196:199], v[72:75], v[116:119], v[196:199]
    ds_read_b128 v[100:103], v44 offset:6144
    v_mfma_f32_16x16x32_bf16 v[212:215], v[76:79], v[116:119], v[212:215]
    v_mfma_f32_16x16x32_bf16 v[228:231], v[80:83], v[116:119], v[228:231]
    v_mfma_f32_16x16x32_bf16 v[244:247], v[84:87], v[116:119], v[244:247]
    s_setprio 3
    s_waitcnt lgkmcnt(9)
    v_mfma_f32_16x16x32_bf16 v[120:123], v[56:59], v[88:91], v[120:123]
    ds_read_b128 v[104:107], v44 offset:8192
    s_waitcnt lgkmcnt(8)
    v_mfma_f32_16x16x32_bf16 v[136:139], v[60:63], v[88:91], v[136:139]
    ds_read_b64_tr_b16 v[72:73], v40 offset:16384
    s_waitcnt lgkmcnt(7)
    v_mfma_f32_16x16x32_bf16 v[152:155], v[64:67], v[88:91], v[152:155]
    ds_read_b64_tr_b16 v[74:75], v40 offset:18432
    s_waitcnt lgkmcnt(6)
    v_mfma_f32_16x16x32_bf16 v[168:171], v[68:71], v[88:91], v[168:171]
    s_waitcnt lgkmcnt(5)
    v_mfma_f32_16x16x32_bf16 v[124:127], v[56:59], v[92:95], v[124:127]
    ds_read_b128 v[108:111], v44 offset:10240
    v_mfma_f32_16x16x32_bf16 v[140:143], v[60:63], v[92:95], v[140:143]
    ds_read_b64_tr_b16 v[76:77], v40 offset:17408
    v_mfma_f32_16x16x32_bf16 v[156:159], v[64:67], v[92:95], v[156:159]
    ds_read_b64_tr_b16 v[78:79], v40 offset:19456
    v_mfma_f32_16x16x32_bf16 v[172:175], v[68:71], v[92:95], v[172:175]
    s_waitcnt lgkmcnt(7)
    v_mfma_f32_16x16x32_bf16 v[128:131], v[56:59], v[96:99], v[128:131]
    ds_read_b128 v[112:115], v44 offset:12288
    v_mfma_f32_16x16x32_bf16 v[144:147], v[60:63], v[96:99], v[144:147]
    ds_read_b64_tr_b16 v[80:81], v41 offset:16384
    v_mfma_f32_16x16x32_bf16 v[160:163], v[64:67], v[96:99], v[160:163]
    ds_read_b64_tr_b16 v[82:83], v41 offset:18432
    v_mfma_f32_16x16x32_bf16 v[176:179], v[68:71], v[96:99], v[176:179]
    s_waitcnt lgkmcnt(9)
    v_mfma_f32_16x16x32_bf16 v[132:135], v[56:59], v[100:103], v[132:135]
    ds_read_b128 v[116:119], v44 offset:14336
    v_mfma_f32_16x16x32_bf16 v[148:151], v[60:63], v[100:103], v[148:151]
    ds_read_b64_tr_b16 v[84:85], v41 offset:17408
    v_mfma_f32_16x16x32_bf16 v[164:167], v[64:67], v[100:103], v[164:167]
    ds_read_b64_tr_b16 v[86:87], v41 offset:19456
    v_mfma_f32_16x16x32_bf16 v[180:183], v[68:71], v[100:103], v[180:183]
    s_waitcnt lgkmcnt(11)
    v_mfma_f32_16x16x32_bf16 v[184:187], v[56:59], v[104:107], v[184:187]
    ds_read_b128 v[88:91], v45 offset:0
    v_mfma_f32_16x16x32_bf16 v[200:203], v[60:63], v[104:107], v[200:203]
    s_cmp_eq_u32 s100, 6
    v_mfma_f32_16x16x32_bf16 v[216:219], v[64:67], v[104:107], v[216:219]
    s_cbranch_scc0 F_xr12
    ds_read_b64 v[32:33], v48 offset:0
    ds_read_b64 v[34:35], v49 offset:0
    ds_read_b64 v[36:37], v48 offset:4096
    ds_read_b64 v[38:39], v49 offset:4096
F_xr12:
    v_mfma_f32_16x16x32_bf16 v[232:235], v[68:71], v[104:107], v[232:235]
    s_waitcnt lgkmcnt(9)
    v_mfma_f32_16x16x32_bf16 v[188:191], v[56:59], v[108:111], v[188:191]
    ds_read_b128 v[92:95], v45 offset:2048
    v_mfma_f32_16x16x32_bf16 v[204:207], v[60:63], v[108:111], v[204:207]
    v_mfma_f32_16x16x32_bf16 v[220:223], v[64:67], v[108:111], v[220:223]
    v_mfma_f32_16x16x32_bf16 v[236:239], v[68:71], v[108:111], v[236:239]
    s_waitcnt lgkmcnt(7)
    v_mfma_f32_16x16x32_bf16 v[192:195], v[56:59], v[112:115], v[192:195]
    ds_read_b128 v[96:99], v45 offset:4096
    v_mfma_f32_16x16x32_bf16 v[208:211], v[60:63], v[112:115], v[208:211]
    v_mfma_f32_16x16x32_bf16 v[224:227], v[64:67], v[112:115], v[224:227]
    v_mfma_f32_16x16x32_bf16 v[240:243], v[68:71], v[112:115], v[240:243]
    s_waitcnt lgkmcnt(5)
    v_mfma_f32_16x16x32_bf16 v[196:199], v[56:59], v[116:119], v[196:199]
    ds_read_b128 v[100:103], v45 offset:6144
    v_mfma_f32_16x16x32_bf16 v[212:215], v[60:63], v[116:119], v[212:215]
    v_mfma_f32_16x16x32_bf16 v[228:231], v[64:67], v[116:119], v[228:231]
    v_mfma_f32_16x16x32_bf16 v[244:247], v[68:71], v[116:119], v[244:247]
    s_waitcnt lgkmcnt(3)
    v_mfma_f32_16x16x32_bf16 v[120:123], v[72:75], v[88:91], v[120:123]
    ds_read_b128 v[104:107], v45 offset:8192
    v_mfma_f32_16x16x32_bf16 v[136:139], v[76:79], v[88:91], v[136:139]
    v_mfma_f32_16x16x32_bf16 v[152:155], v[80:83], v[88:91], v[152:155]
    ds_read_b128 v[108:111], v45 offset:10240
    v_mfma_f32_16x16x32_bf16 v[168:171], v[84:87], v[88:91], v[168:171]
    s_waitcnt lgkmcnt(4)
    v_mfma_f32_16x16x32_bf16 v[124:127], v[72:75], v[92:95], v[124:127]
    ds_read_b128 v[112:115], v45 offset:12288
    v_mfma_f32_16x16x32_bf16 v[140:143], v[76:79], v[92:95], v[140:143]
    v_mfma_f32_16x16x32_bf16 v[156:159], v[80:83], v[92:95], v[156:159]
    ds_read_b128 v[116:119], v45 offset:14336
    v_mfma_f32_16x16x32_bf16 v[172:175], v[84:87], v[92:95], v[172:175]
    s_waitcnt lgkmcnt(5)
    v_mfma_f32_16x16x32_bf16 v[128:131], v[72:75], v[96:99], v[128:131]
    v_mfma_f32_16x16x32_bf16 v[144:147], v[76:79], v[96:99], v[144:147]
    v_mfma_f32_16x16x32_bf16 v[160:163], v[80:83], v[96:99], v[160:163]
    v_mfma_f32_16x16x32_bf16 v[176:179], v[84:87], v[96:99], v[176:179]
    s_waitcnt lgkmcnt(0)
    v_mfma_f32_16x16x32_bf16 v[132:135], v[72:75], v[100:103], v[132:135]
    v_mfma_f32_16x16x32_bf16 v[148:151], v[76:79], v[100:103], v[148:151]
    v_mfma_f32_16x16x32_bf16 v[164:167], v[80:83], v[100:103], v[164:167]
    v_mfma_f32_16x16x32_bf16 v[180:183], v[84:87], v[100:103], v[180:183]
    v_mov_b32 v7, 1
    ds_write_b32 v8, v7
    s_waitcnt vmcnt(0)
    s_mov_b32 s31, 0x8000
Fc_chk:
    v_max_u32 v3, v50, v51
    v_cmp_eq_u32 vcc, -1, v3
    s_cbranch_vccnz Fc_retry
Fc_go:
    v_mfma_f32_16x16x32_bf16 v[184:187], v[72:75], v[104:107], v[184:187]
    v_mfma_f32_16x16x32_bf16 v[200:203], v[76:79], v[104:107], v[200:203]
    v_mfma_f32_16x16x4_4b_bf16 v[120:135], v[50:51], v[52:53], v[120:135] cbsz:2 abid:0
    v_mfma_f32_16x16x32_bf16 v[216:219], v[80:83], v[104:107], v[216:219]
    v_mfma_f32_16x16x32_bf16 v[232:235], v[84:87], v[104:107], v[232:235]
    v_mfma_f32_16x16x4_4b_bf16 v[136:151], v[50:51], v[52:53], v[136:151] cbsz:2 abid:1
    v_mfma_f32_16x16x32_bf16 v[188:191], v[72:75], v[108:111], v[188:191]
    v_mfma_f32_16x16x32_bf16 v[204:207], v[76:79], v[108:111], v[204:207]
    v_mfma_f32_16x16x4_4b_bf16 v[152:167], v[50:51], v[52:53], v[152:167] cbsz:2 abid:2
    v_mfma_f32_16x16x32_bf16 v[220:223], v[80:83], v[108:111], v[220:223]
    v_mfma_f32_16x16x32_bf16 v[236:239], v[84:87], v[108:111], v[236:239]
    v_mfma_f32_16x16x4_4b_bf16 v[168:183], v[50:51], v[52:53], v[168:183] cbsz:2 abid:3
    v_mfma_f32_16x16x32_bf16 v[192:195], v[72:75], v[112:115], v[192:195]
    v_mfma_f32_16x16x32_bf16 v[208:211], v[76:79], v[112:115], v[208:211]
    v_mfma_f32_16x16x32_bf16 v[224:227], v[80:83], v[112:115], v[224:227]
    s_nop 2
    v_mul_f32 v120, v120, v136
    v_mul_f32 v121, v121, v137
    v_mfma_f32_16x16x32_bf16 v[240:243], v[84:87], v[112:115], v[240:243]
    v_mul_f32 v122, v122, v138
    v_mul_f32 v123, v123, v139
    v_mfma_f32_16x16x32_bf16 v[196:199], v[72:75], v[116:119], v[196:199]
    v_mul_f32 v152, v152, v168
    v_mul_f32 v153, v153, v169
    v_mfma_f32_16x16x32_bf16 v[212:215], v[76:79], v[116:119], v[212:215]
    v_mul_f32 v154, v154, v170
    v_mul_f32 v155, v155, v171
    v_mfma_f32_16x16x32_bf16 v[228:231], v[80:83], v[116:119], v[228:231]
    v_cvt_pk_bf16_f32 v88, v120, v121
    v_cvt_pk_bf16_f32 v89, v122, v123
    v_mfma_f32_16x16x32_bf16 v[244:247], v[84:87], v[116:119], v[244:247]
    v_cvt_pk_bf16_f32 v90, v152, v153
    v_cvt_pk_bf16_f32 v91, v154, v155
    buffer_store_dwordx4 v[88:91], v2, s[16:19], s56 offen offset:0 sc1
    v_mul_f32 v124, v124, v140
    v_mul_f32 v125, v125, v141
    v_mul_f32 v126, v126, v142
    v_mul_f32 v127, v127, v143
    v_mul_f32 v156, v156, v172
    v_mfma_f32_16x16x4_4b_bf16 v[184:199], v[50:51], v[54:55], v[184:199] cbsz:2 abid:0
    v_mul_f32 v157, v157, v173
    v_mul_f32 v158, v158, v174
    v_mul_f32 v159, v159, v175
    v_cvt_pk_bf16_f32 v92, v124, v125
    v_cvt_pk_bf16_f32 v93, v126, v127
    v_cvt_pk_bf16_f32 v94, v156, v157
    v_cvt_pk_bf16_f32 v95, v158, v159
    v_mfma_f32_16x16x4_4b_bf16 v[200:215], v[50:51], v[54:55], v[200:215] cbsz:2 abid:1
F_pgG1_8:
    s_cbranch_execz F_ret
    buffer_store_dwordx4 v[92:95], v2, s[16:19], s56 offen offset:1024 sc1
    s_add_u32 s56, s56, 147456
    v_mul_f32 v128, v128, v144
    v_mul_f32 v129, v129, v145
    v_mul_f32 v130, v130, v146
    v_mul_f32 v131, v131, v147
    v_mul_f32 v160, v160, v176
    v_mul_f32 v161, v161, v177
    v_mfma_f32_16x16x4_4b_bf16 v[216:231], v[50:51], v[54:55], v[216:231] cbsz:2 abid:2
    v_mul_f32 v162, v162, v178
    v_mul_f32 v163, v163, v179
    v_cvt_pk_bf16_f32 v96, v128, v129
    v_cvt_pk_bf16_f32 v97, v130, v131
    v_cvt_pk_bf16_f32 v98, v160, v161
    v_cvt_pk_bf16_f32 v99, v162, v163
    buffer_store_dwordx4 v[96:99], v2, s[16:19], s56 offen offset:0 sc1
    v_mfma_f32_16x16x4_4b_bf16 v[232:247], v[50:51], v[54:55], v[232:247] cbsz:2 abid:3
    v_mul_f32 v132, v132, v148
    v_mul_f32 v133, v133, v149
    v_mul_f32 v134, v134, v150
    v_mul_f32 v135, v135, v151
    v_mul_f32 v164, v164, v180
    v_mul_f32 v165, v165, v181
    v_mul_f32 v166, v166, v182
    v_mul_f32 v167, v167, v183
    v_cvt_pk_bf16_f32 v100, v132, v133
    v_cvt_pk_bf16_f32 v101, v134, v135
    v_cvt_pk_bf16_f32 v102, v164, v165
    v_cvt_pk_bf16_f32 v103, v166, v167
    buffer_store_dwordx4 v[100:103], v2, s[16:19], s56 offen offset:1024 sc1
    s_add_u32 s56, s56, 147456
    v_mul_f32 v184, v184, v200
    v_mul_f32 v185, v185, v201
    v_mul_f32 v186, v186, v202
    v_mul_f32 v187, v187, v203
    v_mul_f32 v216, v216, v232
    v_mul_f32 v217, v217, v233
    v_mul_f32 v218, v218, v234
    v_mul_f32 v219, v219, v235
    v_cvt_pk_bf16_f32 v104, v184, v185
    v_cvt_pk_bf16_f32 v105, v186, v187
    v_cvt_pk_bf16_f32 v106, v216, v217
    v_cvt_pk_bf16_f32 v107, v218, v219
    buffer_store_dwordx4 v[104:107], v2, s[16:19], s56 offen offset:0 sc1
    v_mul_f32 v188, v188, v204
    v_mul_f32 v189, v189, v205
    v_mul_f32 v190, v190, v206
    v_mul_f32 v191, v191, v207
    v_mul_f32 v220, v220, v236
    v_mul_f32 v221, v221, v237
    v_mul_f32 v222, v222, v238
    v_mul_f32 v223, v223, v239
    v_cvt_pk_bf16_f32 v108, v188, v189
    v_cvt_pk_bf16_f32 v109, v190, v191
    v_cvt_pk_bf16_f32 v110, v220, v221
    v_cvt_pk_bf16_f32 v111, v222, v223
    buffer_store_dwordx4 v[108:111], v2, s[16:19], s56 offen offset:1024 sc1
    s_add_u32 s56, s56, 147456
    v_mul_f32 v192, v192, v208
    v_mul_f32 v193, v193, v209
    v_mul_f32 v194, v194, v210
    v_mul_f32 v195, v195, v211
    v_mul_f32 v224, v224, v240
    v_mul_f32 v225, v225, v241
    v_mul_f32 v226, v226, v242
    v_mul_f32 v227, v227, v243
    v_cvt_pk_bf16_f32 v112, v192, v193
    v_cvt_pk_bf16_f32 v113, v194, v195
    v_cvt_pk_bf16_f32 v114, v224, v225
    v_cvt_pk_bf16_f32 v115, v226, v227
    buffer_store_dwordx4 v[112:115], v2, s[16:19], s56 offen offset:0 sc1
    v_mul_f32 v196, v196, v212
    v_mul_f32 v197, v197, v213
    v_mul_f32 v198, v198, v214
    v_mul_f32 v199, v199, v215
    v_mul_f32 v228, v228, v244
    v_mul_f32 v229, v229, v245
    v_mul_f32 v230, v230, v246
    v_mul_f32 v231, v231, v247
    v_cvt_pk_bf16_f32 v116, v196, v197
    v_cvt_pk_bf16_f32 v117, v198, v199
    v_cvt_pk_bf16_f32 v118, v228, v229
    v_cvt_pk_bf16_f32 v119, v230, v231
    buffer_store_dwordx4 v[116:119], v2, s[16:19], s56 offen offset:1024 sc1
    s_add_u32 s56, s56, 147456
    s_bitcmp1_b32 s93, 0
    s_cbranch_scc1 F_oh1
F_oh0:
    s_cmp_eq_u32 s3, 1
    s_cbranch_scc1 F_oh01
    v_mov_b32 v56, v88
    v_mov_b32 v57, v89
    v_mov_b32 v58, v90
    v_mov_b32 v59, v91
    v_mov_b32 v60, v96
    v_mov_b32 v61, v97
    v_mov_b32 v62, v98
    v_mov_b32 v63, v99
    v_mov_b32 v64, v92
    v_mov_b32 v65, v93
    v_mov_b32 v66, v94
    v_mov_b32 v67, v95
    v_mov_b32 v68, v100
    v_mov_b32 v69, v101
    v_mov_b32 v70, v102
    v_mov_b32 v71, v103
    s_branch F_ohd
F_oh01:
    v_mov_b32 v56, v104
    v_mov_b32 v57, v105
    v_mov_b32 v58, v106
    v_mov_b32 v59, v107
    v_mov_b32 v60, v112
    v_mov_b32 v61, v113
    v_mov_b32 v62, v114
    v_mov_b32 v63, v115
    v_mov_b32 v64, v108
    v_mov_b32 v65, v109
    v_mov_b32 v66, v110
    v_mov_b32 v67, v111
    v_mov_b32 v68, v116
    v_mov_b32 v69, v117
    v_mov_b32 v70, v118
    v_mov_b32 v71, v119
    s_branch F_ohd
F_oh1:
    s_cmp_eq_u32 s3, 1
    s_cbranch_scc1 F_oh11
    v_mov_b32 v56, v92
    v_mov_b32 v57, v93
    v_mov_b32 v58, v94
    v_mov_b32 v59, v95
    v_mov_b32 v60, v100
    v_mov_b32 v61, v101
    v_mov_b32 v62, v102
    v_mov_b32 v63, v103
    v_mov_b32 v64, v88
    v_mov_b32 v65, v89
    v_mov_b32 v66, v90
    v_mov_b32 v67, v91
    v_mov_b32 v68, v96
    v_mov_b32 v69, v97
    v_mov_b32 v70, v98
    v_mov_b32 v71, v99
    s_branch F_ohd
F_oh11:
    v_mov_b32 v56, v108
    v_mov_b32 v57, v109
    v_mov_b32 v58, v110
    v_mov_b32 v59, v111
    v_mov_b32 v60, v116
    v_mov_b32 v61, v117
    v_mov_b32 v62, v118
    v_mov_b32 v63, v119
    v_mov_b32 v64, v104
    v_mov_b32 v65, v105
    v_mov_b32 v66, v106
    v_mov_b32 v67, v107
    v_mov_b32 v68, v112
    v_mov_b32 v69, v113
    v_mov_b32 v70, v114
    v_mov_b32 v71, v115
F_ohd:
    s_setprio 0
    s_branch F_g2
F_qfin:
    v_cmp_gt_u32 vcc, 32, v1
    s_waitcnt lgkmcnt(0)
    v_add_f32 v208, v208, v212
    v_add_f32 v209, v209, v213
    v_add_f32 v210, v210, v214
    v_add_f32 v211, v211, v215
    v_add_f32 v208, v208, v210
    v_add_f32 v209, v209, v211
    v_add_f32 v208, v208, v209
    v_cvt_pk_bf16_f32 v222, v208, v208
    v_and_b32 v3, 0xffff0000, v222
    v_sub_f32 v3, v208, v3
    v_cvt_pk_bf16_f32 v223, v3, v3
    s_waitcnt vmcnt(12)
    buffer_load_dwordx4 v[64:67], v0, s[16:19], s41 offen offset:0 sc1
    v_cndmask_b32 v216, 0, v216, vcc
    v_cndmask_b32 v217, 0, v217, vcc
    v_add_f32 v224, v224, v225
    ds_write_b32 v250, v219
    v_mfma_f32_32x32x8_bf16 v[192:207], v[222:223], v[216:217], v[192:207]
    buffer_load_dwordx4 v[68:71], v0, s[16:19], s41 offen offset:1024 sc1
    v_max_f32_dpp v224, v224, v224 quad_perm:[1,0,3,2] row_mask:0xf bank_mask:0xf
    s_nop 1
    v_max_f32_dpp v224, v224, v224 quad_perm:[2,3,0,1] row_mask:0xf bank_mask:0xf
    s_nop 1
    v_max_f32_dpp v224, v224, v224 row_half_mirror row_mask:0xf bank_mask:0xf
    s_nop 1
    v_max_f32_dpp v224, v224, v224 row_mirror row_mask:0xf bank_mask:0xf
    s_nop 0
    v_readlane_b32 s28, v224, 0
    buffer_load_dwordx4 v[72:75], v0, s[16:19], s41 offen offset:2048 sc1
    v_readlane_b32 s29, v224, 16
    v_readlane_b32 s30, v224, 32
    v_readlane_b32 s31, v224, 48
    v_mul_f32 v192, v192, v218
    v_mul_f32 v193, v193, v218
    buffer_load_dwordx4 v[76:79], v0, s[16:19], s41 offen offset:3072 sc1
    s_add_u32 s41, s41, 4096
    s_and_b32 s41, s41, 0xffff
    v_mul_f32 v194, v194, v218
    v_mul_f32 v195, v195, v218
    v_mul_f32 v196, v196, v218
    v_mul_f32 v197, v197, v218
    v_mul_f32 v198, v198, v218
    buffer_load_dwordx4 v[80:83], v0, s[16:19], s41 offen offset:0 sc1
    v_mul_f32 v199, v199, v218
    v_mul_f32 v200, v200, v218
    v_mul_f32 v201, v201, v218
F_pgA2_0:
    s_cbranch_execz F_ret
    v_mul_f32 v202, v202, v218
    v_mul_f32 v203, v203, v218
    buffer_load_dwordx4 v[84:87], v0, s[16:19], s41 offen offset:1024 sc1
    v_mul_f32 v204, v204, v218
    v_mul_f32 v205, v205, v218
    v_mul_f32 v206, v206, v218
    v_mul_f32 v207, v207, v218
    v_cvt_pk_bf16_f32 v208, v192, v193
    buffer_load_dwordx4 v[88:91], v0, s[16:19], s41 offen offset:2048 sc1
    v_cvt_pk_bf16_f32 v209, v194, v195
    v_cvt_pk_bf16_f32 v210, v196, v197
    v_cvt_pk_bf16_f32 v211, v198, v199
    v_cvt_pk_bf16_f32 v212, v200, v201
    v_cvt_pk_bf16_f32 v213, v202, v203
    buffer_load_dwordx4 v[92:95], v0, s[16:19], s41 offen offset:3072 sc1
    s_add_u32 s41, s41, 4096
    s_and_b32 s41, s41, 0xffff
    v_cvt_pk_bf16_f32 v214, v204, v205
    v_cvt_pk_bf16_f32 v215, v206, v207
    ds_write_b128 v245, v[208:211]
    v_cndmask_b32 v214, 0, v214, vcc
    v_cndmask_b32 v215, 0, v215, vcc
    buffer_load_dwordx4 v[96:99], v0, s[16:19], s41 offen offset:0 sc1
    s_max_u32 s28, s28, s29
    s_max_u32 s30, s30, s31
    s_max_u32 s28, s28, s30
    v_mul_f32 v3, v192, v192
    v_mul_f32 v4, v193, v193
    buffer_load_dwordx4 v[100:103], v0, s[16:19], s41 offen offset:1024 sc1
    v_fmac_f32 v3, v194, v194
    v_fmac_f32 v4, v195, v195
    v_fmac_f32 v3, v196, v196
    v_fmac_f32 v4, v197, v197
    v_fmac_f32 v3, v198, v198
    buffer_load_dwordx4 v[104:107], v0, s[16:19], s41 offen offset:2048 sc1
    v_fmac_f32 v4, v199, v199
    v_fmac_f32 v3, v200, v200
    v_fmac_f32 v4, v201, v201
    v_fmac_f32 v3, v202, v202
    v_fmac_f32 v4, v203, v203
    buffer_load_dwordx4 v[108:111], v0, s[16:19], s41 offen offset:3072 sc1
    s_add_u32 s41, s41, 4096
    s_and_b32 s41, s41, 0xffff
    v_fmac_f32 v3, v204, v204
    v_fmac_f32 v4, v205, v205
    v_fmac_f32 v3, v206, v206
    v_fmac_f32 v4, v207, v207
    v_add_f32 v3, v3, v4
    buffer_load_dwordx4 v[112:115], v0, s[16:19], s41 offen offset:0 sc1
    v_mov_b32 v4, v3
    s_nop 1
    v_permlane32_swap_b32 v3, v4
    v_add_f32 v3, v3, v4
    v_mul_f32 v3, s28, v3
    v_cmp_nge_f32 vcc, 0x45610000, v3
    s_cbranch_vccnz Fq_slow
Fq_fast:
    buffer_load_dwordx4 v[116:119], v0, s[16:19], s41 offen offset:1024 sc1
    ds_write_b128 v245, v[212:215] offset:1024
    v_mov_b32 v7, 1
    ds_write_b32 v8, v7
    ds_read_b32 v10, v9 offset:1024
    s_waitcnt lgkmcnt(0)
    buffer_load_dwordx4 v[120:123], v0, s[16:19], s41 offen offset:2048 sc1
    v_cmp_gt_u32 vcc, 1, v10
    s_cbranch_vccnz F_fs2
F_fs2_ok:
    ds_read_b128 v[128:131], v246 offset:0
    ds_read_b128 v[132:135], v246 offset:1024
    ds_read_b128 v[144:147], v246 offset:4096
    ds_read_b128 v[148:151], v246 offset:5120
    buffer_load_dwordx4 v[124:127], v0, s[16:19], s41 offen offset:3072 sc1
    s_add_u32 s41, s41, 4096
    s_and_b32 s41, s41, 0xffff
    ds_read_b128 v[136:139], v246 offset:2048
    ds_read_b128 v[140:143], v246 offset:3072
    ds_read_b128 v[152:155], v246 offset:6144
    ds_read_b128 v[156:159], v246 offset:7168
    ds_read_b32 v12, v251 offset:0
    ds_read_b32 v13, v251 offset:128
    s_setprio 2
    v_and_b32 v3, 0x100, v2
    v_and_b32 v4, 0x200, v2
    v_and_b32 v0, 0xf0, v2
    v_lshl_add_u32 v0, v3, 2, v0
    s_and_b32 s28, s93, 2
    s_lshl_b32 s28, s28, 8
    v_lshrrev_b32 v4, 1, v4
    v_add3_u32 v0, v0, v4, s28
    v_add_u32 v1, 90112, v11
    s_waitcnt vmcnt(24)
    s_waitcnt lgkmcnt(8)
    v_mfma_f32_32x32x16_bf16 v[160:175], v[16:19], v[128:131], 0
    v_mfma_f32_32x32x16_bf16 v[160:175], v[20:23], v[132:135], v[160:175]
    s_nop 11
    v_exp_f32 v160, v160
    v_exp_f32 v161, v161
    ds_add_u32 v8, v7
    v_exp_f32 v162, v162
    v_exp_f32 v163, v163
    v_exp_f32 v164, v164
    s_waitcnt lgkmcnt(7)
    v_mfma_f32_32x32x16_bf16 v[176:191], v[16:19], v[144:147], 0
    v_exp_f32 v165, v165
    v_exp_f32 v166, v166
    v_exp_f32 v167, v167
    v_cvt_pk_bf16_f32 v160, v160, v161
    v_cvt_pk_bf16_f32 v161, v162, v163
    v_mfma_f32_32x32x16_bf16 v[176:191], v[20:23], v[148:151], v[176:191]
    v_cvt_pk_bf16_f32 v162, v164, v165
    v_cvt_pk_bf16_f32 v163, v166, v167
    v_exp_f32 v168, v168
    v_exp_f32 v169, v169
    v_exp_f32 v170, v170
    v_exp_f32 v171, v171
    v_mfma_f32_32x32x16_bf16 v[192:207], v[24:27], v[160:163], 0
    v_exp_f32 v172, v172
    v_exp_f32 v173, v173
    v_exp_f32 v174, v174
    v_exp_f32 v175, v175
    v_cvt_pk_bf16_f32 v168, v168, v169
    v_cvt_pk_bf16_f32 v169, v170, v171
    v_cvt_pk_bf16_f32 v170, v172, v173
    v_cvt_pk_bf16_f32 v171, v174, v175
    v_exp_f32 v176, v176
    v_exp_f32 v177, v177
    v_mfma_f32_32x32x16_bf16 v[192:207], v[28:31], v[168:171], v[192:207]
    v_exp_f32 v178, v178
    v_exp_f32 v179, v179
    v_exp_f32 v180, v180
    s_waitcnt lgkmcnt(5)
    v_mfma_f32_32x32x16_bf16 v[160:175], v[16:19], v[136:139], 0
    v_exp_f32 v181, v181
    v_exp_f32 v182, v182
    v_exp_f32 v183, v183
    v_cvt_pk_bf16_f32 v176, v176, v177
    v_cvt_pk_bf16_f32 v177, v178, v179
    v_mfma_f32_32x32x16_bf16 v[160:175], v[20:23], v[140:143], v[160:175]
    v_cvt_pk_bf16_f32 v178, v180, v181
    v_cvt_pk_bf16_f32 v179, v182, v183
    v_exp_f32 v184, v184
    v_exp_f32 v185, v185
    v_exp_f32 v186, v186
    v_exp_f32 v187, v187
    v_mfma_f32_32x32x16_bf16 v[224:239], v[24:27], v[176:179], 0
F_pgA2_1:
    s_cbranch_execz F_ret
    v_exp_f32 v188, v188
    v_exp_f32 v189, v189
    v_exp_f32 v190, v190
    v_exp_f32 v191, v191
    v_cvt_pk_bf16_f32 v184, v184, v185
    v_cvt_pk_bf16_f32 v185, v186, v187
    v_cvt_pk_bf16_f32 v186, v188, v189
    v_cvt_pk_bf16_f32 v187, v190, v191
    v_exp_f32 v160, v160
    v_exp_f32 v161, v161
    v_mfma_f32_32x32x16_bf16 v[224:239], v[28:31], v[184:187], v[224:239]
    v_exp_f32 v162, v162
    v_exp_f32 v163, v163
    v_exp_f32 v164, v164
    s_waitcnt lgkmcnt(3)
    v_mfma_f32_32x32x16_bf16 v[176:191], v[16:19], v[152:155], 0
    v_exp_f32 v165, v165
    v_exp_f32 v166, v166
    v_exp_f32 v167, v167
    v_cvt_pk_bf16_f32 v160, v160, v161
    v_cvt_pk_bf16_f32 v161, v162, v163
    v_mfma_f32_32x32x16_bf16 v[176:191], v[20:23], v[156:159], v[176:191]
    v_cvt_pk_bf16_f32 v162, v164, v165
    v_cvt_pk_bf16_f32 v163, v166, v167
    v_exp_f32 v168, v168
    v_exp_f32 v169, v169
    v_exp_f32 v170, v170
    v_exp_f32 v171, v171
    v_mfma_f32_32x32x16_bf16 v[208:223], v[24:27], v[160:163], 0
    v_exp_f32 v172, v172
    v_exp_f32 v173, v173
    v_exp_f32 v174, v174
    v_exp_f32 v175, v175
    v_cvt_pk_bf16_f32 v168, v168, v169
    v_cvt_pk_bf16_f32 v169, v170, v171
    v_cvt_pk_bf16_f32 v170, v172, v173
    v_cvt_pk_bf16_f32 v171, v174, v175
    v_exp_f32 v176, v176
    v_exp_f32 v177, v177
    v_mfma_f32_32x32x16_bf16 v[208:223], v[28:31], v[168:171], v[208:223]
    v_exp_f32 v178, v178
    v_exp_f32 v179, v179
    v_exp_f32 v180, v180
    s_waitcnt vmcnt(20)
    v_mfma_f32_32x32x16_bf16 v[160:175], v[32:35], v[128:131], 0
    v_exp_f32 v181, v181
    v_exp_f32 v182, v182
    v_exp_f32 v183, v183
    v_cvt_pk_bf16_f32 v176, v176, v177
    v_cvt_pk_bf16_f32 v177, v178, v179
    v_mfma_f32_32x32x16_bf16 v[160:175], v[36:39], v[132:135], v[160:175]
    v_cvt_pk_bf16_f32 v178, v180, v181
    v_cvt_pk_bf16_f32 v179, v182, v183
    v_exp_f32 v184, v184
    v_exp_f32 v185, v185
    v_exp_f32 v186, v186
    v_exp_f32 v187, v187
    v_mfma_f32_32x32x16_bf16 v[240:255], v[24:27], v[176:179], 0
    v_exp_f32 v188, v188
    v_exp_f32 v189, v189
    v_exp_f32 v190, v190
    v_exp_f32 v191, v191
    v_cvt_pk_bf16_f32 v184, v184, v185
    v_cvt_pk_bf16_f32 v185, v186, v187
    v_cvt_pk_bf16_f32 v186, v188, v189
    v_cvt_pk_bf16_f32 v187, v190, v191
    v_exp_f32 v160, v160
    v_exp_f32 v161, v161
    v_mfma_f32_32x32x16_bf16 v[240:255], v[28:31], v[184:187], v[240:255]
    v_exp_f32 v162, v162
    v_exp_f32 v163, v163
    v_exp_f32 v164, v164
    v_mfma_f32_32x32x16_bf16 v[176:191], v[32:35], v[144:147], 0
    v_exp_f32 v165, v165
    v_exp_f32 v166, v166
    v_exp_f32 v167, v167
    v_cvt_pk_bf16_f32 v160, v160, v161
    v_cvt_pk_bf16_f32 v161, v162, v163
    v_mfma_f32_32x32x16_bf16 v[176:191], v[36:39], v[148:151], v[176:191]
    v_cvt_pk_bf16_f32 v162, v164, v165
    v_cvt_pk_bf16_f32 v163, v166, v167
    v_exp_f32 v168, v168
    v_exp_f32 v169, v169
    v_exp_f32 v170, v170
    v_exp_f32 v171, v171
    v_mfma_f32_32x32x16_bf16 v[192:207], v[40:43], v[160:163], v[192:207]
    v_exp_f32 v172, v172
    v_exp_f32 v173, v173
    v_exp_f32 v174, v174
    v_exp_f32 v175, v175
    v_cvt_pk_bf16_f32 v168, v168, v169
    v_cvt_pk_bf16_f32 v169, v170, v171
    v_cvt_pk_bf16_f32 v170, v172, v173
    v_cvt_pk_bf16_f32 v171, v174, v175
    v_exp_f32 v176, v176
    v_exp_f32 v177, v177
    v_mfma_f32_32x32x16_bf16 v[192:207], v[44:47], v[168:171], v[192:207]
    v_exp_f32 v178, v178
    v_exp_f32 v179, v179
    v_exp_f32 v180, v180
    v_mfma_f32_32x32x16_bf16 v[160:175], v[32:35], v[136:139], 0
    v_exp_f32 v181, v181
    v_exp_f32 v182, v182
    v_exp_f32 v183, v183
    v_cvt_pk_bf16_f32 v176, v176, v177
    v_cvt_pk_bf16_f32 v177, v178, v179
    v_mfma_f32_32x32x16_bf16 v[160:175], v[36:39], v[140:143], v[160:175]
    v_cvt_pk_bf16_f32 v178, v180, v181
    v_cvt_pk_bf16_f32 v179, v182, v183
    v_exp_f32 v184, v184
    v_exp_f32 v185, v185
    v_exp_f32 v186, v186
    v_exp_f32 v187, v187
    v_mfma_f32_32x32x16_bf16 v[224:239], v[40:43], v[176:179], v[224:239]
    v_exp_f32 v188, v188
    v_exp_f32 v189, v189
    v_exp_f32 v190, v190
    v_exp_f32 v191, v191
    v_cvt_pk_bf16_f32 v184, v184, v185
    v_cvt_pk_bf16_f32 v185, v186, v187
    v_cvt_pk_bf16_f32 v186, v188, v189
    v_cvt_pk_bf16_f32 v187, v190, v191
    v_exp_f32 v160, v160
    v_exp_f32 v161, v161
    v_mfma_f32_32x32x16_bf16 v[224:239], v[44:47], v[184:187], v[224:239]
    v_exp_f32 v162, v162
    v_exp_f32 v163, v163
    v_exp_f32 v164, v164
    v_mfma_f32_32x32x16_bf16 v[176:191], v[32:35], v[152:155], 0
    v_exp_f32 v165, v165
    v_exp_f32 v166, v166
    v_exp_f32 v167, v167
    v_cvt_pk_bf16_f32 v160, v160, v161
    v_cvt_pk_bf16_f32 v161, v162, v163
    v_mfma_f32_32x32x16_bf16 v[176:191], v[36:39], v[156:159], v[176:191]
    v_cvt_pk_bf16_f32 v162, v164, v165
    v_cvt_pk_bf16_f32 v163, v166, v167
    v_exp_f32 v168, v168
    v_exp_f32 v169, v169
    v_exp_f32 v170, v170
    v_exp_f32 v171, v171
    v_mfma_f32_32x32x16_bf16 v[208:223], v[40:43], v[160:163], v[208:223]
    v_exp_f32 v172, v172
    v_exp_f32 v173, v173
    v_exp_f32 v174, v174
    v_exp_f32 v175, v175
    v_cvt_pk_bf16_f32 v168, v168, v169
    v_cvt_pk_bf16_f32 v169, v170, v171
    v_cvt_pk_bf16_f32 v170, v172, v173
    v_cvt_pk_bf16_f32 v171, v174, v175
    v_exp_f32 v176, v176
    v_exp_f32 v177, v177
    v_mfma_f32_32x32x16_bf16 v[208:223], v[44:47], v[168:171], v[208:223]
    v_exp_f32 v178, v178
    v_exp_f32 v179, v179
    v_exp_f32 v180, v180
    s_waitcnt vmcnt(16)
    v_mfma_f32_32x32x16_bf16 v[160:175], v[48:51], v[128:131], 0
    v_exp_f32 v181, v181
    v_exp_f32 v182, v182
    v_exp_f32 v183, v183
    v_cvt_pk_bf16_f32 v176, v176, v177
    v_cvt_pk_bf16_f32 v177, v178, v179
    v_mfma_f32_32x32x16_bf16 v[160:175], v[52:55], v[132:135], v[160:175]
    v_cvt_pk_bf16_f32 v178, v180, v181
    v_cvt_pk_bf16_f32 v179, v182, v183
    v_exp_f32 v184, v184
    v_exp_f32 v185, v185
    v_exp_f32 v186, v186
    v_exp_f32 v187, v187
    v_mfma_f32_32x32x16_bf16 v[240:255], v[40:43], v[176:179], v[240:255]
    v_exp_f32 v188, v188
    v_exp_f32 v189, v189
    v_exp_f32 v190, v190
    v_exp_f32 v191, v191
    v_cvt_pk_bf16_f32 v184, v184, v185
    v_cvt_pk_bf16_f32 v185, v186, v187
    v_cvt_pk_bf16_f32 v186, v188, v189
    v_cvt_pk_bf16_f32 v187, v190, v191
    v_exp_f32 v160, v160
    v_exp_f32 v161, v161
    v_mfma_f32_32x32x16_bf16 v[240:255], v[44:47], v[184:187], v[240:255]
    v_exp_f32 v162, v162
    v_exp_f32 v163, v163
    v_exp_f32 v164, v164
    v_mfma_f32_32x32x16_bf16 v[176:191], v[48:51], v[144:147], 0
    v_exp_f32 v165, v165
    v_exp_f32 v166, v166
    v_exp_f32 v167, v167
    v_cvt_pk_bf16_f32 v160, v160, v161
    v_cvt_pk_bf16_f32 v161, v162, v163
    v_mfma_f32_32x32x16_bf16 v[176:191], v[52:55], v[148:151], v[176:191]
F_pgA2_2:
    s_cbranch_execz F_ret
    v_cvt_pk_bf16_f32 v162, v164, v165
    v_cvt_pk_bf16_f32 v163, v166, v167
    v_exp_f32 v168, v168
    v_exp_f32 v169, v169
    v_exp_f32 v170, v170
    v_exp_f32 v171, v171
    v_mfma_f32_32x32x16_bf16 v[192:207], v[56:59], v[160:163], v[192:207]
    v_exp_f32 v172, v172
    v_exp_f32 v173, v173
    v_exp_f32 v174, v174
    v_exp_f32 v175, v175
    v_cvt_pk_bf16_f32 v168, v168, v169
    v_cvt_pk_bf16_f32 v169, v170, v171
    v_cvt_pk_bf16_f32 v170, v172, v173
    v_cvt_pk_bf16_f32 v171, v174, v175
    v_exp_f32 v176, v176
    v_exp_f32 v177, v177
    v_mfma_f32_32x32x16_bf16 v[192:207], v[60:63], v[168:171], v[192:207]
    v_exp_f32 v178, v178
    v_exp_f32 v179, v179
    v_exp_f32 v180, v180
    v_mfma_f32_32x32x16_bf16 v[160:175], v[48:51], v[136:139], 0
    v_exp_f32 v181, v181
    v_exp_f32 v182, v182
    v_exp_f32 v183, v183
    v_cvt_pk_bf16_f32 v176, v176, v177
    v_cvt_pk_bf16_f32 v177, v178, v179
    v_mfma_f32_32x32x16_bf16 v[160:175], v[52:55], v[140:143], v[160:175]
    v_cvt_pk_bf16_f32 v178, v180, v181
    v_cvt_pk_bf16_f32 v179, v182, v183
    v_exp_f32 v184, v184
    v_exp_f32 v185, v185
    v_exp_f32 v186, v186
    v_exp_f32 v187, v187
    v_mfma_f32_32x32x16_bf16 v[224:239], v[56:59], v[176:179], v[224:239]
    v_exp_f32 v188, v188
    v_exp_f32 v189, v189
    v_exp_f32 v190, v190
    v_exp_f32 v191, v191
    v_cvt_pk_bf16_f32 v184, v184, v185
    v_cvt_pk_bf16_f32 v185, v186, v187
    v_cvt_pk_bf16_f32 v186, v188, v189
    v_cvt_pk_bf16_f32 v187, v190, v191
    v_exp_f32 v160, v160
    v_exp_f32 v161, v161
    v_mfma_f32_32x32x16_bf16 v[224:239], v[60:63], v[184:187], v[224:239]
    v_exp_f32 v162, v162
    v_exp_f32 v163, v163
    v_exp_f32 v164, v164
    v_mfma_f32_32x32x16_bf16 v[176:191], v[48:51], v[152:155], 0
    v_exp_f32 v165, v165
    v_exp_f32 v166, v166
    v_exp_f32 v167, v167
    v_cvt_pk_bf16_f32 v160, v160, v161
    v_cvt_pk_bf16_f32 v161, v162, v163
    v_mfma_f32_32x32x16_bf16 v[176:191], v[52:55], v[156:159], v[176:191]
    v_cvt_pk_bf16_f32 v162, v164, v165
    v_cvt_pk_bf16_f32 v163, v166, v167
    v_exp_f32 v168, v168
    v_exp_f32 v169, v169
    v_exp_f32 v170, v170
    v_exp_f32 v171, v171
    v_mfma_f32_32x32x16_bf16 v[208:223], v[56:59], v[160:163], v[208:223]
    v_exp_f32 v172, v172
    v_exp_f32 v173, v173
    v_exp_f32 v174, v174
    v_exp_f32 v175, v175
    v_cvt_pk_bf16_f32 v168, v168, v169
    v_cvt_pk_bf16_f32 v169, v170, v171
    v_cvt_pk_bf16_f32 v170, v172, v173
    v_cvt_pk_bf16_f32 v171, v174, v175
    v_exp_f32 v176, v176
    v_exp_f32 v177, v177
    v_mfma_f32_32x32x16_bf16 v[208:223], v[60:63], v[168:171], v[208:223]
    v_exp_f32 v178, v178
    v_exp_f32 v179, v179
    v_exp_f32 v180, v180
    s_waitcnt vmcnt(12)
    v_mfma_f32_32x32x16_bf16 v[160:175], v[64:67], v[128:131], 0
    v_exp_f32 v181, v181
    v_exp_f32 v182, v182
    v_exp_f32 v183, v183
    v_cvt_pk_bf16_f32 v176, v176, v177
    v_cvt_pk_bf16_f32 v177, v178, v179
    v_mfma_f32_32x32x16_bf16 v[160:175], v[68:71], v[132:135], v[160:175]
    v_cvt_pk_bf16_f32 v178, v180, v181
    v_cvt_pk_bf16_f32 v179, v182, v183
    v_exp_f32 v184, v184
    v_exp_f32 v185, v185
    v_exp_f32 v186, v186
    v_exp_f32 v187, v187
    v_mfma_f32_32x32x16_bf16 v[240:255], v[56:59], v[176:179], v[240:255]
    v_exp_f32 v188, v188
    v_exp_f32 v189, v189
    v_exp_f32 v190, v190
    v_exp_f32 v191, v191
    v_cvt_pk_bf16_f32 v184, v184, v185
    v_cvt_pk_bf16_f32 v185, v186, v187
    v_cvt_pk_bf16_f32 v186, v188, v189
    v_cvt_pk_bf16_f32 v187, v190, v191
    v_exp_f32 v160, v160
    v_exp_f32 v161, v161
    v_mfma_f32_32x32x16_bf16 v[240:255], v[60:63], v[184:187], v[240:255]
    v_exp_f32 v162, v162
    v_exp_f32 v163, v163
    v_exp_f32 v164, v164
    v_mfma_f32_32x32x16_bf16 v[176:191], v[64:67], v[144:147], 0
    v_exp_f32 v165, v165
    v_exp_f32 v166, v166
    v_exp_f32 v167, v167
    v_cvt_pk_bf16_f32 v160, v160, v161
    v_cvt_pk_bf16_f32 v161, v162, v163
    v_mfma_f32_32x32x16_bf16 v[176:191], v[68:71], v[148:151], v[176:191]
    v_cvt_pk_bf16_f32 v162, v164, v165
    v_cvt_pk_bf16_f32 v163, v166, v167
    v_exp_f32 v168, v168
    v_exp_f32 v169, v169
    v_exp_f32 v170, v170
    v_exp_f32 v171, v171
    v_mfma_f32_32x32x16_bf16 v[192:207], v[72:75], v[160:163], v[192:207]
    v_exp_f32 v172, v172
    v_exp_f32 v173, v173
    v_exp_f32 v174, v174
    v_exp_f32 v175, v175
    v_cvt_pk_bf16_f32 v168, v168, v169
    v_cvt_pk_bf16_f32 v169, v170, v171
    v_cvt_pk_bf16_f32 v170, v172, v173
    v_cvt_pk_bf16_f32 v171, v174, v175
    v_exp_f32 v176, v176
    v_exp_f32 v177, v177
    v_mfma_f32_32x32x16_bf16 v[192:207], v[76:79], v[168:171], v[192:207]
    v_exp_f32 v178, v178
    v_exp_f32 v179, v179
    v_exp_f32 v180, v180
    v_mfma_f32_32x32x16_bf16 v[160:175], v[64:67], v[136:139], 0
    v_exp_f32 v181, v181
    v_exp_f32 v182, v182
    v_exp_f32 v183, v183
    v_cvt_pk_bf16_f32 v176, v176, v177
    v_cvt_pk_bf16_f32 v177, v178, v179
    v_mfma_f32_32x32x16_bf16 v[160:175], v[68:71], v[140:143], v[160:175]
    v_cvt_pk_bf16_f32 v178, v180, v181
    v_cvt_pk_bf16_f32 v179, v182, v183
    v_exp_f32 v184, v184
    v_exp_f32 v185, v185
    v_exp_f32 v186, v186
    v_exp_f32 v187, v187
    v_mfma_f32_32x32x16_bf16 v[224:239], v[72:75], v[176:179], v[224:239]
    v_exp_f32 v188, v188
    v_exp_f32 v189, v189
    v_exp_f32 v190, v190
    v_exp_f32 v191, v191
    v_cvt_pk_bf16_f32 v184, v184, v185
    v_cvt_pk_bf16_f32 v185, v186, v187
    v_cvt_pk_bf16_f32 v186, v188, v189
    v_cvt_pk_bf16_f32 v187, v190, v191
    v_exp_f32 v160, v160
    v_exp_f32 v161, v161
    v_mfma_f32_32x32x16_bf16 v[224:239], v[76:79], v[184:187], v[224:239]
    v_exp_f32 v162, v162
    v_exp_f32 v163, v163
    v_exp_f32 v164, v164
    v_mfma_f32_32x32x16_bf16 v[176:191], v[64:67], v[152:155], 0
    v_exp_f32 v165, v165
    v_exp_f32 v166, v166
    v_exp_f32 v167, v167
    v_cvt_pk_bf16_f32 v160, v160, v161
    v_cvt_pk_bf16_f32 v161, v162, v163
    v_mfma_f32_32x32x16_bf16 v[176:191], v[68:71], v[156:159], v[176:191]
    v_cvt_pk_bf16_f32 v162, v164, v165
    v_cvt_pk_bf16_f32 v163, v166, v167
    v_exp_f32 v168, v168
    v_exp_f32 v169, v169
    v_exp_f32 v170, v170
    v_exp_f32 v171, v171
    v_mfma_f32_32x32x16_bf16 v[208:223], v[72:75], v[160:163], v[208:223]
    v_exp_f32 v172, v172
    v_exp_f32 v173, v173
    v_exp_f32 v174, v174
    v_exp_f32 v175, v175
    v_cvt_pk_bf16_f32 v168, v168, v169
    v_cvt_pk_bf16_f32 v169, v170, v171
    v_cvt_pk_bf16_f32 v170, v172, v173
    v_cvt_pk_bf16_f32 v171, v174, v175
    v_exp_f32 v176, v176
    v_exp_f32 v177, v177
    v_mfma_f32_32x32x16_bf16 v[208:223], v[76:79], v[168:171], v[208:223]
F_pgA2_3:
    s_cbranch_execz F_ret
    v_exp_f32 v178, v178
    v_exp_f32 v179, v179
    v_exp_f32 v180, v180
    s_waitcnt vmcnt(8)
    v_mfma_f32_32x32x16_bf16 v[160:175], v[80:83], v[128:131], 0
    v_exp_f32 v181, v181
    v_exp_f32 v182, v182
    v_exp_f32 v183, v183
    v_cvt_pk_bf16_f32 v176, v176, v177
    v_cvt_pk_bf16_f32 v177, v178, v179
    v_mfma_f32_32x32x16_bf16 v[160:175], v[84:87], v[132:135], v[160:175]
    v_cvt_pk_bf16_f32 v178, v180, v181
    v_cvt_pk_bf16_f32 v179, v182, v183
    v_exp_f32 v184, v184
    v_exp_f32 v185, v185
    v_exp_f32 v186, v186
    v_exp_f32 v187, v187
    v_mfma_f32_32x32x16_bf16 v[240:255], v[72:75], v[176:179], v[240:255]
    v_exp_f32 v188, v188
    v_exp_f32 v189, v189
    v_exp_f32 v190, v190
    v_exp_f32 v191, v191
    v_cvt_pk_bf16_f32 v184, v184, v185
    v_cvt_pk_bf16_f32 v185, v186, v187
    v_cvt_pk_bf16_f32 v186, v188, v189
    v_cvt_pk_bf16_f32 v187, v190, v191
    v_exp_f32 v160, v160
    v_exp_f32 v161, v161
    v_mfma_f32_32x32x16_bf16 v[240:255], v[76:79], v[184:187], v[240:255]
    v_exp_f32 v162, v162
    v_exp_f32 v163, v163
    v_exp_f32 v164, v164
    v_mfma_f32_32x32x16_bf16 v[176:191], v[80:83], v[144:147], 0
    v_exp_f32 v165, v165
    v_exp_f32 v166, v166
    v_exp_f32 v167, v167
    v_cvt_pk_bf16_f32 v160, v160, v161
    v_cvt_pk_bf16_f32 v161, v162, v163
    v_mfma_f32_32x32x16_bf16 v[176:191], v[84:87], v[148:151], v[176:191]
    v_cvt_pk_bf16_f32 v162, v164, v165
    v_cvt_pk_bf16_f32 v163, v166, v167
    v_exp_f32 v168, v168
    v_exp_f32 v169, v169
    v_exp_f32 v170, v170
    v_exp_f32 v171, v171
    v_mfma_f32_32x32x16_bf16 v[192:207], v[88:91], v[160:163], v[192:207]
    v_exp_f32 v172, v172
    v_exp_f32 v173, v173
    v_exp_f32 v174, v174
    v_exp_f32 v175, v175
    v_cvt_pk_bf16_f32 v168, v168, v169
    v_cvt_pk_bf16_f32 v169, v170, v171
    v_cvt_pk_bf16_f32 v170, v172, v173
    v_cvt_pk_bf16_f32 v171, v174, v175
    v_exp_f32 v176, v176
    v_exp_f32 v177, v177
    v_mfma_f32_32x32x16_bf16 v[192:207], v[92:95], v[168:171], v[192:207]
    v_exp_f32 v178, v178
    v_exp_f32 v179, v179
    v_exp_f32 v180, v180
    v_mfma_f32_32x32x16_bf16 v[160:175], v[80:83], v[136:139], 0
    v_exp_f32 v181, v181
    v_exp_f32 v182, v182
    v_exp_f32 v183, v183
    v_cvt_pk_bf16_f32 v176, v176, v177
    v_cvt_pk_bf16_f32 v177, v178, v179
    v_mfma_f32_32x32x16_bf16 v[160:175], v[84:87], v[140:143], v[160:175]
    v_cvt_pk_bf16_f32 v178, v180, v181
    v_cvt_pk_bf16_f32 v179, v182, v183
    v_exp_f32 v184, v184
    v_exp_f32 v185, v185
    v_exp_f32 v186, v186
    v_exp_f32 v187, v187
    v_mfma_f32_32x32x16_bf16 v[224:239], v[88:91], v[176:179], v[224:239]
    v_exp_f32 v188, v188
    v_exp_f32 v189, v189
    v_exp_f32 v190, v190
    v_exp_f32 v191, v191
    v_cvt_pk_bf16_f32 v184, v184, v185
    v_cvt_pk_bf16_f32 v185, v186, v187
    v_cvt_pk_bf16_f32 v186, v188, v189
    v_cvt_pk_bf16_f32 v187, v190, v191
    v_exp_f32 v160, v160
    v_exp_f32 v161, v161
    v_mfma_f32_32x32x16_bf16 v[224:239], v[92:95], v[184:187], v[224:239]
    v_exp_f32 v162, v162
    v_exp_f32 v163, v163
    v_exp_f32 v164, v164
    v_mfma_f32_32x32x16_bf16 v[176:191], v[80:83], v[152:155], 0
    v_exp_f32 v165, v165
    v_exp_f32 v166, v166
    v_exp_f32 v167, v167
    v_cvt_pk_bf16_f32 v160, v160, v161
    v_cvt_pk_bf16_f32 v161, v162, v163
    v_mfma_f32_32x32x16_bf16 v[176:191], v[84:87], v[156:159], v[176:191]
    v_cvt_pk_bf16_f32 v162, v164, v165
    v_cvt_pk_bf16_f32 v163, v166, v167
    v_exp_f32 v168, v168
    v_exp_f32 v169, v169
    v_exp_f32 v170, v170
    v_exp_f32 v171, v171
    v_mfma_f32_32x32x16_bf16 v[208:223], v[88:91], v[160:163], v[208:223]
    v_exp_f32 v172, v172
    v_exp_f32 v173, v173
    v_exp_f32 v174, v174
    v_exp_f32 v175, v175
    v_cvt_pk_bf16_f32 v168, v168, v169
    v_cvt_pk_bf16_f32 v169, v170, v171
    v_cvt_pk_bf16_f32 v170, v172, v173
    v_cvt_pk_bf16_f32 v171, v174, v175
    v_exp_f32 v176, v176
    v_exp_f32 v177, v177
    v_mfma_f32_32x32x16_bf16 v[208:223], v[92:95], v[168:171], v[208:223]
    v_exp_f32 v178, v178
    v_exp_f32 v179, v179
    v_exp_f32 v180, v180
    s_waitcnt vmcnt(4)
    v_mfma_f32_32x32x16_bf16 v[160:175], v[96:99], v[128:131], 0
    v_exp_f32 v181, v181
    v_exp_f32 v182, v182
    v_exp_f32 v183, v183
    v_cvt_pk_bf16_f32 v176, v176, v177
    v_cvt_pk_bf16_f32 v177, v178, v179
    v_mfma_f32_32x32x16_bf16 v[160:175], v[100:103], v[132:135], v[160:175]
    v_cvt_pk_bf16_f32 v178, v180, v181
    v_cvt_pk_bf16_f32 v179, v182, v183
    v_exp_f32 v184, v184
    v_exp_f32 v185, v185
    v_exp_f32 v186, v186
    v_exp_f32 v187, v187
    v_mfma_f32_32x32x16_bf16 v[240:255], v[88:91], v[176:179], v[240:255]
    v_exp_f32 v188, v188
    v_exp_f32 v189, v189
    v_exp_f32 v190, v190
    v_exp_f32 v191, v191
    v_cvt_pk_bf16_f32 v184, v184, v185
    v_cvt_pk_bf16_f32 v185, v186, v187
    v_cvt_pk_bf16_f32 v186, v188, v189
    v_cvt_pk_bf16_f32 v187, v190, v191
    v_exp_f32 v160, v160
    v_exp_f32 v161, v161
    v_mfma_f32_32x32x16_bf16 v[240:255], v[92:95], v[184:187], v[240:255]
    v_exp_f32 v162, v162
    v_exp_f32 v163, v163
    v_exp_f32 v164, v164
    v_mfma_f32_32x32x16_bf16 v[176:191], v[96:99], v[144:147], 0
    v_exp_f32 v165, v165
    v_exp_f32 v166, v166
    v_exp_f32 v167, v167
    v_cvt_pk_bf16_f32 v160, v160, v161
    v_cvt_pk_bf16_f32 v161, v162, v163
    v_mfma_f32_32x32x16_bf16 v[176:191], v[100:103], v[148:151], v[176:191]
    v_cvt_pk_bf16_f32 v162, v164, v165
    v_cvt_pk_bf16_f32 v163, v166, v167
    v_exp_f32 v168, v168
    v_exp_f32 v169, v169
    v_exp_f32 v170, v170
    v_exp_f32 v171, v171
    v_mfma_f32_32x32x16_bf16 v[192:207], v[104:107], v[160:163], v[192:207]
    v_exp_f32 v172, v172
    v_exp_f32 v173, v173
    v_exp_f32 v174, v174
    v_exp_f32 v175, v175
    v_cvt_pk_bf16_f32 v168, v168, v169
    v_cvt_pk_bf16_f32 v169, v170, v171
    v_cvt_pk_bf16_f32 v170, v172, v173
    v_cvt_pk_bf16_f32 v171, v174, v175
    v_exp_f32 v176, v176
    v_exp_f32 v177, v177
    v_mfma_f32_32x32x16_bf16 v[192:207], v[108:111], v[168:171], v[192:207]
    v_exp_f32 v178, v178
    v_exp_f32 v179, v179
    v_exp_f32 v180, v180
    v_mfma_f32_32x32x16_bf16 v[160:175], v[96:99], v[136:139], 0
    v_exp_f32 v181, v181
    v_exp_f32 v182, v182
    v_exp_f32 v183, v183
    v_cvt_pk_bf16_f32 v176, v176, v177
    v_cvt_pk_bf16_f32 v177, v178, v179
    v_mfma_f32_32x32x16_bf16 v[160:175], v[100:103], v[140:143], v[160:175]
    v_cvt_pk_bf16_f32 v178, v180, v181
    v_cvt_pk_bf16_f32 v179, v182, v183
    v_exp_f32 v184, v184
    v_exp_f32 v185, v185
    v_exp_f32 v186, v186
    v_exp_f32 v187, v187
    v_mfma_f32_32x32x16_bf16 v[224:239], v[104:107], v[176:179], v[224:239]
    v_exp_f32 v188, v188
    v_exp_f32 v189, v189
    v_exp_f32 v190, v190
    v_exp_f32 v191, v191
    v_cvt_pk_bf16_f32 v184, v184, v185
    v_cvt_pk_bf16_f32 v185, v186, v187
    v_cvt_pk_bf16_f32 v186, v188, v189
    v_cvt_pk_bf16_f32 v187, v190, v191
    v_exp_f32 v160, v160
    v_exp_f32 v161, v161
    v_mfma_f32_32x32x16_bf16 v[224:239], v[108:111], v[184:187], v[224:239]
F_pgA2_4:
    s_cbranch_execz F_ret
    v_exp_f32 v162, v162
    v_exp_f32 v163, v163
    v_exp_f32 v164, v164
    v_mfma_f32_32x32x16_bf16 v[176:191], v[96:99], v[152:155], 0
    v_exp_f32 v165, v165
    v_exp_f32 v166, v166
    v_exp_f32 v167, v167
    v_cvt_pk_bf16_f32 v160, v160, v161
    v_cvt_pk_bf16_f32 v161, v162, v163
    v_mfma_f32_32x32x16_bf16 v[176:191], v[100:103], v[156:159], v[176:191]
    v_cvt_pk_bf16_f32 v162, v164, v165
    v_cvt_pk_bf16_f32 v163, v166, v167
    v_exp_f32 v168, v168
    v_exp_f32 v169, v169
    v_exp_f32 v170, v170
    v_exp_f32 v171, v171
    v_mfma_f32_32x32x16_bf16 v[208:223], v[104:107], v[160:163], v[208:223]
    v_exp_f32 v172, v172
    v_exp_f32 v173, v173
    v_exp_f32 v174, v174
    v_exp_f32 v175, v175
    v_cvt_pk_bf16_f32 v168, v168, v169
    v_cvt_pk_bf16_f32 v169, v170, v171
    v_cvt_pk_bf16_f32 v170, v172, v173
    v_cvt_pk_bf16_f32 v171, v174, v175
    v_exp_f32 v176, v176
    v_exp_f32 v177, v177
    v_mfma_f32_32x32x16_bf16 v[208:223], v[108:111], v[168:171], v[208:223]
    v_exp_f32 v178, v178
    v_exp_f32 v179, v179
    v_exp_f32 v180, v180
    s_waitcnt vmcnt(0)
    v_mfma_f32_32x32x16_bf16 v[160:175], v[112:115], v[128:131], 0
    v_exp_f32 v181, v181
    v_exp_f32 v182, v182
    v_exp_f32 v183, v183
    v_cvt_pk_bf16_f32 v176, v176, v177
    v_cvt_pk_bf16_f32 v177, v178, v179
    v_mfma_f32_32x32x16_bf16 v[160:175], v[116:119], v[132:135], v[160:175]
    v_cvt_pk_bf16_f32 v178, v180, v181
    v_cvt_pk_bf16_f32 v179, v182, v183
    v_exp_f32 v184, v184
    v_exp_f32 v185, v185
    v_exp_f32 v186, v186
    v_exp_f32 v187, v187
    v_mfma_f32_32x32x16_bf16 v[240:255], v[104:107], v[176:179], v[240:255]
    v_exp_f32 v188, v188
    v_exp_f32 v189, v189
    v_exp_f32 v190, v190
    v_exp_f32 v191, v191
    v_cvt_pk_bf16_f32 v184, v184, v185
    v_cvt_pk_bf16_f32 v185, v186, v187
    v_cvt_pk_bf16_f32 v186, v188, v189
    v_cvt_pk_bf16_f32 v187, v190, v191
    v_exp_f32 v160, v160
    v_exp_f32 v161, v161
    v_mfma_f32_32x32x16_bf16 v[240:255], v[108:111], v[184:187], v[240:255]
    v_exp_f32 v162, v162
    v_exp_f32 v163, v163
    v_exp_f32 v164, v164
    v_mfma_f32_32x32x16_bf16 v[176:191], v[112:115], v[144:147], 0
    v_exp_f32 v165, v165
    v_exp_f32 v166, v166
    v_exp_f32 v167, v167
    v_cvt_pk_bf16_f32 v160, v160, v161
    v_cvt_pk_bf16_f32 v161, v162, v163
    v_mfma_f32_32x32x16_bf16 v[176:191], v[116:119], v[148:151], v[176:191]
    v_cvt_pk_bf16_f32 v162, v164, v165
    v_cvt_pk_bf16_f32 v163, v166, v167
    v_exp_f32 v168, v168
    v_exp_f32 v169, v169
    v_exp_f32 v170, v170
    v_exp_f32 v171, v171
    v_mfma_f32_32x32x16_bf16 v[192:207], v[120:123], v[160:163], v[192:207]
    v_exp_f32 v172, v172
    v_exp_f32 v173, v173
    v_exp_f32 v174, v174
    v_exp_f32 v175, v175
    v_cvt_pk_bf16_f32 v168, v168, v169
    v_cvt_pk_bf16_f32 v169, v170, v171
    v_cvt_pk_bf16_f32 v170, v172, v173
    v_cvt_pk_bf16_f32 v171, v174, v175
    v_exp_f32 v176, v176
    v_exp_f32 v177, v177
    v_mfma_f32_32x32x16_bf16 v[192:207], v[124:127], v[168:171], v[192:207]
    v_exp_f32 v178, v178
    v_exp_f32 v179, v179
    v_exp_f32 v180, v180
    v_mfma_f32_32x32x16_bf16 v[160:175], v[112:115], v[136:139], 0
    ds_read_b32 v10, v9 offset:0
    v_exp_f32 v181, v181
    v_exp_f32 v182, v182
    v_exp_f32 v183, v183
    v_cvt_pk_bf16_f32 v176, v176, v177
    v_cvt_pk_bf16_f32 v177, v178, v179
    v_mfma_f32_32x32x16_bf16 v[160:175], v[116:119], v[140:143], v[160:175]
    v_cvt_pk_bf16_f32 v178, v180, v181
    v_cvt_pk_bf16_f32 v179, v182, v183
    v_exp_f32 v184, v184
    v_exp_f32 v185, v185
    v_exp_f32 v186, v186
    v_exp_f32 v187, v187
    v_mfma_f32_32x32x16_bf16 v[224:239], v[120:123], v[176:179], v[224:239]
    s_waitcnt lgkmcnt(0)
    v_cmp_gt_u32 vcc, 2, v10
    s_cbranch_vccnz F_fs3
F_fs3_ok:
    v_exp_f32 v188, v188
    v_exp_f32 v189, v189
    v_exp_f32 v190, v190
    v_exp_f32 v191, v191
    v_cvt_pk_bf16_f32 v184, v184, v185
    v_cvt_pk_bf16_f32 v185, v186, v187
    v_cvt_pk_bf16_f32 v186, v188, v189
    v_cvt_pk_bf16_f32 v187, v190, v191
    v_exp_f32 v160, v160
    v_exp_f32 v161, v161
    v_mfma_f32_32x32x16_bf16 v[224:239], v[124:127], v[184:187], v[224:239]
    ds_read_b128 v[16:19], v1 offset:49152
    v_exp_f32 v162, v162
    v_exp_f32 v163, v163
    v_exp_f32 v164, v164
    v_mfma_f32_32x32x16_bf16 v[176:191], v[112:115], v[152:155], 0
    ds_read_b128 v[20:23], v1 offset:50176
    v_exp_f32 v165, v165
    v_exp_f32 v166, v166
    v_exp_f32 v167, v167
    v_cvt_pk_bf16_f32 v160, v160, v161
    v_cvt_pk_bf16_f32 v161, v162, v163
    v_mfma_f32_32x32x16_bf16 v[176:191], v[116:119], v[156:159], v[176:191]
    ds_read_b128 v[24:27], v1 offset:57344
    v_cvt_pk_bf16_f32 v162, v164, v165
    v_cvt_pk_bf16_f32 v163, v166, v167
    v_exp_f32 v168, v168
    v_exp_f32 v169, v169
    v_exp_f32 v170, v170
    v_exp_f32 v171, v171
    v_mfma_f32_32x32x16_bf16 v[208:223], v[120:123], v[160:163], v[208:223]
F_pgA2_5:
    s_cbranch_execz F_ret
    ds_read_b128 v[28:31], v1 offset:58368
    v_exp_f32 v172, v172
    v_exp_f32 v173, v173
    v_exp_f32 v174, v174
    v_exp_f32 v175, v175
    v_cvt_pk_bf16_f32 v168, v168, v169
    v_cvt_pk_bf16_f32 v169, v170, v171
    v_cvt_pk_bf16_f32 v170, v172, v173
    v_cvt_pk_bf16_f32 v171, v174, v175
    v_exp_f32 v176, v176
    v_exp_f32 v177, v177
    v_mfma_f32_32x32x16_bf16 v[208:223], v[124:127], v[168:171], v[208:223]
    ds_read_b128 v[32:35], v11 offset:0
    v_exp_f32 v178, v178
    v_exp_f32 v179, v179
    v_exp_f32 v180, v180
    s_waitcnt lgkmcnt(1)
    v_mfma_f32_32x32x16_bf16 v[160:175], v[16:19], v[128:131], 0
    ds_read_b128 v[36:39], v11 offset:1024
    v_exp_f32 v181, v181
    v_exp_f32 v182, v182
    v_exp_f32 v183, v183
    v_cvt_pk_bf16_f32 v176, v176, v177
    v_cvt_pk_bf16_f32 v177, v178, v179
    v_mfma_f32_32x32x16_bf16 v[160:175], v[20:23], v[132:135], v[160:175]
    ds_read_b128 v[40:43], v11 offset:8192
    v_cvt_pk_bf16_f32 v178, v180, v181
    v_cvt_pk_bf16_f32 v179, v182, v183
    v_exp_f32 v184, v184
    v_exp_f32 v185, v185
    v_exp_f32 v186, v186
    v_exp_f32 v187, v187
    v_mfma_f32_32x32x16_bf16 v[240:255], v[120:123], v[176:179], v[240:255]
    ds_read_b128 v[44:47], v11 offset:9216
    v_exp_f32 v188, v188
    v_exp_f32 v189, v189
    v_exp_f32 v190, v190
    v_exp_f32 v191, v191
    v_cvt_pk_bf16_f32 v184, v184, v185
    v_cvt_pk_bf16_f32 v185, v186, v187
    v_cvt_pk_bf16_f32 v186, v188, v189
    v_cvt_pk_bf16_f32 v187, v190, v191
    v_exp_f32 v160, v160
    v_exp_f32 v161, v161
    v_mfma_f32_32x32x16_bf16 v[240:255], v[124:127], v[184:187], v[240:255]
    ds_read_b128 v[48:51], v11 offset:16384
    v_exp_f32 v162, v162
    v_exp_f32 v163, v163
    v_exp_f32 v164, v164
    v_mfma_f32_32x32x16_bf16 v[176:191], v[16:19], v[144:147], 0
    ds_read_b128 v[52:55], v11 offset:17408
    v_exp_f32 v165, v165
    v_exp_f32 v166, v166
    v_exp_f32 v167, v167
    v_cvt_pk_bf16_f32 v160, v160, v161
    v_cvt_pk_bf16_f32 v161, v162, v163
    v_mfma_f32_32x32x16_bf16 v[176:191], v[20:23], v[148:151], v[176:191]
    ds_read_b128 v[56:59], v11 offset:24576
    v_cvt_pk_bf16_f32 v162, v164, v165
    v_cvt_pk_bf16_f32 v163, v166, v167
    v_exp_f32 v168, v168
    v_exp_f32 v169, v169
    v_exp_f32 v170, v170
    v_exp_f32 v171, v171
    v_mfma_f32_32x32x16_bf16 v[192:207], v[24:27], v[160:163], v[192:207]
    ds_read_b128 v[60:63], v11 offset:25600
    ds_add_u32 v8, v7
    v_exp_f32 v172, v172
    v_exp_f32 v173, v173
    v_exp_f32 v174, v174
    v_exp_f32 v175, v175
    v_cvt_pk_bf16_f32 v168, v168, v169
    v_cvt_pk_bf16_f32 v169, v170, v171
    v_cvt_pk_bf16_f32 v170, v172, v173
    v_cvt_pk_bf16_f32 v171, v174, v175
    v_exp_f32 v176, v176
    v_exp_f32 v177, v177
    v_mfma_f32_32x32x16_bf16 v[192:207], v[28:31], v[168:171], v[192:207]
    ds_read_b128 v[64:67], v1 offset:0
    v_exp_f32 v178, v178
    v_exp_f32 v179, v179
    v_exp_f32 v180, v180
    v_mfma_f32_32x32x16_bf16 v[160:175], v[16:19], v[136:139], 0
    ds_read_b128 v[68:71], v1 offset:1024
    v_exp_f32 v181, v181
    v_exp_f32 v182, v182
    v_exp_f32 v183, v183
    v_cvt_pk_bf16_f32 v176, v176, v177
    v_cvt_pk_bf16_f32 v177, v178, v179
    v_mfma_f32_32x32x16_bf16 v[160:175], v[20:23], v[140:143], v[160:175]
    ds_read_b128 v[72:75], v1 offset:8192
    v_cvt_pk_bf16_f32 v178, v180, v181
    v_cvt_pk_bf16_f32 v179, v182, v183
    v_exp_f32 v184, v184
    v_exp_f32 v185, v185
    v_exp_f32 v186, v186
    v_exp_f32 v187, v187
    v_mfma_f32_32x32x16_bf16 v[224:239], v[24:27], v[176:179], v[224:239]
    ds_read_b128 v[76:79], v1 offset:9216
    v_exp_f32 v188, v188
    v_exp_f32 v189, v189
    v_exp_f32 v190, v190
    v_exp_f32 v191, v191
    v_cvt_pk_bf16_f32 v184, v184, v185
    v_cvt_pk_bf16_f32 v185, v186, v187
    v_cvt_pk_bf16_f32 v186, v188, v189
    v_cvt_pk_bf16_f32 v187, v190, v191
    v_exp_f32 v160, v160
    v_exp_f32 v161, v161
    v_mfma_f32_32x32x16_bf16 v[224:239], v[28:31], v[184:187], v[224:239]
    ds_read_b128 v[80:83], v1 offset:16384
    v_exp_f32 v162, v162
    v_exp_f32 v163, v163
    v_exp_f32 v164, v164
    v_mfma_f32_32x32x16_bf16 v[176:191], v[16:19], v[152:155], 0
    ds_read_b128 v[84:87], v1 offset:17408
    v_exp_f32 v165, v165
    v_exp_f32 v166, v166
    v_exp_f32 v167, v167
    v_cvt_pk_bf16_f32 v160, v160, v161
    v_cvt_pk_bf16_f32 v161, v162, v163
    v_mfma_f32_32x32x16_bf16 v[176:191], v[20:23], v[156:159], v[176:191]
    ds_read_b128 v[88:91], v1 offset:24576
    v_cvt_pk_bf16_f32 v162, v164, v165
    v_cvt_pk_bf16_f32 v163, v166, v167
    v_exp_f32 v168, v168
    v_exp_f32 v169, v169
    v_exp_f32 v170, v170
    v_exp_f32 v171, v171
    v_mfma_f32_32x32x16_bf16 v[208:223], v[24:27], v[160:163], v[208:223]
    ds_read_b128 v[92:95], v1 offset:25600
    v_exp_f32 v172, v172
    v_exp_f32 v173, v173
    v_exp_f32 v174, v174
    v_exp_f32 v175, v175
    v_cvt_pk_bf16_f32 v168, v168, v169
    v_cvt_pk_bf16_f32 v169, v170, v171
    v_cvt_pk_bf16_f32 v170, v172, v173
    v_cvt_pk_bf16_f32 v171, v174, v175
    v_exp_f32 v176, v176
    v_exp_f32 v177, v177
    v_mfma_f32_32x32x16_bf16 v[208:223], v[28:31], v[168:171], v[208:223]
    ds_read_b128 v[96:99], v1 offset:32768
    v_exp_f32 v178, v178
    v_exp_f32 v179, v179
    v_exp_f32 v180, v180
    s_waitcnt lgkmcnt(14)
    v_mfma_f32_32x32x16_bf16 v[160:175], v[32:35], v[128:131], 0
    ds_read_b128 v[100:103], v1 offset:33792
    v_exp_f32 v181, v181
    v_exp_f32 v182, v182
    v_exp_f32 v183, v183
    v_cvt_pk_bf16_f32 v176, v176, v177
    v_cvt_pk_bf16_f32 v177, v178, v179
    v_mfma_f32_32x32x16_bf16 v[160:175], v[36:39], v[132:135], v[160:175]
    ds_read_b128 v[104:107], v1 offset:40960
    v_cvt_pk_bf16_f32 v178, v180, v181
    v_cvt_pk_bf16_f32 v179, v182, v183
    v_exp_f32 v184, v184
    v_exp_f32 v185, v185
    v_exp_f32 v186, v186
    v_exp_f32 v187, v187
    v_mfma_f32_32x32x16_bf16 v[240:255], v[24:27], v[176:179], v[240:255]
    ds_read_b128 v[108:111], v1 offset:41984
    ds_add_u32 v8, v7
    v_exp_f32 v188, v188
    v_exp_f32 v189, v189
    v_exp_f32 v190, v190
    v_exp_f32 v191, v191
    v_cvt_pk_bf16_f32 v184, v184, v185
    v_cvt_pk_bf16_f32 v185, v186, v187
    v_cvt_pk_bf16_f32 v186, v188, v189
    v_cvt_pk_bf16_f32 v187, v190, v191
    v_exp_f32 v160, v160
    v_exp_f32 v161, v161
    v_mfma_f32_32x32x16_bf16 v[240:255], v[28:31], v[184:187], v[240:255]
    v_exp_f32 v162, v162
    v_exp_f32 v163, v163
    v_exp_f32 v164, v164
    v_mfma_f32_32x32x16_bf16 v[176:191], v[32:35], v[144:147], 0
F_pgA2_6:
    s_cbranch_execz F_ret
    v_exp_f32 v165, v165
    v_exp_f32 v166, v166
    v_exp_f32 v167, v167
    v_cvt_pk_bf16_f32 v160, v160, v161
    v_cvt_pk_bf16_f32 v161, v162, v163
    v_mfma_f32_32x32x16_bf16 v[176:191], v[36:39], v[148:151], v[176:191]
    v_cvt_pk_bf16_f32 v162, v164, v165
    v_cvt_pk_bf16_f32 v163, v166, v167
    v_exp_f32 v168, v168
    v_exp_f32 v169, v169
    v_exp_f32 v170, v170
    v_exp_f32 v171, v171
    v_mfma_f32_32x32x16_bf16 v[192:207], v[40:43], v[160:163], v[192:207]
    v_exp_f32 v172, v172
    v_exp_f32 v173, v173
    v_exp_f32 v174, v174
    v_exp_f32 v175, v175
    v_cvt_pk_bf16_f32 v168, v168, v169
    v_cvt_pk_bf16_f32 v169, v170, v171
    v_cvt_pk_bf16_f32 v170, v172, v173
    v_cvt_pk_bf16_f32 v171, v174, v175
    v_exp_f32 v176, v176
    v_exp_f32 v177, v177
    v_mfma_f32_32x32x16_bf16 v[192:207], v[44:47], v[168:171], v[192:207]
    v_exp_f32 v178, v178
    v_exp_f32 v179, v179
    v_exp_f32 v180, v180
    v_mfma_f32_32x32x16_bf16 v[160:175], v[32:35], v[136:139], 0
    v_exp_f32 v181, v181
    v_exp_f32 v182, v182
    v_exp_f32 v183, v183
    v_cvt_pk_bf16_f32 v176, v176, v177
    v_cvt_pk_bf16_f32 v177, v178, v179
    v_mfma_f32_32x32x16_bf16 v[160:175], v[36:39], v[140:143], v[160:175]
    v_cvt_pk_bf16_f32 v178, v180, v181
    v_cvt_pk_bf16_f32 v179, v182, v183
    v_exp_f32 v184, v184
    v_exp_f32 v185, v185
    v_exp_f32 v186, v186
    v_exp_f32 v187, v187
    v_mfma_f32_32x32x16_bf16 v[224:239], v[40:43], v[176:179], v[224:239]
    v_exp_f32 v188, v188
    v_exp_f32 v189, v189
    v_exp_f32 v190, v190
    v_exp_f32 v191, v191
    v_cvt_pk_bf16_f32 v184, v184, v185
    v_cvt_pk_bf16_f32 v185, v186, v187
    v_cvt_pk_bf16_f32 v186, v188, v189
    v_cvt_pk_bf16_f32 v187, v190, v191
    v_exp_f32 v160, v160
    v_exp_f32 v161, v161
    v_mfma_f32_32x32x16_bf16 v[224:239], v[44:47], v[184:187], v[224:239]
    v_exp_f32 v162, v162
    v_exp_f32 v163, v163
    v_exp_f32 v164, v164
    v_mfma_f32_32x32x16_bf16 v[176:191], v[32:35], v[152:155], 0
    v_exp_f32 v165, v165
    v_exp_f32 v166, v166
    v_exp_f32 v167, v167
    v_cvt_pk_bf16_f32 v160, v160, v161
    v_cvt_pk_bf16_f32 v161, v162, v163
    v_mfma_f32_32x32x16_bf16 v[176:191], v[36:39], v[156:159], v[176:191]
    v_cvt_pk_bf16_f32 v162, v164, v165
    v_cvt_pk_bf16_f32 v163, v166, v167
    v_exp_f32 v168, v168
    v_exp_f32 v169, v169
    v_exp_f32 v170, v170
    v_exp_f32 v171, v171
    v_mfma_f32_32x32x16_bf16 v[208:223], v[40:43], v[160:163], v[208:223]
    v_exp_f32 v172, v172
    v_exp_f32 v173, v173
    v_exp_f32 v174, v174
    v_exp_f32 v175, v175
    v_cvt_pk_bf16_f32 v168, v168, v169
    v_cvt_pk_bf16_f32 v169, v170, v171
    v_cvt_pk_bf16_f32 v170, v172, v173
    v_cvt_pk_bf16_f32 v171, v174, v175
    v_exp_f32 v176, v176
    v_exp_f32 v177, v177
    v_mfma_f32_32x32x16_bf16 v[208:223], v[44:47], v[168:171], v[208:223]
    v_exp_f32 v178, v178
    v_exp_f32 v179, v179
    v_exp_f32 v180, v180
    s_waitcnt lgkmcnt(14)
    v_mfma_f32_32x32x16_bf16 v[160:175], v[48:51], v[128:131], 0
    v_exp_f32 v181, v181
    v_exp_f32 v182, v182
    v_exp_f32 v183, v183
    v_cvt_pk_bf16_f32 v176, v176, v177
    v_cvt_pk_bf16_f32 v177, v178, v179
    v_mfma_f32_32x32x16_bf16 v[160:175], v[52:55], v[132:135], v[160:175]
    v_cvt_pk_bf16_f32 v178, v180, v181
    v_cvt_pk_bf16_f32 v179, v182, v183
    v_exp_f32 v184, v184
    v_exp_f32 v185, v185
    v_exp_f32 v186, v186
    v_exp_f32 v187, v187
    v_mfma_f32_32x32x16_bf16 v[240:255], v[40:43], v[176:179], v[240:255]
    v_exp_f32 v188, v188
    v_exp_f32 v189, v189
    v_exp_f32 v190, v190
    v_exp_f32 v191, v191
    v_cvt_pk_bf16_f32 v184, v184, v185
    v_cvt_pk_bf16_f32 v185, v186, v187
    v_cvt_pk_bf16_f32 v186, v188, v189
    v_cvt_pk_bf16_f32 v187, v190, v191
    v_exp_f32 v160, v160
    v_exp_f32 v161, v161
    v_mfma_f32_32x32x16_bf16 v[240:255], v[44:47], v[184:187], v[240:255]
    v_exp_f32 v162, v162
    v_exp_f32 v163, v163
    v_exp_f32 v164, v164
    v_mfma_f32_32x32x16_bf16 v[176:191], v[48:51], v[144:147], 0
    v_exp_f32 v165, v165
    v_exp_f32 v166, v166
    v_exp_f32 v167, v167
    v_cvt_pk_bf16_f32 v160, v160, v161
    v_cvt_pk_bf16_f32 v161, v162, v163
    v_mfma_f32_32x32x16_bf16 v[176:191], v[52:55], v[148:151], v[176:191]
    v_cvt_pk_bf16_f32 v162, v164, v165
    v_cvt_pk_bf16_f32 v163, v166, v167
    v_exp_f32 v168, v168
    v_exp_f32 v169, v169
    v_exp_f32 v170, v170
    v_exp_f32 v171, v171
    v_mfma_f32_32x32x16_bf16 v[192:207], v[56:59], v[160:163], v[192:207]
    v_exp_f32 v172, v172
    v_exp_f32 v173, v173
    v_exp_f32 v174, v174
    v_exp_f32 v175, v175
    v_cvt_pk_bf16_f32 v168, v168, v169
    v_cvt_pk_bf16_f32 v169, v170, v171
    v_cvt_pk_bf16_f32 v170, v172, v173
    v_cvt_pk_bf16_f32 v171, v174, v175
    v_exp_f32 v176, v176
    v_exp_f32 v177, v177
    v_mfma_f32_32x32x16_bf16 v[192:207], v[60:63], v[168:171], v[192:207]
    v_exp_f32 v178, v178
    v_exp_f32 v179, v179
    v_exp_f32 v180, v180
    v_mfma_f32_32x32x16_bf16 v[160:175], v[48:51], v[136:139], 0
    v_exp_f32 v181, v181
    v_exp_f32 v182, v182
    v_exp_f32 v183, v183
    v_cvt_pk_bf16_f32 v176, v176, v177
    v_cvt_pk_bf16_f32 v177, v178, v179
    v_mfma_f32_32x32x16_bf16 v[160:175], v[52:55], v[140:143], v[160:175]
    v_cvt_pk_bf16_f32 v178, v180, v181
    v_cvt_pk_bf16_f32 v179, v182, v183
    v_exp_f32 v184, v184
    v_exp_f32 v185, v185
    v_exp_f32 v186, v186
    v_exp_f32 v187, v187
    v_mfma_f32_32x32x16_bf16 v[224:239], v[56:59], v[176:179], v[224:239]
    v_exp_f32 v188, v188
    v_exp_f32 v189, v189
    v_exp_f32 v190, v190
    v_exp_f32 v191, v191
    v_cvt_pk_bf16_f32 v184, v184, v185
    v_cvt_pk_bf16_f32 v185, v186, v187
    v_cvt_pk_bf16_f32 v186, v188, v189
    v_cvt_pk_bf16_f32 v187, v190, v191
    v_exp_f32 v160, v160
    v_exp_f32 v161, v161
    v_mfma_f32_32x32x16_bf16 v[224:239], v[60:63], v[184:187], v[224:239]
    v_exp_f32 v162, v162
    v_exp_f32 v163, v163
    v_exp_f32 v164, v164
    v_mfma_f32_32x32x16_bf16 v[176:191], v[48:51], v[152:155], 0
    v_exp_f32 v165, v165
    v_exp_f32 v166, v166
    v_exp_f32 v167, v167
    v_cvt_pk_bf16_f32 v160, v160, v161
    v_cvt_pk_bf16_f32 v161, v162, v163
    v_mfma_f32_32x32x16_bf16 v[176:191], v[52:55], v[156:159], v[176:191]
    v_cvt_pk_bf16_f32 v162, v164, v165
    v_cvt_pk_bf16_f32 v163, v166, v167
    v_exp_f32 v168, v168
    v_exp_f32 v169, v169
    v_exp_f32 v170, v170
    v_exp_f32 v171, v171
    v_mfma_f32_32x32x16_bf16 v[208:223], v[56:59], v[160:163], v[208:223]
    v_exp_f32 v172, v172
    v_exp_f32 v173, v173
    v_exp_f32 v174, v174
    v_exp_f32 v175, v175
    v_cvt_pk_bf16_f32 v168, v168, v169
    v_cvt_pk_bf16_f32 v169, v170, v171
    v_cvt_pk_bf16_f32 v170, v172, v173
    v_cvt_pk_bf16_f32 v171, v174, v175
    v_exp_f32 v176, v176
    v_exp_f32 v177, v177
    v_mfma_f32_32x32x16_bf16 v[208:223], v[60:63], v[168:171], v[208:223]
F_pgA2_7:
    s_cbranch_execz F_ret
    v_exp_f32 v178, v178
    v_exp_f32 v179, v179
    v_exp_f32 v180, v180
    s_waitcnt lgkmcnt(9)
    v_mfma_f32_32x32x16_bf16 v[160:175], v[64:67], v[128:131], 0
    v_exp_f32 v181, v181
    v_exp_f32 v182, v182
    v_exp_f32 v183, v183
    v_cvt_pk_bf16_f32 v176, v176, v177
    v_cvt_pk_bf16_f32 v177, v178, v179
    v_mfma_f32_32x32x16_bf16 v[160:175], v[68:71], v[132:135], v[160:175]
    v_cvt_pk_bf16_f32 v178, v180, v181
    v_cvt_pk_bf16_f32 v179, v182, v183
    v_exp_f32 v184, v184
    v_exp_f32 v185, v185
    v_exp_f32 v186, v186
    v_exp_f32 v187, v187
    v_mfma_f32_32x32x16_bf16 v[240:255], v[56:59], v[176:179], v[240:255]
    v_exp_f32 v188, v188
    v_exp_f32 v189, v189
    v_exp_f32 v190, v190
    v_exp_f32 v191, v191
    v_cvt_pk_bf16_f32 v184, v184, v185
    v_cvt_pk_bf16_f32 v185, v186, v187
    v_cvt_pk_bf16_f32 v186, v188, v189
    v_cvt_pk_bf16_f32 v187, v190, v191
    v_exp_f32 v160, v160
    v_exp_f32 v161, v161
    v_mfma_f32_32x32x16_bf16 v[240:255], v[60:63], v[184:187], v[240:255]
    v_exp_f32 v162, v162
    v_exp_f32 v163, v163
    v_exp_f32 v164, v164
    v_mfma_f32_32x32x16_bf16 v[176:191], v[64:67], v[144:147], 0
    v_exp_f32 v165, v165
    v_exp_f32 v166, v166
    v_exp_f32 v167, v167
    v_cvt_pk_bf16_f32 v160, v160, v161
    v_cvt_pk_bf16_f32 v161, v162, v163
    v_mfma_f32_32x32x16_bf16 v[176:191], v[68:71], v[148:151], v[176:191]
    v_cvt_pk_bf16_f32 v162, v164, v165
    v_cvt_pk_bf16_f32 v163, v166, v167
    v_exp_f32 v168, v168
    v_exp_f32 v169, v169
    v_exp_f32 v170, v170
    v_exp_f32 v171, v171
    v_mfma_f32_32x32x16_bf16 v[192:207], v[72:75], v[160:163], v[192:207]
    v_exp_f32 v172, v172
    v_exp_f32 v173, v173
    v_exp_f32 v174, v174
    v_exp_f32 v175, v175
    v_cvt_pk_bf16_f32 v168, v168, v169
    v_cvt_pk_bf16_f32 v169, v170, v171
    v_cvt_pk_bf16_f32 v170, v172, v173
    v_cvt_pk_bf16_f32 v171, v174, v175
    v_exp_f32 v176, v176
    v_exp_f32 v177, v177
    v_mfma_f32_32x32x16_bf16 v[192:207], v[76:79], v[168:171], v[192:207]
    v_exp_f32 v178, v178
    v_exp_f32 v179, v179
    v_exp_f32 v180, v180
    s_waitcnt lgkmcnt(5)
    v_mfma_f32_32x32x16_bf16 v[160:175], v[80:83], v[128:131], 0
    v_exp_f32 v181, v181
    v_exp_f32 v182, v182
    v_exp_f32 v183, v183
    v_cvt_pk_bf16_f32 v176, v176, v177
    v_cvt_pk_bf16_f32 v177, v178, v179
    v_mfma_f32_32x32x16_bf16 v[160:175], v[84:87], v[132:135], v[160:175]
    v_cvt_pk_bf16_f32 v178, v180, v181
    v_cvt_pk_bf16_f32 v179, v182, v183
    v_exp_f32 v184, v184
    v_exp_f32 v185, v185
    v_exp_f32 v186, v186
    v_exp_f32 v187, v187
    v_mfma_f32_32x32x16_bf16 v[224:239], v[72:75], v[176:179], v[224:239]
    v_exp_f32 v188, v188
    v_exp_f32 v189, v189
    v_exp_f32 v190, v190
    v_exp_f32 v191, v191
    v_cvt_pk_bf16_f32 v184, v184, v185
    v_cvt_pk_bf16_f32 v185, v186, v187
    v_cvt_pk_bf16_f32 v186, v188, v189
    v_cvt_pk_bf16_f32 v187, v190, v191
    v_exp_f32 v160, v160
    v_exp_f32 v161, v161
    v_mfma_f32_32x32x16_bf16 v[224:239], v[76:79], v[184:187], v[224:239]
    v_exp_f32 v162, v162
    v_exp_f32 v163, v163
    v_exp_f32 v164, v164
    v_mfma_f32_32x32x16_bf16 v[176:191], v[80:83], v[144:147], 0
    v_exp_f32 v165, v165
    v_exp_f32 v166, v166
    v_exp_f32 v167, v167
    v_cvt_pk_bf16_f32 v160, v160, v161
    v_cvt_pk_bf16_f32 v161, v162, v163
    v_mfma_f32_32x32x16_bf16 v[176:191], v[84:87], v[148:151], v[176:191]
    v_cvt_pk_bf16_f32 v162, v164, v165
    v_cvt_pk_bf16_f32 v163, v166, v167
    v_exp_f32 v168, v168
    v_exp_f32 v169, v169
    v_exp_f32 v170, v170
    v_exp_f32 v171, v171
    v_mfma_f32_32x32x16_bf16 v[192:207], v[88:91], v[160:163], v[192:207]
    v_exp_f32 v172, v172
    v_exp_f32 v173, v173
    v_exp_f32 v174, v174
    v_exp_f32 v175, v175
    v_cvt_pk_bf16_f32 v168, v168, v169
    v_cvt_pk_bf16_f32 v169, v170, v171
    v_cvt_pk_bf16_f32 v170, v172, v173
    v_cvt_pk_bf16_f32 v171, v174, v175
    v_exp_f32 v176, v176
    v_exp_f32 v177, v177
    v_mfma_f32_32x32x16_bf16 v[192:207], v[92:95], v[168:171], v[192:207]
    v_exp_f32 v178, v178
    v_exp_f32 v179, v179
    v_exp_f32 v180, v180
    s_waitcnt lgkmcnt(1)
    v_mfma_f32_32x32x16_bf16 v[160:175], v[96:99], v[128:131], 0
    ds_read_b32 v10, v9 offset:0
    v_exp_f32 v181, v181
    v_exp_f32 v182, v182
    v_exp_f32 v183, v183
    v_cvt_pk_bf16_f32 v176, v176, v177
    v_cvt_pk_bf16_f32 v177, v178, v179
    v_mfma_f32_32x32x16_bf16 v[160:175], v[100:103], v[132:135], v[160:175]
    v_cvt_pk_bf16_f32 v178, v180, v181
    v_cvt_pk_bf16_f32 v179, v182, v183
    v_exp_f32 v184, v184
    v_exp_f32 v185, v185
    v_exp_f32 v186, v186
    v_exp_f32 v187, v187
    v_mfma_f32_32x32x16_bf16 v[224:239], v[88:91], v[176:179], v[224:239]
    s_waitcnt lgkmcnt(0)
    v_cmp_gt_u32 vcc, 3, v10
    s_cbranch_vccnz F_fs4
F_fs4_ok:
    v_exp_f32 v188, v188
    v_exp_f32 v189, v189
    v_exp_f32 v190, v190
    v_exp_f32 v191, v191
    v_cvt_pk_bf16_f32 v184, v184, v185
    v_cvt_pk_bf16_f32 v185, v186, v187
    v_cvt_pk_bf16_f32 v186, v188, v189
    v_cvt_pk_bf16_f32 v187, v190, v191
    v_exp_f32 v160, v160
    v_exp_f32 v161, v161
    v_mfma_f32_32x32x16_bf16 v[224:239], v[92:95], v[184:187], v[224:239]
    ds_read_b128 v[112:115], v1 offset:49152
    v_exp_f32 v162, v162
    v_exp_f32 v163, v163
    v_exp_f32 v164, v164
    v_mfma_f32_32x32x16_bf16 v[176:191], v[96:99], v[144:147], 0
    ds_read_b128 v[116:119], v1 offset:50176
    v_exp_f32 v165, v165
    v_exp_f32 v166, v166
    v_exp_f32 v167, v167
    v_cvt_pk_bf16_f32 v160, v160, v161
    v_cvt_pk_bf16_f32 v161, v162, v163
    v_mfma_f32_32x32x16_bf16 v[176:191], v[100:103], v[148:151], v[176:191]
    ds_read_b128 v[120:123], v1 offset:57344
    v_cvt_pk_bf16_f32 v162, v164, v165
    v_cvt_pk_bf16_f32 v163, v166, v167
    v_exp_f32 v168, v168
    v_exp_f32 v169, v169
    v_exp_f32 v170, v170
    v_exp_f32 v171, v171
    v_mfma_f32_32x32x16_bf16 v[192:207], v[104:107], v[160:163], v[192:207]
    ds_read_b128 v[124:127], v1 offset:58368
    ds_add_u32 v8, v7
    v_exp_f32 v172, v172
    v_exp_f32 v173, v173
    v_exp_f32 v174, v174
    v_exp_f32 v175, v175
    v_cvt_pk_bf16_f32 v168, v168, v169
    v_cvt_pk_bf16_f32 v169, v170, v171
    v_cvt_pk_bf16_f32 v170, v172, v173
    v_cvt_pk_bf16_f32 v171, v174, v175
    v_exp_f32 v176, v176
    v_exp_f32 v177, v177
    v_mfma_f32_32x32x16_bf16 v[192:207], v[108:111], v[168:171], v[192:207]
    ds_read_b128 v[16:19], v11 offset:0
    v_exp_f32 v178, v178
    v_exp_f32 v179, v179
    v_exp_f32 v180, v180
    s_waitcnt lgkmcnt(2)
    v_mfma_f32_32x32x16_bf16 v[160:175], v[112:115], v[128:131], 0
F_pgA2_8:
    s_cbranch_execz F_ret
    ds_read_b128 v[20:23], v11 offset:1024
    v_exp_f32 v181, v181
    v_exp_f32 v182, v182
    v_exp_f32 v183, v183
    v_cvt_pk_bf16_f32 v176, v176, v177
    v_cvt_pk_bf16_f32 v177, v178, v179
    v_mfma_f32_32x32x16_bf16 v[160:175], v[116:119], v[132:135], v[160:175]
    ds_read_b128 v[24:27], v11 offset:8192
    v_cvt_pk_bf16_f32 v178, v180, v181
    v_cvt_pk_bf16_f32 v179, v182, v183
    v_exp_f32 v184, v184
    v_exp_f32 v185, v185
    v_exp_f32 v186, v186
    v_exp_f32 v187, v187
    v_mfma_f32_32x32x16_bf16 v[224:239], v[104:107], v[176:179], v[224:239]
    ds_read_b128 v[28:31], v11 offset:9216
    v_exp_f32 v188, v188
    v_exp_f32 v189, v189
    v_exp_f32 v190, v190
    v_exp_f32 v191, v191
    v_cvt_pk_bf16_f32 v184, v184, v185
    v_cvt_pk_bf16_f32 v185, v186, v187
    v_cvt_pk_bf16_f32 v186, v188, v189
    v_cvt_pk_bf16_f32 v187, v190, v191
    v_exp_f32 v160, v160
    v_exp_f32 v161, v161
    v_mfma_f32_32x32x16_bf16 v[224:239], v[108:111], v[184:187], v[224:239]
    ds_read_b128 v[32:35], v11 offset:16384
    v_exp_f32 v162, v162
    v_exp_f32 v163, v163
    v_exp_f32 v164, v164
    v_mfma_f32_32x32x16_bf16 v[176:191], v[112:115], v[144:147], 0
    ds_read_b128 v[36:39], v11 offset:17408
    v_exp_f32 v165, v165
    v_exp_f32 v166, v166
    v_exp_f32 v167, v167
    v_cvt_pk_bf16_f32 v160, v160, v161
    v_cvt_pk_bf16_f32 v161, v162, v163
    v_mfma_f32_32x32x16_bf16 v[176:191], v[116:119], v[148:151], v[176:191]
    ds_read_b128 v[40:43], v11 offset:24576
    v_cvt_pk_bf16_f32 v162, v164, v165
    v_cvt_pk_bf16_f32 v163, v166, v167
    v_exp_f32 v168, v168
    v_exp_f32 v169, v169
    v_exp_f32 v170, v170
    v_exp_f32 v171, v171
    v_mfma_f32_32x32x16_bf16 v[192:207], v[120:123], v[160:163], v[192:207]
    ds_read_b128 v[44:47], v11 offset:25600
    v_exp_f32 v172, v172
    v_exp_f32 v173, v173
    v_exp_f32 v174, v174
    v_exp_f32 v175, v175
    v_cvt_pk_bf16_f32 v168, v168, v169
    v_cvt_pk_bf16_f32 v169, v170, v171
    v_cvt_pk_bf16_f32 v170, v172, v173
    v_cvt_pk_bf16_f32 v171, v174, v175
    v_exp_f32 v176, v176
    v_exp_f32 v177, v177
    v_mfma_f32_32x32x16_bf16 v[192:207], v[124:127], v[168:171], v[192:207]
    v_exp_f32 v178, v178
    v_exp_f32 v179, v179
    v_exp_f32 v180, v180
    s_waitcnt lgkmcnt(4)
    v_mfma_f32_32x32x16_bf16 v[160:175], v[16:19], v[128:131], 0
    v_exp_f32 v181, v181
    v_exp_f32 v182, v182
    v_exp_f32 v183, v183
    v_cvt_pk_bf16_f32 v176, v176, v177
    v_cvt_pk_bf16_f32 v177, v178, v179
    v_mfma_f32_32x32x16_bf16 v[160:175], v[20:23], v[132:135], v[160:175]
    v_cvt_pk_bf16_f32 v178, v180, v181
    v_cvt_pk_bf16_f32 v179, v182, v183
    v_exp_f32 v184, v184
    v_exp_f32 v185, v185
    v_exp_f32 v186, v186
    v_exp_f32 v187, v187
    v_mfma_f32_32x32x16_bf16 v[224:239], v[120:123], v[176:179], v[224:239]
    v_exp_f32 v188, v188
    v_exp_f32 v189, v189
    v_exp_f32 v190, v190
    v_exp_f32 v191, v191
    v_cvt_pk_bf16_f32 v184, v184, v185
    v_cvt_pk_bf16_f32 v185, v186, v187
    v_cvt_pk_bf16_f32 v186, v188, v189
    v_cvt_pk_bf16_f32 v187, v190, v191
    v_exp_f32 v160, v160
    v_exp_f32 v161, v161
    v_mfma_f32_32x32x16_bf16 v[224:239], v[124:127], v[184:187], v[224:239]
    v_exp_f32 v162, v162
    v_exp_f32 v163, v163
    v_exp_f32 v164, v164
    v_mfma_f32_32x32x16_bf16 v[176:191], v[16:19], v[144:147], 0
    v_exp_f32 v165, v165
    v_exp_f32 v166, v166
    v_exp_f32 v167, v167
    v_cvt_pk_bf16_f32 v160, v160, v161
    v_cvt_pk_bf16_f32 v161, v162, v163
    v_mfma_f32_32x32x16_bf16 v[176:191], v[20:23], v[148:151], v[176:191]
    v_cvt_pk_bf16_f32 v162, v164, v165
    v_cvt_pk_bf16_f32 v163, v166, v167
    v_exp_f32 v168, v168
    v_exp_f32 v169, v169
    v_exp_f32 v170, v170
    v_exp_f32 v171, v171
    v_mfma_f32_32x32x16_bf16 v[192:207], v[24:27], v[160:163], v[192:207]
    v_exp_f32 v172, v172
    v_exp_f32 v173, v173
    v_exp_f32 v174, v174
    v_exp_f32 v175, v175
    v_cvt_pk_bf16_f32 v168, v168, v169
    v_cvt_pk_bf16_f32 v169, v170, v171
    v_cvt_pk_bf16_f32 v170, v172, v173
    v_cvt_pk_bf16_f32 v171, v174, v175
    v_exp_f32 v176, v176
    v_exp_f32 v177, v177
    v_mfma_f32_32x32x16_bf16 v[192:207], v[28:31], v[168:171], v[192:207]
    v_exp_f32 v178, v178
    v_exp_f32 v179, v179
    v_exp_f32 v180, v180
    s_waitcnt lgkmcnt(0)
    v_mfma_f32_32x32x16_bf16 v[160:175], v[32:35], v[128:131], 0
    v_exp_f32 v181, v181
    v_exp_f32 v182, v182
    v_exp_f32 v183, v183
    v_cvt_pk_bf16_f32 v176, v176, v177
    v_cvt_pk_bf16_f32 v177, v178, v179
    v_mfma_f32_32x32x16_bf16 v[160:175], v[36:39], v[132:135], v[160:175]
    v_cvt_pk_bf16_f32 v178, v180, v181
    v_cvt_pk_bf16_f32 v179, v182, v183
    v_exp_f32 v184, v184
    v_exp_f32 v185, v185
    v_exp_f32 v186, v186
    v_exp_f32 v187, v187
    v_mfma_f32_32x32x16_bf16 v[224:239], v[24:27], v[176:179], v[224:239]
    v_exp_f32 v188, v188
    v_exp_f32 v189, v189
    v_exp_f32 v190, v190
    v_exp_f32 v191, v191
    v_cvt_pk_bf16_f32 v184, v184, v185
    v_cvt_pk_bf16_f32 v185, v186, v187
    v_cvt_pk_bf16_f32 v186, v188, v189
    v_cvt_pk_bf16_f32 v187, v190, v191
    v_exp_f32 v160, v160
    v_exp_f32 v161, v161
    v_mfma_f32_32x32x16_bf16 v[224:239], v[28:31], v[184:187], v[224:239]
F_pgA2_9:
    s_cbranch_execz F_ret
    v_exp_f32 v162, v162
    v_exp_f32 v163, v163
    v_exp_f32 v164, v164
    v_mfma_f32_32x32x16_bf16 v[176:191], v[32:35], v[144:147], 0
    v_exp_f32 v165, v165
    v_exp_f32 v166, v166
    v_exp_f32 v167, v167
    v_cvt_pk_bf16_f32 v160, v160, v161
    v_cvt_pk_bf16_f32 v161, v162, v163
    v_mfma_f32_32x32x16_bf16 v[176:191], v[36:39], v[148:151], v[176:191]
    v_cvt_pk_bf16_f32 v162, v164, v165
    v_cvt_pk_bf16_f32 v163, v166, v167
    v_exp_f32 v168, v168
    v_exp_f32 v169, v169
    v_exp_f32 v170, v170
    v_exp_f32 v171, v171
    v_mfma_f32_32x32x16_bf16 v[192:207], v[40:43], v[160:163], v[192:207]
    v_exp_f32 v172, v172
    v_exp_f32 v173, v173
    v_exp_f32 v174, v174
    v_exp_f32 v175, v175
    v_cvt_pk_bf16_f32 v168, v168, v169
    v_cvt_pk_bf16_f32 v169, v170, v171
    v_cvt_pk_bf16_f32 v170, v172, v173
    v_cvt_pk_bf16_f32 v171, v174, v175
    v_exp_f32 v176, v176
    v_exp_f32 v177, v177
    v_mfma_f32_32x32x16_bf16 v[192:207], v[44:47], v[168:171], v[192:207]
    v_exp_f32 v178, v178
    v_exp_f32 v179, v179
    v_exp_f32 v180, v180
    v_mfma_f32_32x32x16_bf16 v[160:175], v[64:67], v[136:139], 0
    v_exp_f32 v181, v181
    v_exp_f32 v182, v182
    v_exp_f32 v183, v183
    v_cvt_pk_bf16_f32 v176, v176, v177
    v_cvt_pk_bf16_f32 v177, v178, v179
    v_mfma_f32_32x32x16_bf16 v[160:175], v[68:71], v[140:143], v[160:175]
    v_cvt_pk_bf16_f32 v178, v180, v181
    v_cvt_pk_bf16_f32 v179, v182, v183
    v_exp_f32 v184, v184
    v_exp_f32 v185, v185
    v_exp_f32 v186, v186
    v_exp_f32 v187, v187
    v_mfma_f32_32x32x16_bf16 v[224:239], v[40:43], v[176:179], v[224:239]
    ds_write_b128 v11, v[192:195] offset:0
    v_exp_f32 v188, v188
    v_exp_f32 v189, v189
    v_exp_f32 v190, v190
    v_exp_f32 v191, v191
    v_cvt_pk_bf16_f32 v184, v184, v185
    v_cvt_pk_bf16_f32 v185, v186, v187
    v_cvt_pk_bf16_f32 v186, v188, v189
    v_cvt_pk_bf16_f32 v187, v190, v191
    v_exp_f32 v160, v160
    v_exp_f32 v161, v161
    v_mfma_f32_32x32x16_bf16 v[224:239], v[44:47], v[184:187], v[224:239]
    ds_write_b128 v11, v[196:199] offset:1024
    v_exp_f32 v162, v162
    v_exp_f32 v163, v163
    v_exp_f32 v164, v164
    v_mfma_f32_32x32x16_bf16 v[176:191], v[64:67], v[152:155], 0
    ds_write_b128 v11, v[200:203] offset:8192
    v_exp_f32 v165, v165
    v_exp_f32 v166, v166
    v_exp_f32 v167, v167
    v_cvt_pk_bf16_f32 v160, v160, v161
    v_cvt_pk_bf16_f32 v161, v162, v163
    v_mfma_f32_32x32x16_bf16 v[176:191], v[68:71], v[156:159], v[176:191]
    ds_write_b128 v11, v[204:207] offset:9216
    v_cvt_pk_bf16_f32 v162, v164, v165
    v_cvt_pk_bf16_f32 v163, v166, v167
    v_exp_f32 v168, v168
    v_exp_f32 v169, v169
    v_exp_f32 v170, v170
    v_exp_f32 v171, v171
    v_mfma_f32_32x32x16_bf16 v[208:223], v[72:75], v[160:163], v[208:223]
    ds_write_b128 v11, v[224:227] offset:16384
    v_exp_f32 v172, v172
    v_exp_f32 v173, v173
    v_exp_f32 v174, v174
    v_exp_f32 v175, v175
    v_cvt_pk_bf16_f32 v168, v168, v169
    v_cvt_pk_bf16_f32 v169, v170, v171
    v_cvt_pk_bf16_f32 v170, v172, v173
    v_cvt_pk_bf16_f32 v171, v174, v175
    v_exp_f32 v176, v176
    v_exp_f32 v177, v177
    v_mfma_f32_32x32x16_bf16 v[208:223], v[76:79], v[168:171], v[208:223]
    ds_write_b128 v11, v[228:231] offset:17408
    v_exp_f32 v178, v178
    v_exp_f32 v179, v179
    v_exp_f32 v180, v180
    v_mfma_f32_32x32x16_bf16 v[160:175], v[80:83], v[136:139], 0
    ds_write_b128 v11, v[232:235] offset:24576
    v_exp_f32 v181, v181
    v_exp_f32 v182, v182
    v_exp_f32 v183, v183
    v_cvt_pk_bf16_f32 v176, v176, v177
    v_cvt_pk_bf16_f32 v177, v178, v179
    v_mfma_f32_32x32x16_bf16 v[160:175], v[84:87], v[140:143], v[160:175]
    ds_write_b128 v11, v[236:239] offset:25600
    ds_add_u32 v8, v7
    v_cvt_pk_bf16_f32 v178, v180, v181
    v_cvt_pk_bf16_f32 v179, v182, v183
    v_exp_f32 v184, v184
    v_exp_f32 v185, v185
    v_exp_f32 v186, v186
    v_exp_f32 v187, v187
    v_mfma_f32_32x32x16_bf16 v[240:255], v[72:75], v[176:179], v[240:255]
    v_exp_f32 v188, v188
    v_exp_f32 v189, v189
    v_exp_f32 v190, v190
    v_exp_f32 v191, v191
    v_cvt_pk_bf16_f32 v184, v184, v185
    v_cvt_pk_bf16_f32 v185, v186, v187
    v_cvt_pk_bf16_f32 v186, v188, v189
    v_cvt_pk_bf16_f32 v187, v190, v191
    v_exp_f32 v160, v160
    v_exp_f32 v161, v161
    v_mfma_f32_32x32x16_bf16 v[240:255], v[76:79], v[184:187], v[240:255]
    v_exp_f32 v162, v162
    v_exp_f32 v163, v163
    v_exp_f32 v164, v164
    v_mfma_f32_32x32x16_bf16 v[176:191], v[80:83], v[152:155], 0
    v_exp_f32 v165, v165
    v_exp_f32 v166, v166
    v_exp_f32 v167, v167
    v_cvt_pk_bf16_f32 v160, v160, v161
    v_cvt_pk_bf16_f32 v161, v162, v163
    v_mfma_f32_32x32x16_bf16 v[176:191], v[84:87], v[156:159], v[176:191]
    v_cvt_pk_bf16_f32 v162, v164, v165
    v_cvt_pk_bf16_f32 v163, v166, v167
    v_exp_f32 v168, v168
    v_exp_f32 v169, v169
    v_exp_f32 v170, v170
    v_exp_f32 v171, v171
    v_mfma_f32_32x32x16_bf16 v[208:223], v[88:91], v[160:163], v[208:223]
    v_exp_f32 v172, v172
    v_exp_f32 v173, v173
    v_exp_f32 v174, v174
    v_exp_f32 v175, v175
    v_cvt_pk_bf16_f32 v168, v168, v169
    v_cvt_pk_bf16_f32 v169, v170, v171
    v_cvt_pk_bf16_f32 v170, v172, v173
    v_cvt_pk_bf16_f32 v171, v174, v175
    v_exp_f32 v176, v176
    v_exp_f32 v177, v177
    v_mfma_f32_32x32x16_bf16 v[208:223], v[92:95], v[168:171], v[208:223]
    v_exp_f32 v178, v178
    v_exp_f32 v179, v179
    v_exp_f32 v180, v180
    v_mfma_f32_32x32x16_bf16 v[160:175], v[96:99], v[136:139], 0
    v_exp_f32 v181, v181
    v_exp_f32 v182, v182
    v_exp_f32 v183, v183
    v_cvt_pk_bf16_f32 v176, v176, v177
    v_cvt_pk_bf16_f32 v177, v178, v179
    v_mfma_f32_32x32x16_bf16 v[160:175], v[100:103], v[140:143], v[160:175]
    ds_read_b32 v10, v9 offset:1024
    v_cvt_pk_bf16_f32 v178, v180, v181
    v_cvt_pk_bf16_f32 v179, v182, v183
    v_exp_f32 v184, v184
    v_exp_f32 v185, v185
    v_exp_f32 v186, v186
    v_exp_f32 v187, v187
    v_mfma_f32_32x32x16_bf16 v[240:255], v[88:91], v[176:179], v[240:255]
    v_exp_f32 v188, v188
    v_exp_f32 v189, v189
    v_exp_f32 v190, v190
    v_exp_f32 v191, v191
    v_cvt_pk_bf16_f32 v184, v184, v185
    v_cvt_pk_bf16_f32 v185, v186, v187
    v_cvt_pk_bf16_f32 v186, v188, v189
    v_cvt_pk_bf16_f32 v187, v190, v191
    v_exp_f32 v160, v160
    v_exp_f32 v161, v161
    v_mfma_f32_32x32x16_bf16 v[240:255], v[92:95], v[184:187], v[240:255]
    s_waitcnt lgkmcnt(0)
    v_cmp_gt_u32 vcc, 6, v10
    s_cbranch_vccnz F_fs5
F_fs5_ok:
    ds_read_b32 v3, v15 offset:0
    ds_read_b32 v4, v15 offset:2048
    v_exp_f32 v162, v162
    v_exp_f32 v163, v163
    v_exp_f32 v164, v164
    v_mfma_f32_32x32x16_bf16 v[176:191], v[96:99], v[152:155], 0
F_pgA2_10:
    s_cbranch_execz F_ret
    ds_read_b32 v5, v15 offset:4096
    ds_read_b32 v6, v15 offset:6144
    v_exp_f32 v165, v165
    v_exp_f32 v166, v166
    v_exp_f32 v167, v167
    v_cvt_pk_bf16_f32 v160, v160, v161
    v_cvt_pk_bf16_f32 v161, v162, v163
    v_mfma_f32_32x32x16_bf16 v[176:191], v[100:103], v[156:159], v[176:191]
    ds_read_b128 v[192:195], v14 offset:0
    ds_read_b128 v[196:199], v14 offset:1024
    v_cvt_pk_bf16_f32 v162, v164, v165
    v_cvt_pk_bf16_f32 v163, v166, v167
    v_exp_f32 v168, v168
    v_exp_f32 v169, v169
    v_exp_f32 v170, v170
    v_exp_f32 v171, v171
    v_mfma_f32_32x32x16_bf16 v[208:223], v[104:107], v[160:163], v[208:223]
    ds_read_b128 v[200:203], v14 offset:2048
    ds_read_b128 v[204:207], v14 offset:3072
    v_exp_f32 v172, v172
    v_exp_f32 v173, v173
    v_exp_f32 v174, v174
    v_exp_f32 v175, v175
    v_cvt_pk_bf16_f32 v168, v168, v169
    v_cvt_pk_bf16_f32 v169, v170, v171
    v_cvt_pk_bf16_f32 v170, v172, v173
    v_cvt_pk_bf16_f32 v171, v174, v175
    v_exp_f32 v176, v176
    v_exp_f32 v177, v177
    v_mfma_f32_32x32x16_bf16 v[208:223], v[108:111], v[168:171], v[208:223]
    ds_read_b128 v[224:227], v14 offset:4096
    ds_read_b128 v[228:231], v14 offset:5120
    v_exp_f32 v178, v178
    v_exp_f32 v179, v179
    v_exp_f32 v180, v180
    v_mfma_f32_32x32x16_bf16 v[160:175], v[112:115], v[136:139], 0
    ds_read_b128 v[232:235], v14 offset:6144
    ds_read_b128 v[236:239], v14 offset:7168
    ds_add_u32 v8, v7
    s_waitcnt lgkmcnt(9)
    v_add_f32 v3, v3, v4
    v_add_f32 v5, v5, v6
    s_waitcnt lgkmcnt(5)
    v_add_f32 v192, v192, v200
    v_add_f32 v193, v193, v201
    v_exp_f32 v181, v181
    v_exp_f32 v182, v182
    v_exp_f32 v183, v183
    v_cvt_pk_bf16_f32 v176, v176, v177
    v_cvt_pk_bf16_f32 v177, v178, v179
    v_mfma_f32_32x32x16_bf16 v[160:175], v[116:119], v[140:143], v[160:175]
    v_add_f32 v3, v3, v5
    v_add_f32 v194, v194, v202
    v_add_f32 v195, v195, v203
    v_mul_f32 v3, v3, v12
    v_add_f32 v196, v196, v204
    v_add_f32 v197, v197, v205
    v_cvt_pk_bf16_f32 v178, v180, v181
    v_cvt_pk_bf16_f32 v179, v182, v183
    v_exp_f32 v184, v184
    v_exp_f32 v185, v185
    v_exp_f32 v186, v186
    v_exp_f32 v187, v187
    v_mfma_f32_32x32x16_bf16 v[240:255], v[104:107], v[176:179], v[240:255]
    v_rcp_f32 v3, v3
    v_add_f32 v198, v198, v206
    v_add_f32 v199, v199, v207
    s_waitcnt lgkmcnt(1)
    v_add_f32 v224, v224, v232
    v_add_f32 v225, v225, v233
    v_exp_f32 v188, v188
    v_exp_f32 v189, v189
    v_exp_f32 v190, v190
    v_exp_f32 v191, v191
    v_cvt_pk_bf16_f32 v184, v184, v185
    v_cvt_pk_bf16_f32 v185, v186, v187
    v_cvt_pk_bf16_f32 v186, v188, v189
    v_cvt_pk_bf16_f32 v187, v190, v191
    v_exp_f32 v160, v160
    v_exp_f32 v161, v161
    v_mfma_f32_32x32x16_bf16 v[240:255], v[108:111], v[184:187], v[240:255]
    v_add_f32 v226, v226, v234
    v_add_f32 v227, v227, v235
    v_add_f32 v228, v228, v236
    v_add_f32 v229, v229, v237
    v_add_f32 v230, v230, v238
    v_add_f32 v231, v231, v239
    v_exp_f32 v162, v162
    v_exp_f32 v163, v163
    v_exp_f32 v164, v164
    v_mfma_f32_32x32x16_bf16 v[176:191], v[112:115], v[152:155], 0
    v_add_f32 v192, v192, v224
    v_add_f32 v193, v193, v225
    v_add_f32 v194, v194, v226
    v_add_f32 v195, v195, v227
    v_add_f32 v196, v196, v228
    v_add_f32 v197, v197, v229
    v_exp_f32 v165, v165
    v_exp_f32 v166, v166
    v_exp_f32 v167, v167
    v_cvt_pk_bf16_f32 v160, v160, v161
    v_cvt_pk_bf16_f32 v161, v162, v163
    v_mfma_f32_32x32x16_bf16 v[176:191], v[116:119], v[156:159], v[176:191]
    v_add_f32 v198, v198, v230
    v_add_f32 v199, v199, v231
    v_mul_f32 v192, v192, v3
    v_mul_f32 v193, v193, v3
    v_mul_f32 v194, v194, v3
    v_mul_f32 v195, v195, v3
    v_cvt_pk_bf16_f32 v162, v164, v165
    v_cvt_pk_bf16_f32 v163, v166, v167
    v_exp_f32 v168, v168
    v_exp_f32 v169, v169
    v_exp_f32 v170, v170
    v_exp_f32 v171, v171
    v_mfma_f32_32x32x16_bf16 v[208:223], v[120:123], v[160:163], v[208:223]
    v_mul_f32 v196, v196, v3
    v_mul_f32 v197, v197, v3
    v_mul_f32 v198, v198, v3
    v_mul_f32 v199, v199, v3
    v_cvt_pk_bf16_f32 v202, v196, v197
    v_cvt_pk_bf16_f32 v203, v198, v199
    v_exp_f32 v172, v172
    v_exp_f32 v173, v173
    v_exp_f32 v174, v174
    v_exp_f32 v175, v175
    v_cvt_pk_bf16_f32 v168, v168, v169
    v_cvt_pk_bf16_f32 v169, v170, v171
    v_cvt_pk_bf16_f32 v170, v172, v173
    v_cvt_pk_bf16_f32 v171, v174, v175
    v_exp_f32 v176, v176
    v_exp_f32 v177, v177
    v_mfma_f32_32x32x16_bf16 v[208:223], v[124:127], v[168:171], v[208:223]
    v_cndmask_b32 v202, 0, v202, s[42:43]
    v_cndmask_b32 v203, 0, v203, s[42:43]
    v_cvt_pk_bf16_f32 v200, v192, v193
    v_cvt_pk_bf16_f32 v201, v194, v195
    buffer_store_dwordx4 v[200:203], v0, s[16:19], s40 offen sc1
    s_add_u32 s40, s40, 147456
    v_exp_f32 v178, v178
    v_exp_f32 v179, v179
    v_exp_f32 v180, v180
    v_mfma_f32_32x32x16_bf16 v[160:175], v[16:19], v[136:139], 0
    v_exp_f32 v181, v181
    v_exp_f32 v182, v182
    v_exp_f32 v183, v183
    v_cvt_pk_bf16_f32 v176, v176, v177
    v_cvt_pk_bf16_f32 v177, v178, v179
    v_mfma_f32_32x32x16_bf16 v[160:175], v[20:23], v[140:143], v[160:175]
    v_cvt_pk_bf16_f32 v178, v180, v181
    v_cvt_pk_bf16_f32 v179, v182, v183
    v_exp_f32 v184, v184
    v_exp_f32 v185, v185
    v_exp_f32 v186, v186
    v_exp_f32 v187, v187
    v_mfma_f32_32x32x16_bf16 v[240:255], v[120:123], v[176:179], v[240:255]
    v_exp_f32 v188, v188
    v_exp_f32 v189, v189
    v_exp_f32 v190, v190
    v_exp_f32 v191, v191
    v_cvt_pk_bf16_f32 v184, v184, v185
    v_cvt_pk_bf16_f32 v185, v186, v187
    v_cvt_pk_bf16_f32 v186, v188, v189
    v_cvt_pk_bf16_f32 v187, v190, v191
    v_exp_f32 v160, v160
    v_exp_f32 v161, v161
    v_mfma_f32_32x32x16_bf16 v[240:255], v[124:127], v[184:187], v[240:255]
    v_exp_f32 v162, v162
    v_exp_f32 v163, v163
    v_exp_f32 v164, v164
    v_mfma_f32_32x32x16_bf16 v[176:191], v[16:19], v[152:155], 0
    v_exp_f32 v165, v165
    v_exp_f32 v166, v166
    v_exp_f32 v167, v167
    v_cvt_pk_bf16_f32 v160, v160, v161
    v_cvt_pk_bf16_f32 v161, v162, v163
    v_mfma_f32_32x32x16_bf16 v[176:191], v[20:23], v[156:159], v[176:191]
    v_cvt_pk_bf16_f32 v162, v164, v165
    v_cvt_pk_bf16_f32 v163, v166, v167
    v_exp_f32 v168, v168
    v_exp_f32 v169, v169
    v_exp_f32 v170, v170
    v_exp_f32 v171, v171
    v_mfma_f32_32x32x16_bf16 v[208:223], v[24:27], v[160:163], v[208:223]
    v_exp_f32 v172, v172
    v_exp_f32 v173, v173
    v_exp_f32 v174, v174
    v_exp_f32 v175, v175
    v_cvt_pk_bf16_f32 v168, v168, v169
    v_cvt_pk_bf16_f32 v169, v170, v171
    v_cvt_pk_bf16_f32 v170, v172, v173
    v_cvt_pk_bf16_f32 v171, v174, v175
    v_exp_f32 v176, v176
    v_exp_f32 v177, v177
    v_mfma_f32_32x32x16_bf16 v[208:223], v[28:31], v[168:171], v[208:223]
F_pgA2_11:
    s_cbranch_execz F_ret
    v_exp_f32 v178, v178
    v_exp_f32 v179, v179
    v_exp_f32 v180, v180
    v_mfma_f32_32x32x16_bf16 v[160:175], v[32:35], v[136:139], 0
    v_exp_f32 v181, v181
    v_exp_f32 v182, v182
    v_exp_f32 v183, v183
    v_cvt_pk_bf16_f32 v176, v176, v177
    v_cvt_pk_bf16_f32 v177, v178, v179
    v_mfma_f32_32x32x16_bf16 v[160:175], v[36:39], v[140:143], v[160:175]
    v_cvt_pk_bf16_f32 v178, v180, v181
    v_cvt_pk_bf16_f32 v179, v182, v183
    v_exp_f32 v184, v184
    v_exp_f32 v185, v185
    v_exp_f32 v186, v186
    v_exp_f32 v187, v187
    v_mfma_f32_32x32x16_bf16 v[240:255], v[24:27], v[176:179], v[240:255]
    v_exp_f32 v188, v188
    v_exp_f32 v189, v189
    v_exp_f32 v190, v190
    v_exp_f32 v191, v191
    v_cvt_pk_bf16_f32 v184, v184, v185
    v_cvt_pk_bf16_f32 v185, v186, v187
    v_cvt_pk_bf16_f32 v186, v188, v189
    v_cvt_pk_bf16_f32 v187, v190, v191
    v_exp_f32 v160, v160
    v_exp_f32 v161, v161
    v_mfma_f32_32x32x16_bf16 v[240:255], v[28:31], v[184:187], v[240:255]
    v_exp_f32 v162, v162
    v_exp_f32 v163, v163
    v_exp_f32 v164, v164
    v_mfma_f32_32x32x16_bf16 v[176:191], v[32:35], v[152:155], 0
    ds_read_b32 v10, v9 offset:1024
    v_exp_f32 v165, v165
    v_exp_f32 v166, v166
    v_exp_f32 v167, v167
    v_cvt_pk_bf16_f32 v160, v160, v161
    v_cvt_pk_bf16_f32 v161, v162, v163
    v_mfma_f32_32x32x16_bf16 v[176:191], v[36:39], v[156:159], v[176:191]
    v_cvt_pk_bf16_f32 v162, v164, v165
    v_cvt_pk_bf16_f32 v163, v166, v167
    v_exp_f32 v168, v168
    v_exp_f32 v169, v169
    v_exp_f32 v170, v170
    v_exp_f32 v171, v171
    v_mfma_f32_32x32x16_bf16 v[208:223], v[40:43], v[160:163], v[208:223]
    v_exp_f32 v172, v172
    v_exp_f32 v173, v173
    v_exp_f32 v174, v174
    v_exp_f32 v175, v175
    v_cvt_pk_bf16_f32 v168, v168, v169
    v_cvt_pk_bf16_f32 v169, v170, v171
    v_cvt_pk_bf16_f32 v170, v172, v173
    v_cvt_pk_bf16_f32 v171, v174, v175
    v_exp_f32 v176, v176
    v_exp_f32 v177, v177
    v_mfma_f32_32x32x16_bf16 v[208:223], v[44:47], v[168:171], v[208:223]
    v_exp_f32 v178, v178
    v_exp_f32 v179, v179
    v_exp_f32 v180, v180
    s_waitcnt lgkmcnt(0)
    v_cmp_gt_u32 vcc, 7, v10
    s_cbranch_vccnz F_fs6
F_fs6_ok:
    v_exp_f32 v181, v181
    v_exp_f32 v182, v182
    v_exp_f32 v183, v183
    v_cvt_pk_bf16_f32 v176, v176, v177
    v_cvt_pk_bf16_f32 v177, v178, v179
    ds_add_u32 v8, v7
    v_cvt_pk_bf16_f32 v178, v180, v181
    v_cvt_pk_bf16_f32 v179, v182, v183
    v_exp_f32 v184, v184
    v_exp_f32 v185, v185
    v_exp_f32 v186, v186
    v_exp_f32 v187, v187
    v_mfma_f32_32x32x16_bf16 v[240:255], v[40:43], v[176:179], v[240:255]
    ds_write_b128 v11, v[208:211] offset:0
    ds_write_b128 v11, v[212:215] offset:1024
    ds_write_b128 v11, v[216:219] offset:8192
    ds_write_b128 v11, v[220:223] offset:9216
    v_exp_f32 v188, v188
    v_exp_f32 v189, v189
    v_exp_f32 v190, v190
    v_exp_f32 v191, v191
    v_cvt_pk_bf16_f32 v184, v184, v185
    v_cvt_pk_bf16_f32 v185, v186, v187
    v_cvt_pk_bf16_f32 v186, v188, v189
    v_cvt_pk_bf16_f32 v187, v190, v191
    s_nop 1
    v_mfma_f32_32x32x16_bf16 v[240:255], v[44:47], v[184:187], v[240:255]
    s_nop 11
    ds_write_b128 v11, v[240:243] offset:16384
    ds_write_b128 v11, v[244:247] offset:17408
    ds_write_b128 v11, v[248:251] offset:24576
    ds_write_b128 v11, v[252:255] offset:25600
    ds_add_u32 v8, v7
    ds_read_b32 v10, v9 offset:1024
    s_waitcnt lgkmcnt(0)
    v_cmp_gt_u32 vcc, 9, v10
    s_cbranch_vccnz F_fs7
F_fs7_ok:
    ds_read_b32 v3, v15 offset:0
    ds_read_b32 v4, v15 offset:2048
    ds_read_b32 v5, v15 offset:4096
    ds_read_b32 v6, v15 offset:6144
    ds_read_b128 v[208:211], v14 offset:0
    ds_read_b128 v[212:215], v14 offset:1024
    ds_read_b128 v[216:219], v14 offset:2048
    ds_read_b128 v[220:223], v14 offset:3072
    ds_read_b128 v[240:243], v14 offset:4096
    ds_read_b128 v[244:247], v14 offset:5120
    ds_read_b128 v[248:251], v14 offset:6144
    ds_read_b128 v[252:255], v14 offset:7168
    s_waitcnt lgkmcnt(8)
    v_add_f32 v3, v3, v4
    v_add_f32 v5, v5, v6
    s_waitcnt lgkmcnt(4)
    v_add_f32 v208, v208, v216
    v_add_f32 v209, v209, v217
    v_add_f32 v3, v3, v5
    v_add_f32 v210, v210, v218
    v_add_f32 v211, v211, v219
    v_mul_f32 v3, v3, v13
    v_add_f32 v212, v212, v220
    v_add_f32 v213, v213, v221
    v_rcp_f32 v3, v3
    v_add_f32 v214, v214, v222
    v_add_f32 v215, v215, v223
    s_waitcnt lgkmcnt(0)
    v_add_f32 v240, v240, v248
    v_add_f32 v241, v241, v249
    v_add_f32 v242, v242, v250
    v_add_f32 v243, v243, v251
    v_add_f32 v244, v244, v252
    v_add_f32 v245, v245, v253
    v_add_f32 v246, v246, v254
    v_add_f32 v247, v247, v255
    v_add_f32 v208, v208, v240
    v_add_f32 v209, v209, v241
    v_add_f32 v210, v210, v242
    v_add_f32 v211, v211, v243
    v_add_f32 v212, v212, v244
    v_add_f32 v213, v213, v245
    v_add_f32 v214, v214, v246
    v_add_f32 v215, v215, v247
    v_mul_f32 v208, v208, v3
    v_mul_f32 v209, v209, v3
    v_mul_f32 v210, v210, v3
    v_mul_f32 v211, v211, v3
    v_mul_f32 v212, v212, v3
    v_mul_f32 v213, v213, v3
    v_mul_f32 v214, v214, v3
    v_mul_f32 v215, v215, v3
    v_cvt_pk_bf16_f32 v218, v212, v213
    v_cvt_pk_bf16_f32 v219, v214, v215
    v_cndmask_b32 v218, 0, v218, s[42:43]
    v_cndmask_b32 v219, 0, v219, s[42:43]
    v_cvt_pk_bf16_f32 v216, v208, v209
    v_cvt_pk_bf16_f32 v217, v210, v211
    buffer_store_dwordx4 v[216:219], v0, s[16:19], s40 offen sc1
    s_cmp_eq_u32 s91, 7
    s_cbranch_scc1 F_fin
    ds_read_b32 v10, v9 offset:0
    ds_add_u32 v8, v7
    s_lshl_b32 s28, s93, 10
    s_sub_u32 s28, 155648, s28
    v_add_u32 v116, s28, v11
    s_lshl1_add_u32 s28, s90, s3
    s_mul_i32 s30, s28, 294912
    s_and_b32 s29, s93, 1
    s_lshl_b32 s28, s93, 1
    s_sub_u32 s29, s29, s28
    s_lshl_b32 s29, s29, 10
    s_add_u32 s30, s30, s29
    s_add_u32 s30, s30, 3407872
    s_lshl2_add_u32 s28, s3, s93
    s_lshl_b32 s28, s28, 12
    s_xor_b32 s29, s28, 0x4000
    s_add_u32 s48, s30, s28
    s_add_u32 s49, s30, s29
    s_xor_b32 s50, s48, 1024
    s_xor_b32 s51, s49, 1024
    s_waitcnt lgkmcnt(1)
    v_cmp_gt_u32 vcc, 4, v10
    s_cbranch_vccnz F_fs8
F_fs8_ok:
    ds_read_b128 v[116:119], v116
    v_xor_b32 v121, 2048, v11
    v_xor_b32 v122, 4096, v11
    v_xor_b32 v123, 6144, v11
F_pgA2_12:
    s_cbranch_execz F_ret
    s_mov_b32 s30, 0x8000
    s_movk_i32 s28, 28672
    s_waitcnt lgkmcnt(0)
    v_mov_b32 v112, v116
    v_xor_b32 v113, 0x20, v116
    v_xor_b32 v114, 0x100, v116
    v_xor_b32 v115, 0x120, v116
    ds_read_b64_tr_b16 v[128:129], v112 offset:0
    ds_read_b64_tr_b16 v[130:131], v112 offset:8192
    ds_read_b64_tr_b16 v[132:133], v113 offset:0
    ds_read_b64_tr_b16 v[134:135], v113 offset:8192
    ds_read_b64_tr_b16 v[136:137], v114 offset:0
    ds_read_b64_tr_b16 v[138:139], v114 offset:8192
    ds_read_b64_tr_b16 v[140:141], v115 offset:0
    ds_read_b64_tr_b16 v[142:143], v115 offset:8192
    ds_read_b64_tr_b16 v[144:145], v112 offset:16384
    ds_read_b64_tr_b16 v[146:147], v112 offset:24576
    ds_read_b64_tr_b16 v[148:149], v113 offset:16384
    ds_read_b64_tr_b16 v[150:151], v113 offset:24576
    s_waitcnt lgkmcnt(8)
    ds_read_b64_tr_b16 v[152:153], v114 offset:16384
    ds_read_b64_tr_b16 v[154:155], v114 offset:24576
    ds_read_b64_tr_b16 v[156:157], v115 offset:16384
    ds_read_b64_tr_b16 v[158:159], v115 offset:24576
    s_waitcnt lgkmcnt(8)
    ds_read_b64_tr_b16 v[160:161], v112 offset:32768
    ds_read_b64_tr_b16 v[162:163], v112 offset:40960
    ds_read_b64_tr_b16 v[164:165], v113 offset:32768
    ds_read_b64_tr_b16 v[166:167], v113 offset:40960
    s_waitcnt lgkmcnt(8)
    ds_read_b64_tr_b16 v[168:169], v114 offset:32768
    ds_read_b64_tr_b16 v[170:171], v114 offset:40960
    ds_read_b64_tr_b16 v[172:173], v115 offset:32768
    ds_read_b64_tr_b16 v[174:175], v115 offset:40960
    s_waitcnt lgkmcnt(8)
    ds_read_b64_tr_b16 v[176:177], v112 offset:49152
    ds_read_b64_tr_b16 v[178:179], v112 offset:57344
    ds_read_b64_tr_b16 v[180:181], v113 offset:49152
    ds_read_b64_tr_b16 v[182:183], v113 offset:57344
    s_waitcnt lgkmcnt(8)
    ds_read_b64_tr_b16 v[184:185], v114 offset:49152
    ds_read_b64_tr_b16 v[186:187], v114 offset:57344
    ds_read_b64_tr_b16 v[188:189], v115 offset:49152
    ds_read_b64_tr_b16 v[190:191], v115 offset:57344
    ds_read_b32 v10, v9 offset:1024
    s_waitcnt lgkmcnt(0)
    v_cmp_gt_u32 vcc, 10, v10
    s_cbranch_vccnz F_fs9
F_fs9_ok:
    ds_read_b32 v10, v9 offset:0
    s_waitcnt lgkmcnt(0)
    v_cmp_gt_u32 vcc, 5, v10
    s_cbranch_vccnz F_fs10
F_fs10_ok:
    ds_read_b128 v[16:19], v11 offset:32768
    ds_read_b128 v[20:23], v11 offset:33792
    ds_read_b128 v[24:27], v121 offset:40960
    ds_read_b128 v[28:31], v121 offset:41984
    ds_read_b128 v[32:35], v122 offset:49152
    ds_read_b128 v[36:39], v122 offset:50176
    ds_read_b128 v[40:43], v123 offset:57344
    ds_read_b128 v[44:47], v123 offset:58368
    buffer_load_dwordx4 v[80:83], v11, s[16:19], s48 offen offset:0 sc1
    buffer_load_dwordx4 v[84:87], v11, s[16:19], s50 offen offset:0 sc1
    buffer_load_dwordx4 v[88:91], v11, s[16:19], s48 offen offset:2048 sc1
    buffer_load_dwordx4 v[92:95], v11, s[16:19], s50 offen offset:2048 sc1
    buffer_load_dwordx4 v[96:99], v11, s[16:19], s49 offen offset:0 sc1
    buffer_load_dwordx4 v[100:103], v11, s[16:19], s51 offen offset:0 sc1
    buffer_load_dwordx4 v[104:107], v11, s[16:19], s49 offen offset:2048 sc1
    buffer_load_dwordx4 v[108:111], v11, s[16:19], s51 offen offset:2048 sc1
    s_waitcnt lgkmcnt(4)
    v_add_f32 v16, v16, v24
    v_add_f32 v17, v17, v25
    v_add_f32 v18, v18, v26
    v_add_f32 v19, v19, v27
    v_add_f32 v20, v20, v28
    v_add_f32 v21, v21, v29
    v_add_f32 v22, v22, v30
    v_add_f32 v23, v23, v31
    s_waitcnt lgkmcnt(0)
    v_add_f32 v32, v32, v40
    v_add_f32 v33, v33, v41
    v_add_f32 v34, v34, v42
    v_add_f32 v35, v35, v43
    v_add_f32 v36, v36, v44
    v_add_f32 v37, v37, v45
    v_add_f32 v38, v38, v46
    v_add_f32 v39, v39, v47
    v_add_f32 v16, v16, v32
    v_add_f32 v17, v17, v33
    v_add_f32 v18, v18, v34
    v_add_f32 v19, v19, v35
    v_add_f32 v20, v20, v36
    v_add_f32 v21, v21, v37
    v_add_f32 v22, v22, v38
    v_add_f32 v23, v23, v39
    s_waitcnt vmcnt(6)
Fo_chk10:
    v_max3_u32 v3, v80, v81, v82
    v_max3_u32 v4, v84, v85, v86
    v_max3_u32 v3, v3, v83, v87
    v_max_u32 v3, v3, v4
    v_cmp_eq_u32 vcc, -1, v3
    s_cbranch_vccnz Fo_retry10
Fo_go10:
    v_mfma_f32_16x16x32_bf16 v[240:243], v[136:139], v[80:83], 0
    v_mfma_f32_16x16x32_bf16 v[244:247], v[140:143], v[80:83], 0
    v_mfma_f32_16x16x32_bf16 v[248:251], v[136:139], v[84:87], 0
    v_mfma_f32_16x16x32_bf16 v[252:255], v[140:143], v[84:87], 0
    v_mfma_f32_16x16x32_bf16 v[232:235], v[128:131], v[84:87], 0
    v_mfma_f32_16x16x32_bf16 v[236:239], v[132:135], v[84:87], 0
    v_mfma_f32_16x16x32_bf16 v[224:227], v[128:131], v[80:83], v[16:19]
    v_mfma_f32_16x16x32_bf16 v[228:231], v[132:135], v[80:83], v[20:23]
    s_waitcnt vmcnt(4)
Fo_chk11:
    v_max3_u32 v3, v88, v89, v90
    v_max3_u32 v4, v92, v93, v94
    v_max3_u32 v3, v3, v91, v95
    v_max_u32 v3, v3, v4
    v_cmp_eq_u32 vcc, -1, v3
    s_cbranch_vccnz Fo_retry11
Fo_go11:
    v_mfma_f32_16x16x32_bf16 v[240:243], v[152:155], v[88:91], v[240:243]
    v_mfma_f32_16x16x32_bf16 v[244:247], v[156:159], v[88:91], v[244:247]
    v_mfma_f32_16x16x32_bf16 v[248:251], v[152:155], v[92:95], v[248:251]
    v_mfma_f32_16x16x32_bf16 v[252:255], v[156:159], v[92:95], v[252:255]
    v_mfma_f32_16x16x32_bf16 v[232:235], v[144:147], v[92:95], v[232:235]
    v_mfma_f32_16x16x32_bf16 v[236:239], v[148:151], v[92:95], v[236:239]
    s_waitcnt vmcnt(2)
Fo_chk12:
    v_max3_u32 v3, v96, v97, v98
    v_max3_u32 v4, v100, v101, v102
    v_max3_u32 v3, v3, v99, v103
    v_max_u32 v3, v3, v4
    v_cmp_eq_u32 vcc, -1, v3
    s_cbranch_vccnz Fo_retry12
Fo_go12:
    v_mfma_f32_16x16x32_bf16 v[240:243], v[168:171], v[96:99], v[240:243]
F_pgA2_13:
    s_cbranch_execz F_ret
    v_mfma_f32_16x16x32_bf16 v[244:247], v[172:175], v[96:99], v[244:247]
    v_mfma_f32_16x16x32_bf16 v[248:251], v[168:171], v[100:103], v[248:251]
    v_mfma_f32_16x16x32_bf16 v[252:255], v[172:175], v[100:103], v[252:255]
    v_mfma_f32_16x16x32_bf16 v[232:235], v[160:163], v[100:103], v[232:235]
    v_mfma_f32_16x16x32_bf16 v[236:239], v[164:167], v[100:103], v[236:239]
    s_waitcnt vmcnt(0)
Fo_chk13:
    v_max3_u32 v3, v104, v105, v106
    v_max3_u32 v4, v108, v109, v110
    v_max3_u32 v3, v3, v107, v111
    v_max_u32 v3, v3, v4
    v_cmp_eq_u32 vcc, -1, v3
    s_cbranch_vccnz Fo_retry13
Fo_go13:
    v_mfma_f32_16x16x32_bf16 v[240:243], v[184:187], v[104:107], v[240:243]
    v_mfma_f32_16x16x32_bf16 v[244:247], v[188:191], v[104:107], v[244:247]
    v_mfma_f32_16x16x32_bf16 v[248:251], v[184:187], v[108:111], v[248:251]
    v_mfma_f32_16x16x32_bf16 v[252:255], v[188:191], v[108:111], v[252:255]
    s_nop 4
    ds_write_b128 v11, v[240:243] offset:16384
    v_mfma_f32_16x16x32_bf16 v[232:235], v[176:179], v[108:111], v[232:235]
    ds_write_b128 v11, v[244:247] offset:17408
    v_mfma_f32_16x16x32_bf16 v[236:239], v[180:183], v[108:111], v[236:239]
    ds_write_b128 v11, v[248:251] offset:24576
    v_mfma_f32_16x16x32_bf16 v[224:227], v[144:147], v[88:91], v[224:227]
    ds_write_b128 v11, v[252:255] offset:25600
    v_mfma_f32_16x16x32_bf16 v[228:231], v[148:151], v[88:91], v[228:231]
    s_nop 1
    ds_write_b128 v11, v[232:235] offset:8192
    v_mfma_f32_16x16x32_bf16 v[224:227], v[160:163], v[96:99], v[224:227]
    ds_write_b128 v11, v[236:239] offset:9216
    ds_add_u32 v8, v7
    ds_read_b32 v10, v9 offset:1024
    v_mfma_f32_16x16x32_bf16 v[228:231], v[164:167], v[96:99], v[228:231]
    v_mfma_f32_16x16x32_bf16 v[224:227], v[176:179], v[104:107], v[224:227]
    v_mfma_f32_16x16x32_bf16 v[228:231], v[180:183], v[104:107], v[228:231]
    s_waitcnt lgkmcnt(0)
    v_cmp_gt_u32 vcc, 11, v10
    s_cbranch_vccnz F_fs11
F_fs11_ok:
    ds_read_b128 v[56:59], v121 offset:8192
    ds_read_b128 v[60:63], v121 offset:9216
    ds_read_b128 v[64:67], v122 offset:16384
    ds_read_b128 v[68:71], v122 offset:17408
    ds_read_b128 v[72:75], v123 offset:24576
    ds_read_b128 v[76:79], v123 offset:25600
    v_mul_f32 v224, v224, v118
    v_mul_f32 v225, v225, v118
    v_mul_f32 v226, v226, v118
    v_mul_f32 v227, v227, v118
    v_mul_f32 v228, v228, v118
    v_mul_f32 v229, v229, v118
    v_mul_f32 v230, v230, v118
    v_mul_f32 v231, v231, v118
    s_waitcnt lgkmcnt(4)
    v_fmac_f32 v224, v56, v118
    v_fmac_f32 v225, v57, v118
    v_fmac_f32 v226, v58, v118
    v_fmac_f32 v227, v59, v118
    v_fmac_f32 v228, v60, v118
    v_fmac_f32 v229, v61, v118
    v_fmac_f32 v230, v62, v118
    v_fmac_f32 v231, v63, v118
    s_waitcnt lgkmcnt(2)
    v_fmac_f32 v224, v64, v118
    v_fmac_f32 v225, v65, v118
    v_fmac_f32 v226, v66, v118
    v_fmac_f32 v227, v67, v118
    v_fmac_f32 v228, v68, v118
    v_fmac_f32 v229, v69, v118
    v_fmac_f32 v230, v70, v118
    v_fmac_f32 v231, v71, v118
    s_waitcnt lgkmcnt(0)
    v_fmac_f32 v224, v72, v118
    v_fmac_f32 v225, v73, v118
    v_fmac_f32 v226, v74, v118
    v_fmac_f32 v227, v75, v118
    v_fmac_f32 v228, v76, v118
    v_fmac_f32 v229, v77, v118
    v_fmac_f32 v230, v78, v118
    v_fmac_f32 v231, v79, v118
    v_cvt_pk_bf16_f32 v232, v224, v225
    v_cvt_pk_bf16_f32 v234, v228, v229
    v_cvt_pk_bf16_f32 v233, v226, v227
    v_cvt_pk_bf16_f32 v235, v230, v231
    v_permlane16_swap_b32 v232, v234
    s_nop 0
    v_permlane16_swap_b32 v233, v235
    buffer_store_dwordx4 v[232:235], v117, s[44:47], s28 offen sc1
F_fin:
F_end:
    s_endpgm
F_g2:
    ds_read_b32 v4, v9 offset:1024
    ds_read_b32 v10, v9 offset:0
    s_setprio 3
    s_waitcnt lgkmcnt(0)
    v_cmp_gt_u32 vcc, 1, v10
    s_cbranch_vccnz F_fs12
F_fs12_ok:
    v_cmp_gt_u32 vcc, 2, v4
    s_cbranch_vccnz F_fs13
F_fs13_ok:
    ds_read_b32 v12, v18 offset:0
    ds_read_b32 v13, v18 offset:128
    s_lshl_b32 s28, s93, 10
    s_add_u32 s28, s28, 155648
    v_add_u32 v18, s28, v2
    s_setprio 0
    s_add_u32 m0, s49, 106496
    s_add_u32 s28, s99, s41
    buffer_load_dwordx4 v2, s[16:19], s28 offen offset:0 sc1 lds
    s_add_u32 m0, s49, 106496
    s_add_u32 s28, s99, s41
    buffer_load_dwordx4 v2, s[16:19], s28 offen offset:1024 sc1 lds
    s_add_u32 m0, s49, 112640
    s_add_u32 s28, s99, s41
    buffer_load_dwordx4 v2, s[16:19], s28 offen offset:2048 sc1 lds
    s_add_u32 m0, s49, 112640
    s_add_u32 s28, s99, s41
    buffer_load_dwordx4 v2, s[16:19], s28 offen offset:3072 sc1 lds
    s_add_u32 s41, s41, 4096
    s_and_b32 s41, s41, 0xffff
    s_add_u32 m0, s49, 4294934528
    s_add_u32 s28, s99, s41
    buffer_load_dwordx4 v2, s[16:19], s28 offen offset:0 sc1 lds
    s_add_u32 m0, s49, 4294934528
    s_add_u32 s28, s99, s41
    buffer_load_dwordx4 v2, s[16:19], s28 offen offset:1024 sc1 lds
    s_add_u32 m0, s49, 4294940672
    s_add_u32 s28, s99, s41
    buffer_load_dwordx4 v2, s[16:19], s28 offen offset:2048 sc1 lds
    s_add_u32 m0, s49, 4294940672
    s_add_u32 s28, s99, s41
    buffer_load_dwordx4 v2, s[16:19], s28 offen offset:3072 sc1 lds
    s_add_u32 s41, s41, 4096
    s_and_b32 s41, s41, 0xffff
    s_add_u32 m0, s49, 4294950912
    s_add_u32 s28, s99, s41
    buffer_load_dwordx4 v2, s[16:19], s28 offen offset:0 sc1 lds
    s_add_u32 m0, s49, 4294950912
    s_add_u32 s28, s99, s41
    buffer_load_dwordx4 v2, s[16:19], s28 offen offset:1024 sc1 lds
    s_add_u32 m0, s49, 4294957056
    s_add_u32 s28, s99, s41
    buffer_load_dwordx4 v2, s[16:19], s28 offen offset:2048 sc1 lds
    s_add_u32 m0, s49, 4294957056
    s_add_u32 s28, s99, s41
    buffer_load_dwordx4 v2, s[16:19], s28 offen offset:3072 sc1 lds
    s_add_u32 s41, s41, 4096
    s_and_b32 s41, s41, 0xffff
    s_waitcnt vmcnt(12)
    s_lshl2_add_u32 s28, s95, s93
    s_lshl_b32 s28, s28, 7
    s_add_u32 s28, s28, s40
    s_mov_b64 exec, 1
    buffer_store_dword v7, off, s[16:19], s28 sc1
    s_mov_b64 exec, -1
    s_add_u32 m0, s49, 57344
    s_add_u32 s28, s99, s41
    buffer_load_dwordx4 v2, s[16:19], s28 offen offset:0 sc1 lds
    s_add_u32 m0, s49, 57344
    s_add_u32 s28, s99, s41
    buffer_load_dwordx4 v2, s[16:19], s28 offen offset:1024 sc1 lds
    s_add_u32 m0, s49, 63488
    s_add_u32 s28, s99, s41
    buffer_load_dwordx4 v2, s[16:19], s28 offen offset:2048 sc1 lds
    s_add_u32 m0, s49, 63488
    s_add_u32 s28, s99, s41
    buffer_load_dwordx4 v2, s[16:19], s28 offen offset:3072 sc1 lds
    s_add_u32 s41, s41, 4096
    s_and_b32 s41, s41, 0xffff
    s_add_u32 m0, s49, 73728
    s_add_u32 s28, s99, s41
    buffer_load_dwordx4 v2, s[16:19], s28 offen offset:0 sc1 lds
    s_add_u32 m0, s49, 73728
    s_add_u32 s28, s99, s41
    buffer_load_dwordx4 v2, s[16:19], s28 offen offset:1024 sc1 lds
    s_add_u32 m0, s49, 79872
    s_add_u32 s28, s99, s41
    buffer_load_dwordx4 v2, s[16:19], s28 offen offset:2048 sc1 lds
    s_add_u32 m0, s49, 79872
    s_add_u32 s28, s99, s41
    buffer_load_dwordx4 v2, s[16:19], s28 offen offset:3072 sc1 lds
    s_add_u32 s41, s41, 4096
F_pgG2_0:
    s_cbranch_execz F_ret
    s_and_b32 s41, s41, 0xffff
    s_add_u32 m0, s49, 90112
    s_add_u32 s28, s99, s41
    buffer_load_dwordx4 v2, s[16:19], s28 offen offset:0 sc1 lds
    s_add_u32 m0, s49, 90112
    s_add_u32 s28, s99, s41
    buffer_load_dwordx4 v2, s[16:19], s28 offen offset:1024 sc1 lds
    s_add_u32 m0, s49, 96256
    s_add_u32 s28, s99, s41
    buffer_load_dwordx4 v2, s[16:19], s28 offen offset:2048 sc1 lds
    s_add_u32 m0, s49, 96256
    s_add_u32 s28, s99, s41
    buffer_load_dwordx4 v2, s[16:19], s28 offen offset:3072 sc1 lds
    s_add_u32 s41, s41, 4096
    s_and_b32 s41, s41, 0xffff
    s_add_u32 m0, s49, 0
    s_add_u32 s54, s51, s50
    s_add_u32 s28, s54, 0
    buffer_load_dwordx4 v14, s[32:35], s28 offen lds
    s_add_u32 m0, s49, 1024
    s_add_u32 s28, s54, 7168
    buffer_load_dwordx4 v14, s[32:35], s28 offen lds
    s_add_u32 m0, s49, 8192
    s_add_u32 s28, s54, 14336
    buffer_load_dwordx4 v14, s[32:35], s28 offen lds
    s_add_u32 m0, s49, 9216
    s_add_u32 s28, s54, 21504
    buffer_load_dwordx4 v14, s[32:35], s28 offen lds
    s_mov_b32 s50, s12
    s_add_u32 m0, s49, 16384
    s_cmp_ge_u32 s50, s8
    s_cselect_b32 s54, 114688, 0
    s_add_u32 s54, s54, s50
    s_add_u32 s54, s54, s51
    s_add_u32 s28, s54, 0
    buffer_load_dwordx4 v14, s[32:35], s28 offen lds
    s_add_u32 m0, s49, 17408
    s_add_u32 s28, s54, 7168
    buffer_load_dwordx4 v14, s[32:35], s28 offen lds
    s_waitcnt vmcnt(6)
    ds_add_u32 v8, v7
    s_mov_b32 exec_hi, 0
    s_mov_b32 exec_lo, 126
    buffer_load_dword v17, v16, s[16:19], s40 offen sc1
    s_mov_b64 exec, -1
    s_add_u32 m0, s49, 24576
    s_add_u32 s28, s54, 14336
    buffer_load_dwordx4 v14, s[32:35], s28 offen lds
    s_add_u32 m0, s49, 25600
    s_add_u32 s28, s54, 21504
    buffer_load_dwordx4 v14, s[32:35], s28 offen lds
    s_add_u32 s50, s50, 114688
    s_cmp_eq_u32 s50, 688128
    s_cselect_b32 s50, 0, s50
    s_add_u32 m0, s49, 32768
    s_cmp_ge_u32 s50, s8
    s_cselect_b32 s54, 114688, 0
    s_add_u32 s54, s54, s50
    s_add_u32 s54, s54, s51
    s_add_u32 s28, s54, 0
    buffer_load_dwordx4 v14, s[32:35], s28 offen lds
    s_add_u32 m0, s49, 33792
    s_add_u32 s28, s54, 7168
    buffer_load_dwordx4 v14, s[32:35], s28 offen lds
    s_add_u32 m0, s49, 40960
    s_add_u32 s28, s54, 14336
    buffer_load_dwordx4 v14, s[32:35], s28 offen lds
    s_add_u32 m0, s49, 41984
    s_add_u32 s28, s54, 21504
    buffer_load_dwordx4 v14, s[32:35], s28 offen lds
    s_add_u32 s50, s50, 114688
    s_cmp_eq_u32 s50, 688128
    s_cselect_b32 s50, 0, s50
    s_add_u32 m0, s49, 49152
    s_cmp_ge_u32 s50, s8
    s_cselect_b32 s54, 114688, 0
    s_add_u32 s54, s54, s50
    s_add_u32 s54, s54, s51
    s_add_u32 s28, s54, 0
    buffer_load_dwordx4 v14, s[32:35], s28 offen lds
    s_add_u32 m0, s49, 50176
    s_add_u32 s28, s54, 7168
    buffer_load_dwordx4 v14, s[32:35], s28 offen lds
    s_setprio 3
    s_waitcnt vmcnt(8)
    v_cmp_ne_u32 s[42:43], 1, v17
    s_setprio 0
    s_bitcmp1_b32 s42, 1
    s_cbranch_scc1 Fh_w1
Fh_ok1:
    s_cmp_ge_u32 s52, s9
    s_cselect_b32 s55, 8192, 0
    s_add_u32 s55, s55, s52
    s_add_u32 s55, s55, s53
    s_add_u32 s48, s55, 147456
    buffer_load_dwordx4 v[104:107], v2, s[16:19], s55 offen sc1
    s_xor_b32 s55, s55, 1024
    buffer_load_dwordx4 v[108:111], v2, s[16:19], s48 offen sc1
    s_xor_b32 s48, s48, 1024
    buffer_load_dwordx4 v[112:115], v2, s[16:19], s55 offen sc1
    buffer_load_dwordx4 v[116:119], v2, s[16:19], s48 offen sc1
    s_add_u32 s52, s52, 8192
    s_cmp_eq_u32 s52, 49152
    s_cselect_b32 s52, 0, s52
    s_bitcmp1_b32 s42, 2
    s_cbranch_scc1 Fh_w2
Fh_ok2:
    s_cmp_ge_u32 s52, s9
    s_cselect_b32 s55, 8192, 0
    s_add_u32 s55, s55, s52
    s_add_u32 s55, s55, s53
    s_add_u32 s48, s55, 147456
    buffer_load_dwordx4 v[120:123], v2, s[16:19], s55 offen sc1
    s_xor_b32 s55, s55, 1024
    buffer_load_dwordx4 v[124:127], v2, s[16:19], s48 offen sc1
    s_xor_b32 s48, s48, 1024
    buffer_load_dwordx4 v[128:131], v2, s[16:19], s55 offen sc1
    buffer_load_dwordx4 v[132:135], v2, s[16:19], s48 offen sc1
    s_add_u32 s52, s52, 8192
    s_cmp_eq_u32 s52, 49152
    s_cselect_b32 s52, 0, s52
    ds_read_b64_tr_b16 v[40:41], v20 offset:0
    ds_read_b64_tr_b16 v[42:43], v20 offset:8192
    ds_read_b64_tr_b16 v[44:45], v21 offset:0
    ds_read_b64_tr_b16 v[46:47], v21 offset:8192
    s_lshl2_add_u32 s28, s3, s93
    s_lshl_b32 s28, s28, 12
    s_xor_b32 s29, s28, 0x4000
    s_add_u32 s98, s98, 114688
    s_add_u32 s56, s98, s28
    s_add_u32 s57, s98, s29
    s_xor_b32 s58, s56, 1024
    s_xor_b32 s59, s57, 1024
    s_waitcnt lgkmcnt(0)
    v_mfma_f32_16x16x32_bf16 v[184:187], v[40:43], v[56:59], 0
    v_mfma_f32_16x16x32_bf16 v[188:191], v[44:47], v[56:59], 0
    ds_read_b64_tr_b16 v[48:49], v22 offset:0
    ds_read_b64_tr_b16 v[50:51], v22 offset:8192
    ds_read_b64_tr_b16 v[52:53], v23 offset:0
    ds_read_b64_tr_b16 v[54:55], v23 offset:8192
    v_mfma_f32_16x16x32_bf16 v[216:219], v[40:43], v[60:63], 0
    v_mfma_f32_16x16x32_bf16 v[220:223], v[44:47], v[60:63], 0
    v_mfma_f32_16x16x32_bf16 v[192:195], v[40:43], v[64:67], 0
    v_mfma_f32_16x16x32_bf16 v[196:199], v[44:47], v[64:67], 0
    v_mfma_f32_16x16x32_bf16 v[224:227], v[40:43], v[68:71], 0
    v_mfma_f32_16x16x32_bf16 v[228:231], v[44:47], v[68:71], 0
    s_waitcnt vmcnt(14)
    s_waitcnt lgkmcnt(0)
    v_mfma_f32_16x16x32_bf16 v[200:203], v[48:51], v[56:59], 0
    v_mfma_f32_16x16x32_bf16 v[204:207], v[52:55], v[56:59], 0
    ds_read_b64_tr_b16 v[40:41], v20 offset:16384
    ds_read_b64_tr_b16 v[42:43], v20 offset:24576
    ds_read_b64_tr_b16 v[44:45], v21 offset:16384
    ds_read_b64_tr_b16 v[46:47], v21 offset:24576
    v_mfma_f32_16x16x32_bf16 v[232:235], v[48:51], v[60:63], 0
    v_mfma_f32_16x16x32_bf16 v[236:239], v[52:55], v[60:63], 0
    s_add_u32 m0, s49, 0
    s_add_u32 s28, s54, 14336
    buffer_load_dwordx4 v14, s[32:35], s28 offen lds
    s_add_u32 m0, s49, 1024
    s_add_u32 s28, s54, 21504
    buffer_load_dwordx4 v14, s[32:35], s28 offen lds
    s_add_u32 s50, s50, 114688
    s_cmp_eq_u32 s50, 688128
    s_cselect_b32 s50, 0, s50
    v_mfma_f32_16x16x32_bf16 v[208:211], v[48:51], v[64:67], 0
F_pgG2_1:
    s_cbranch_execz F_ret
    v_mfma_f32_16x16x32_bf16 v[212:215], v[52:55], v[64:67], 0
    v_mfma_f32_16x16x32_bf16 v[240:243], v[48:51], v[68:71], 0
    v_mfma_f32_16x16x32_bf16 v[244:247], v[52:55], v[68:71], 0
    s_waitcnt vmcnt(8)
    s_waitcnt lgkmcnt(0)
    v_mfma_f32_16x16x32_bf16 v[184:187], v[40:43], v[104:107], v[184:187]
    v_mfma_f32_16x16x32_bf16 v[188:191], v[44:47], v[104:107], v[188:191]
    ds_read_b64_tr_b16 v[48:49], v22 offset:16384
    ds_read_b64_tr_b16 v[50:51], v22 offset:24576
    ds_read_b64_tr_b16 v[52:53], v23 offset:16384
    ds_read_b64_tr_b16 v[54:55], v23 offset:24576
    v_mfma_f32_16x16x32_bf16 v[216:219], v[40:43], v[108:111], v[216:219]
    v_mfma_f32_16x16x32_bf16 v[220:223], v[44:47], v[108:111], v[220:223]
    s_add_u32 m0, s49, 8192
    s_cmp_ge_u32 s50, s8
    s_cselect_b32 s54, 114688, 0
    s_add_u32 s54, s54, s50
    s_add_u32 s54, s54, s51
    s_add_u32 s28, s54, 0
    buffer_load_dwordx4 v14, s[32:35], s28 offen lds
    s_add_u32 m0, s49, 9216
    s_add_u32 s28, s54, 7168
    buffer_load_dwordx4 v14, s[32:35], s28 offen lds
    s_waitcnt vmcnt(8)
    v_mfma_f32_16x16x32_bf16 v[192:195], v[40:43], v[112:115], v[192:195]
    v_mfma_f32_16x16x32_bf16 v[196:199], v[44:47], v[112:115], v[196:199]
    ds_read_b32 v10, v8 offset:1024
    s_setprio 3
    s_waitcnt lgkmcnt(0)
    v_cmp_gt_u32 vcc, 3, v10
    s_cbranch_vccnz F_fs14
F_fs14_ok:
    s_setprio 0
    s_add_u32 m0, s49, 106496
    s_add_u32 s28, s99, s41
    buffer_load_dwordx4 v2, s[16:19], s28 offen offset:0 sc1 lds
    s_add_u32 m0, s49, 106496
    s_add_u32 s28, s99, s41
    buffer_load_dwordx4 v2, s[16:19], s28 offen offset:1024 sc1 lds
    s_add_u32 m0, s49, 112640
    s_add_u32 s28, s99, s41
    buffer_load_dwordx4 v2, s[16:19], s28 offen offset:2048 sc1 lds
    s_add_u32 m0, s49, 112640
    s_add_u32 s28, s99, s41
    buffer_load_dwordx4 v2, s[16:19], s28 offen offset:3072 sc1 lds
    s_add_u32 s41, s41, 4096
    s_and_b32 s41, s41, 0xffff
    v_mfma_f32_16x16x32_bf16 v[224:227], v[40:43], v[116:119], v[224:227]
    v_mfma_f32_16x16x32_bf16 v[228:231], v[44:47], v[116:119], v[228:231]
    s_bitcmp1_b32 s42, 3
    s_cbranch_scc1 Fh_w3
Fh_ok3:
    s_cmp_ge_u32 s52, s9
    s_cselect_b32 s55, 8192, 0
    s_add_u32 s55, s55, s52
    s_add_u32 s55, s55, s53
    s_add_u32 s48, s55, 147456
    buffer_load_dwordx4 v[136:139], v2, s[16:19], s55 offen sc1
    s_xor_b32 s55, s55, 1024
    buffer_load_dwordx4 v[140:143], v2, s[16:19], s48 offen sc1
    s_xor_b32 s48, s48, 1024
    v_mfma_f32_16x16x32_bf16 v[200:203], v[48:51], v[104:107], v[200:203]
    v_mfma_f32_16x16x32_bf16 v[204:207], v[52:55], v[104:107], v[204:207]
    ds_read_b64_tr_b16 v[40:41], v20 offset:32768
    ds_read_b64_tr_b16 v[42:43], v20 offset:40960
    ds_read_b64_tr_b16 v[44:45], v21 offset:32768
    ds_read_b64_tr_b16 v[46:47], v21 offset:40960
    v_mfma_f32_16x16x32_bf16 v[232:235], v[48:51], v[108:111], v[232:235]
    v_mfma_f32_16x16x32_bf16 v[236:239], v[52:55], v[108:111], v[236:239]
    s_add_u32 m0, s49, 16384
    s_add_u32 s28, s54, 14336
    buffer_load_dwordx4 v14, s[32:35], s28 offen lds
    s_add_u32 m0, s49, 17408
    s_add_u32 s28, s54, 21504
    buffer_load_dwordx4 v14, s[32:35], s28 offen lds
    s_add_u32 s50, s50, 114688
    s_cmp_eq_u32 s50, 688128
    s_cselect_b32 s50, 0, s50
    v_mfma_f32_16x16x32_bf16 v[208:211], v[48:51], v[112:115], v[208:211]
    v_mfma_f32_16x16x32_bf16 v[212:215], v[52:55], v[112:115], v[212:215]
    s_add_u32 m0, s49, 4294934528
    s_add_u32 s28, s99, s41
    buffer_load_dwordx4 v2, s[16:19], s28 offen offset:0 sc1 lds
    s_add_u32 m0, s49, 4294934528
    s_add_u32 s28, s99, s41
    buffer_load_dwordx4 v2, s[16:19], s28 offen offset:1024 sc1 lds
    s_add_u32 m0, s49, 4294940672
    s_add_u32 s28, s99, s41
    buffer_load_dwordx4 v2, s[16:19], s28 offen offset:2048 sc1 lds
    s_add_u32 m0, s49, 4294940672
    s_add_u32 s28, s99, s41
    buffer_load_dwordx4 v2, s[16:19], s28 offen offset:3072 sc1 lds
    s_add_u32 s41, s41, 4096
    s_and_b32 s41, s41, 0xffff
    v_mfma_f32_16x16x32_bf16 v[240:243], v[48:51], v[116:119], v[240:243]
    v_mfma_f32_16x16x32_bf16 v[244:247], v[52:55], v[116:119], v[244:247]
    buffer_load_dwordx4 v[144:147], v2, s[16:19], s55 offen sc1
    buffer_load_dwordx4 v[148:151], v2, s[16:19], s48 offen sc1
    s_add_u32 s52, s52, 8192
    s_cmp_eq_u32 s52, 49152
    s_cselect_b32 s52, 0, s52
    s_waitcnt vmcnt(20)
    s_waitcnt lgkmcnt(0)
    v_mfma_f32_16x16x32_bf16 v[184:187], v[40:43], v[120:123], v[184:187]
    v_mfma_f32_16x16x32_bf16 v[188:191], v[44:47], v[120:123], v[188:191]
    ds_read_b64_tr_b16 v[48:49], v22 offset:32768
    ds_read_b64_tr_b16 v[50:51], v22 offset:40960
    ds_read_b64_tr_b16 v[52:53], v23 offset:32768
    ds_read_b64_tr_b16 v[54:55], v23 offset:40960
    v_mfma_f32_16x16x32_bf16 v[216:219], v[40:43], v[124:127], v[216:219]
    v_mfma_f32_16x16x32_bf16 v[220:223], v[44:47], v[124:127], v[220:223]
    s_add_u32 m0, s49, 24576
    s_cmp_ge_u32 s50, s8
    s_cselect_b32 s54, 114688, 0
    s_add_u32 s54, s54, s50
    s_add_u32 s54, s54, s51
    s_add_u32 s28, s54, 0
    buffer_load_dwordx4 v14, s[32:35], s28 offen lds
    s_add_u32 m0, s49, 25600
    s_add_u32 s28, s54, 7168
    buffer_load_dwordx4 v14, s[32:35], s28 offen lds
    s_waitcnt vmcnt(20)
    v_mfma_f32_16x16x32_bf16 v[192:195], v[40:43], v[128:131], v[192:195]
    v_mfma_f32_16x16x32_bf16 v[196:199], v[44:47], v[128:131], v[196:199]
    s_add_u32 m0, s49, 4294950912
    s_add_u32 s28, s99, s41
    buffer_load_dwordx4 v2, s[16:19], s28 offen offset:0 sc1 lds
    s_add_u32 m0, s49, 4294950912
    s_add_u32 s28, s99, s41
    buffer_load_dwordx4 v2, s[16:19], s28 offen offset:1024 sc1 lds
    s_add_u32 m0, s49, 4294957056
    s_add_u32 s28, s99, s41
    buffer_load_dwordx4 v2, s[16:19], s28 offen offset:2048 sc1 lds
    s_add_u32 m0, s49, 4294957056
    s_add_u32 s28, s99, s41
    buffer_load_dwordx4 v2, s[16:19], s28 offen offset:3072 sc1 lds
    s_add_u32 s41, s41, 4096
    s_and_b32 s41, s41, 0xffff
    v_mfma_f32_16x16x32_bf16 v[224:227], v[40:43], v[132:135], v[224:227]
    v_mfma_f32_16x16x32_bf16 v[228:231], v[44:47], v[132:135], v[228:231]
    s_bitcmp1_b32 s42, 4
    s_cbranch_scc1 Fh_w4
Fh_ok4:
    s_cmp_ge_u32 s52, s9
    s_cselect_b32 s55, 8192, 0
    s_add_u32 s55, s55, s52
    s_add_u32 s55, s55, s53
    s_add_u32 s48, s55, 147456
    buffer_load_dwordx4 v[152:155], v2, s[16:19], s55 offen sc1
    s_xor_b32 s55, s55, 1024
    buffer_load_dwordx4 v[156:159], v2, s[16:19], s48 offen sc1
    s_xor_b32 s48, s48, 1024
    s_waitcnt vmcnt(24)
    s_waitcnt lgkmcnt(0)
    v_mfma_f32_16x16x32_bf16 v[200:203], v[48:51], v[120:123], v[200:203]
    v_mfma_f32_16x16x32_bf16 v[204:207], v[52:55], v[120:123], v[204:207]
    ds_read_b64_tr_b16 v[40:41], v20 offset:49152
    ds_read_b64_tr_b16 v[42:43], v20 offset:0
    ds_read_b64_tr_b16 v[44:45], v21 offset:49152
    ds_read_b64_tr_b16 v[46:47], v21 offset:0
    v_mfma_f32_16x16x32_bf16 v[232:235], v[48:51], v[124:127], v[232:235]
F_pgG2_2:
    s_cbranch_execz F_ret
    v_mfma_f32_16x16x32_bf16 v[236:239], v[52:55], v[124:127], v[236:239]
    s_add_u32 m0, s49, 32768
    s_add_u32 s28, s54, 14336
    buffer_load_dwordx4 v14, s[32:35], s28 offen lds
    s_add_u32 m0, s49, 33792
    s_add_u32 s28, s54, 21504
    buffer_load_dwordx4 v14, s[32:35], s28 offen lds
    s_add_u32 s50, s50, 114688
    s_cmp_eq_u32 s50, 688128
    s_cselect_b32 s50, 0, s50
    v_mfma_f32_16x16x32_bf16 v[208:211], v[48:51], v[128:131], v[208:211]
    v_mfma_f32_16x16x32_bf16 v[212:215], v[52:55], v[128:131], v[212:215]
    ds_read_b32 v10, v8 offset:1024
    s_setprio 3
    s_waitcnt lgkmcnt(0)
    v_cmp_gt_u32 vcc, 4, v10
    s_cbranch_vccnz F_fs15
F_fs15_ok:
    s_setprio 0
    s_add_u32 m0, s49, 57344
    s_lshl2_add_u32 s100, s3, s93
    s_mul_i32 s100, s100, 50176
    s_add_u32 s28, s100, 0
    buffer_load_dwordx4 v14, s[36:39], s28 offen lds
    v_mfma_f32_16x16x32_bf16 v[240:243], v[48:51], v[132:135], v[240:243]
    v_mfma_f32_16x16x32_bf16 v[244:247], v[52:55], v[132:135], v[244:247]
    buffer_load_dwordx4 v[160:163], v2, s[16:19], s55 offen sc1
    buffer_load_dwordx4 v[164:167], v2, s[16:19], s48 offen sc1
    s_add_u32 s52, s52, 8192
    s_cmp_eq_u32 s52, 49152
    s_cselect_b32 s52, 0, s52
    ds_write_b32 v18, v24 offset:0
    ds_write_b32 v18, v15 offset:4
    ds_write_b32 v18, v13 offset:8
    s_waitcnt vmcnt(21)
    v_mfma_f32_16x16x32_bf16 v[184:187], v[40:43], v[136:139], v[184:187]
    v_mfma_f32_16x16x32_bf16 v[188:191], v[44:47], v[136:139], v[188:191]
    ds_read_b64_tr_b16 v[48:49], v22 offset:49152
    ds_read_b64_tr_b16 v[50:51], v22 offset:0
    ds_read_b64_tr_b16 v[52:53], v23 offset:49152
    ds_read_b64_tr_b16 v[54:55], v23 offset:0
    s_mov_b32 exec_hi, 0
    s_mov_b32 exec_lo, 16256
    buffer_load_dword v17, v16, s[16:19], s40 offen sc1
    s_mov_b64 exec, -1
    v_mfma_f32_16x16x32_bf16 v[216:219], v[40:43], v[140:143], v[216:219]
    v_mfma_f32_16x16x32_bf16 v[220:223], v[44:47], v[140:143], v[220:223]
    s_add_u32 m0, s49, 40960
    s_cmp_ge_u32 s50, s8
    s_cselect_b32 s54, 114688, 0
    s_add_u32 s54, s54, s50
    s_add_u32 s54, s54, s51
    s_add_u32 s28, s54, 0
    buffer_load_dwordx4 v14, s[32:35], s28 offen lds
    s_add_u32 m0, s49, 41984
    s_add_u32 s28, s54, 7168
    buffer_load_dwordx4 v14, s[32:35], s28 offen lds
    s_waitcnt vmcnt(16)
    v_mfma_f32_16x16x32_bf16 v[192:195], v[40:43], v[144:147], v[192:195]
    v_mfma_f32_16x16x32_bf16 v[196:199], v[44:47], v[144:147], v[196:199]
    s_add_u32 m0, s49, 58368
    s_add_u32 s28, s100, 14336
    buffer_load_dwordx4 v14, s[36:39], s28 offen lds
    v_mfma_f32_16x16x32_bf16 v[224:227], v[40:43], v[148:151], v[224:227]
    v_mfma_f32_16x16x32_bf16 v[228:231], v[44:47], v[148:151], v[228:231]
    s_bitcmp1_b32 s42, 5
    s_cbranch_scc1 Fh_w5
Fh_ok5:
    s_cmp_ge_u32 s52, s9
    s_cselect_b32 s55, 8192, 0
    s_add_u32 s55, s55, s52
    s_add_u32 s55, s55, s53
    s_add_u32 s48, s55, 147456
    buffer_load_dwordx4 v[168:171], v2, s[16:19], s55 offen sc1
    s_xor_b32 s55, s55, 1024
    buffer_load_dwordx4 v[172:175], v2, s[16:19], s48 offen sc1
    s_xor_b32 s48, s48, 1024
    s_waitcnt lgkmcnt(0)
    v_mfma_f32_16x16x32_bf16 v[200:203], v[48:51], v[136:139], v[200:203]
    v_mfma_f32_16x16x32_bf16 v[204:207], v[52:55], v[136:139], v[204:207]
    ds_read_b64_tr_b16 v[40:41], v20 offset:8192
    ds_read_b64_tr_b16 v[42:43], v20 offset:16384
    ds_read_b64_tr_b16 v[44:45], v21 offset:8192
    ds_read_b64_tr_b16 v[46:47], v21 offset:16384
    v_mfma_f32_16x16x32_bf16 v[232:235], v[48:51], v[140:143], v[232:235]
    v_mfma_f32_16x16x32_bf16 v[236:239], v[52:55], v[140:143], v[236:239]
    s_add_u32 m0, s49, 49152
    s_add_u32 s28, s54, 14336
    buffer_load_dwordx4 v14, s[32:35], s28 offen lds
    s_add_u32 m0, s49, 50176
    s_add_u32 s28, s54, 21504
    buffer_load_dwordx4 v14, s[32:35], s28 offen lds
    s_mov_b32 s50, s10
    v_mfma_f32_16x16x32_bf16 v[208:211], v[48:51], v[144:147], v[208:211]
    v_mfma_f32_16x16x32_bf16 v[212:215], v[52:55], v[144:147], v[212:215]
    s_add_u32 m0, s49, 65536
    s_add_u32 s28, s100, 7168
    buffer_load_dwordx4 v14, s[36:39], s28 offen lds
    v_mfma_f32_16x16x32_bf16 v[240:243], v[48:51], v[148:151], v[240:243]
    v_mfma_f32_16x16x32_bf16 v[244:247], v[52:55], v[148:151], v[244:247]
    buffer_load_dwordx4 v[176:179], v2, s[16:19], s55 offen sc1
    buffer_load_dwordx4 v[180:183], v2, s[16:19], s48 offen sc1
    s_add_u32 s52, s52, 8192
    s_cmp_eq_u32 s52, 49152
    s_cselect_b32 s52, 0, s52
    s_waitcnt vmcnt(16)
    ds_add_u32 v8, v7
    s_waitcnt lgkmcnt(1)
    v_mfma_f32_16x16x32_bf16 v[184:187], v[40:43], v[152:155], v[184:187]
    v_mfma_f32_16x16x32_bf16 v[188:191], v[44:47], v[152:155], v[188:191]
    ds_read_b64_tr_b16 v[48:49], v22 offset:8192
    ds_read_b64_tr_b16 v[50:51], v22 offset:16384
    ds_read_b64_tr_b16 v[52:53], v23 offset:8192
    ds_read_b64_tr_b16 v[54:55], v23 offset:16384
    v_mfma_f32_16x16x32_bf16 v[216:219], v[40:43], v[156:159], v[216:219]
F_pgG2_3:
    s_cbranch_execz F_ret
    v_mfma_f32_16x16x32_bf16 v[220:223], v[44:47], v[156:159], v[220:223]
    s_add_u32 m0, s49, 0
    s_add_u32 s54, s96, s50
    s_add_u32 s28, s54, 0
    buffer_load_dwordx4 v14, s[32:35], s28 offen lds
    s_add_u32 m0, s49, 1024
    s_add_u32 s28, s54, 7168
    buffer_load_dwordx4 v14, s[32:35], s28 offen lds
    s_waitcnt vmcnt(13)
    v_mfma_f32_16x16x32_bf16 v[192:195], v[40:43], v[160:163], v[192:195]
    v_mfma_f32_16x16x32_bf16 v[196:199], v[44:47], v[160:163], v[196:199]
    s_add_u32 m0, s49, 66560
    s_add_u32 s28, s100, 21504
    buffer_load_dwordx4 v14, s[36:39], s28 offen lds
    v_mfma_f32_16x16x32_bf16 v[224:227], v[40:43], v[164:167], v[224:227]
    v_mfma_f32_16x16x32_bf16 v[228:231], v[44:47], v[164:167], v[228:231]
    s_bitcmp1_b32 s42, 6
    s_cbranch_scc1 Fh_w6
Fh_ok6:
    s_cmp_ge_u32 s52, s9
    s_cselect_b32 s55, 8192, 0
    s_add_u32 s55, s55, s52
    s_add_u32 s55, s55, s53
    s_add_u32 s48, s55, 147456
    buffer_load_dwordx4 v[88:91], v2, s[16:19], s55 offen sc1
    s_xor_b32 s55, s55, 1024
    buffer_load_dwordx4 v[92:95], v2, s[16:19], s48 offen sc1
    s_xor_b32 s48, s48, 1024
    s_waitcnt lgkmcnt(0)
    v_mfma_f32_16x16x32_bf16 v[200:203], v[48:51], v[152:155], v[200:203]
    v_mfma_f32_16x16x32_bf16 v[204:207], v[52:55], v[152:155], v[204:207]
    ds_read_b64_tr_b16 v[40:41], v20 offset:24576
    ds_read_b64_tr_b16 v[42:43], v20 offset:32768
    ds_read_b64_tr_b16 v[44:45], v21 offset:24576
    ds_read_b64_tr_b16 v[46:47], v21 offset:32768
    v_mfma_f32_16x16x32_bf16 v[232:235], v[48:51], v[156:159], v[232:235]
    v_mfma_f32_16x16x32_bf16 v[236:239], v[52:55], v[156:159], v[236:239]
    s_add_u32 m0, s49, 8192
    s_add_u32 s28, s54, 14336
    buffer_load_dwordx4 v14, s[32:35], s28 offen lds
    s_add_u32 m0, s49, 9216
    s_add_u32 s28, s54, 21504
    buffer_load_dwordx4 v14, s[32:35], s28 offen lds
    s_add_u32 s50, s50, 114688
    s_cmp_eq_u32 s50, 802816
    s_cselect_b32 s50, 0, s50
    v_mfma_f32_16x16x32_bf16 v[208:211], v[48:51], v[160:163], v[208:211]
    v_mfma_f32_16x16x32_bf16 v[212:215], v[52:55], v[160:163], v[212:215]
    s_add_u32 m0, s49, 73728
    s_add_u32 s28, s100, 25088
    buffer_load_dwordx4 v14, s[36:39], s28 offen lds
    v_mfma_f32_16x16x32_bf16 v[240:243], v[48:51], v[164:167], v[240:243]
    v_mfma_f32_16x16x32_bf16 v[244:247], v[52:55], v[164:167], v[244:247]
    buffer_load_dwordx4 v[96:99], v2, s[16:19], s55 offen sc1
    buffer_load_dwordx4 v[100:103], v2, s[16:19], s48 offen sc1
    s_mov_b32 s52, s11
    s_setprio 3
    s_waitcnt vmcnt(20)
    v_cmp_ne_u32 s[42:43], 1, v17
    s_setprio 0
    s_waitcnt vmcnt(15)
    s_waitcnt lgkmcnt(0)
    v_mfma_f32_16x16x32_bf16 v[184:187], v[40:43], v[168:171], v[184:187]
    v_mfma_f32_16x16x32_bf16 v[188:191], v[44:47], v[168:171], v[188:191]
    ds_read_b64_tr_b16 v[48:49], v22 offset:24576
    ds_read_b64_tr_b16 v[50:51], v22 offset:32768
    ds_read_b64_tr_b16 v[52:53], v23 offset:24576
    ds_read_b64_tr_b16 v[54:55], v23 offset:32768
    v_mfma_f32_16x16x32_bf16 v[216:219], v[40:43], v[172:175], v[216:219]
    v_mfma_f32_16x16x32_bf16 v[220:223], v[44:47], v[172:175], v[220:223]
    s_add_u32 m0, s49, 16384
    s_add_u32 s54, s96, s50
    s_add_u32 s28, s54, 0
    buffer_load_dwordx4 v14, s[32:35], s28 offen lds
    s_add_u32 m0, s49, 17408
    s_add_u32 s28, s54, 7168
    buffer_load_dwordx4 v14, s[32:35], s28 offen lds
    s_waitcnt vmcnt(12)
    v_mfma_f32_16x16x32_bf16 v[192:195], v[40:43], v[176:179], v[192:195]
    v_mfma_f32_16x16x32_bf16 v[196:199], v[44:47], v[176:179], v[196:199]
    s_add_u32 m0, s49, 74752
    s_add_u32 s28, s100, 39424
    buffer_load_dwordx4 v14, s[36:39], s28 offen lds
    v_mfma_f32_16x16x32_bf16 v[224:227], v[40:43], v[180:183], v[224:227]
    v_mfma_f32_16x16x32_bf16 v[228:231], v[44:47], v[180:183], v[228:231]
    s_bitcmp1_b32 s42, 7
    s_cbranch_scc1 Fh_w7
Fh_ok7:
    s_add_u32 s55, s97, s52
    s_add_u32 s48, s55, 147456
    buffer_load_dwordx4 v[104:107], v2, s[16:19], s55 offen sc1
    s_xor_b32 s55, s55, 1024
    buffer_load_dwordx4 v[108:111], v2, s[16:19], s48 offen sc1
    s_xor_b32 s48, s48, 1024
    s_waitcnt lgkmcnt(0)
    v_mfma_f32_16x16x32_bf16 v[200:203], v[48:51], v[168:171], v[200:203]
    v_mfma_f32_16x16x32_bf16 v[204:207], v[52:55], v[168:171], v[204:207]
    ds_read_b64_tr_b16 v[40:41], v20 offset:40960
    ds_read_b64_tr_b16 v[42:43], v20 offset:49152
    ds_read_b64_tr_b16 v[44:45], v21 offset:40960
    ds_read_b64_tr_b16 v[46:47], v21 offset:49152
    v_mfma_f32_16x16x32_bf16 v[232:235], v[48:51], v[172:175], v[232:235]
    v_mfma_f32_16x16x32_bf16 v[236:239], v[52:55], v[172:175], v[236:239]
    s_add_u32 m0, s49, 24576
    s_add_u32 s28, s54, 14336
    buffer_load_dwordx4 v14, s[32:35], s28 offen lds
    s_add_u32 m0, s49, 25600
    s_add_u32 s28, s54, 21504
    buffer_load_dwordx4 v14, s[32:35], s28 offen lds
    s_add_u32 s50, s50, 114688
    s_cmp_eq_u32 s50, 802816
    s_cselect_b32 s50, 0, s50
    v_mfma_f32_16x16x32_bf16 v[208:211], v[48:51], v[176:179], v[208:211]
    v_mfma_f32_16x16x32_bf16 v[212:215], v[52:55], v[176:179], v[212:215]
    s_add_u32 m0, s49, 81920
    s_add_u32 s28, s100, 32256
    buffer_load_dwordx4 v14, s[36:39], s28 offen lds
    v_mfma_f32_16x16x32_bf16 v[240:243], v[48:51], v[180:183], v[240:243]
    v_mfma_f32_16x16x32_bf16 v[244:247], v[52:55], v[180:183], v[244:247]
    buffer_load_dwordx4 v[112:115], v2, s[16:19], s55 offen sc1
    buffer_load_dwordx4 v[116:119], v2, s[16:19], s48 offen sc1
    s_add_u32 s52, s52, 8192
    s_cmp_eq_u32 s52, 57344
    s_cselect_b32 s52, 0, s52
    s_waitcnt vmcnt(15)
    s_waitcnt lgkmcnt(0)
    v_mfma_f32_16x16x32_bf16 v[184:187], v[40:43], v[88:91], v[184:187]
    v_mfma_f32_16x16x32_bf16 v[188:191], v[44:47], v[88:91], v[188:191]
    ds_read_b64_tr_b16 v[48:49], v22 offset:40960
    ds_read_b64_tr_b16 v[50:51], v22 offset:49152
    ds_read_b64_tr_b16 v[52:53], v23 offset:40960
    ds_read_b64_tr_b16 v[54:55], v23 offset:49152
    v_mfma_f32_16x16x32_bf16 v[216:219], v[40:43], v[92:95], v[216:219]
    v_mfma_f32_16x16x32_bf16 v[220:223], v[44:47], v[92:95], v[220:223]
    s_add_u32 m0, s49, 32768
    s_add_u32 s54, s96, s50
    s_add_u32 s28, s54, 0
    buffer_load_dwordx4 v14, s[32:35], s28 offen lds
    s_add_u32 m0, s49, 33792
    s_add_u32 s28, s54, 7168
    buffer_load_dwordx4 v14, s[32:35], s28 offen lds
    s_waitcnt vmcnt(12)
    v_mfma_f32_16x16x32_bf16 v[192:195], v[40:43], v[96:99], v[192:195]
    v_mfma_f32_16x16x32_bf16 v[196:199], v[44:47], v[96:99], v[196:199]
    s_add_u32 m0, s49, 82944
    s_add_u32 s28, s100, 46592
    buffer_load_dwordx4 v14, s[36:39], s28 offen lds
    v_mfma_f32_16x16x32_bf16 v[224:227], v[40:43], v[100:103], v[224:227]
    v_mfma_f32_16x16x32_bf16 v[228:231], v[44:47], v[100:103], v[228:231]
    s_bitcmp1_b32 s42, 8
    s_cbranch_scc1 Fh_w8
Fh_ok8:
    s_add_u32 s55, s97, s52
    s_add_u32 s48, s55, 147456
    buffer_load_dwordx4 v[120:123], v2, s[16:19], s55 offen sc1
    s_xor_b32 s55, s55, 1024
    buffer_load_dwordx4 v[124:127], v2, s[16:19], s48 offen sc1
    s_xor_b32 s48, s48, 1024
    s_waitcnt lgkmcnt(0)
    v_mfma_f32_16x16x32_bf16 v[200:203], v[48:51], v[88:91], v[200:203]
F_pgG2_4:
    s_cbranch_execz F_ret
    v_mfma_f32_16x16x32_bf16 v[204:207], v[52:55], v[88:91], v[204:207]
    ds_read_b64_tr_b16 v[40:41], v20 offset:0
    ds_read_b64_tr_b16 v[42:43], v20 offset:8192
    ds_read_b64_tr_b16 v[44:45], v21 offset:0
    ds_read_b64_tr_b16 v[46:47], v21 offset:8192
    v_mfma_f32_16x16x32_bf16 v[232:235], v[48:51], v[92:95], v[232:235]
    v_mfma_f32_16x16x32_bf16 v[236:239], v[52:55], v[92:95], v[236:239]
    s_add_u32 m0, s49, 40960
    s_add_u32 s28, s54, 14336
    buffer_load_dwordx4 v14, s[32:35], s28 offen lds
    s_add_u32 m0, s49, 41984
    s_add_u32 s28, s54, 21504
    buffer_load_dwordx4 v14, s[32:35], s28 offen lds
    s_add_u32 s50, s50, 114688
    s_cmp_eq_u32 s50, 802816
    s_cselect_b32 s50, 0, s50
    v_mfma_f32_16x16x32_bf16 v[208:211], v[48:51], v[96:99], v[208:211]
    v_mfma_f32_16x16x32_bf16 v[212:215], v[52:55], v[96:99], v[212:215]
    s_add_u32 m0, s49, 90112
    s_lshl2_add_u32 s100, s3, s93
    s_xor_b32 s100, s100, 4
    s_mul_i32 s100, s100, 50176
    s_add_u32 s28, s100, 0
    buffer_load_dwordx4 v14, s[36:39], s28 offen lds
    v_mfma_f32_16x16x32_bf16 v[240:243], v[48:51], v[100:103], v[240:243]
    v_mfma_f32_16x16x32_bf16 v[244:247], v[52:55], v[100:103], v[244:247]
    buffer_load_dwordx4 v[128:131], v2, s[16:19], s55 offen sc1
    buffer_load_dwordx4 v[132:135], v2, s[16:19], s48 offen sc1
    s_add_u32 s52, s52, 8192
    s_cmp_eq_u32 s52, 57344
    s_cselect_b32 s52, 0, s52
    s_waitcnt vmcnt(15)
    s_waitcnt lgkmcnt(0)
    v_mfma_f32_16x16x32_bf16 v[184:187], v[40:43], v[104:107], v[184:187]
    v_mfma_f32_16x16x32_bf16 v[188:191], v[44:47], v[104:107], v[188:191]
    ds_read_b64_tr_b16 v[48:49], v22 offset:0
    ds_read_b64_tr_b16 v[50:51], v22 offset:8192
    ds_read_b64_tr_b16 v[52:53], v23 offset:0
    ds_read_b64_tr_b16 v[54:55], v23 offset:8192
    v_mfma_f32_16x16x32_bf16 v[216:219], v[40:43], v[108:111], v[216:219]
    v_mfma_f32_16x16x32_bf16 v[220:223], v[44:47], v[108:111], v[220:223]
    s_add_u32 m0, s49, 49152
    s_add_u32 s54, s96, s50
    s_add_u32 s28, s54, 0
    buffer_load_dwordx4 v14, s[32:35], s28 offen lds
    s_add_u32 m0, s49, 50176
    s_add_u32 s28, s54, 7168
    buffer_load_dwordx4 v14, s[32:35], s28 offen lds
    s_waitcnt vmcnt(12)
    v_mfma_f32_16x16x32_bf16 v[192:195], v[40:43], v[112:115], v[192:195]
    v_mfma_f32_16x16x32_bf16 v[196:199], v[44:47], v[112:115], v[196:199]
    s_add_u32 m0, s49, 91136
    s_add_u32 s28, s100, 14336
    buffer_load_dwordx4 v14, s[36:39], s28 offen lds
    v_mfma_f32_16x16x32_bf16 v[224:227], v[40:43], v[116:119], v[224:227]
    v_mfma_f32_16x16x32_bf16 v[228:231], v[44:47], v[116:119], v[228:231]
    s_bitcmp1_b32 s42, 9
    s_cbranch_scc1 Fh_w9
Fh_ok9:
    s_add_u32 s55, s97, s52
    s_add_u32 s48, s55, 147456
    buffer_load_dwordx4 v[136:139], v2, s[16:19], s55 offen sc1
    s_xor_b32 s55, s55, 1024
    buffer_load_dwordx4 v[140:143], v2, s[16:19], s48 offen sc1
    s_xor_b32 s48, s48, 1024
    s_waitcnt lgkmcnt(0)
    v_mfma_f32_16x16x32_bf16 v[200:203], v[48:51], v[104:107], v[200:203]
    v_mfma_f32_16x16x32_bf16 v[204:207], v[52:55], v[104:107], v[204:207]
    ds_read_b64_tr_b16 v[40:41], v20 offset:16384
    ds_read_b64_tr_b16 v[42:43], v20 offset:24576
    ds_read_b64_tr_b16 v[44:45], v21 offset:16384
    ds_read_b64_tr_b16 v[46:47], v21 offset:24576
    v_mfma_f32_16x16x32_bf16 v[232:235], v[48:51], v[108:111], v[232:235]
    v_mfma_f32_16x16x32_bf16 v[236:239], v[52:55], v[108:111], v[236:239]
    s_add_u32 m0, s49, 0
    s_add_u32 s28, s54, 14336
    buffer_load_dwordx4 v14, s[32:35], s28 offen lds
    s_add_u32 m0, s49, 1024
    s_add_u32 s28, s54, 21504
    buffer_load_dwordx4 v14, s[32:35], s28 offen lds
    s_add_u32 s50, s50, 114688
    s_cmp_eq_u32 s50, 802816
    s_cselect_b32 s50, 0, s50
    v_mfma_f32_16x16x32_bf16 v[208:211], v[48:51], v[112:115], v[208:211]
    v_mfma_f32_16x16x32_bf16 v[212:215], v[52:55], v[112:115], v[212:215]
    s_add_u32 m0, s49, 98304
    s_add_u32 s28, s100, 7168
    buffer_load_dwordx4 v14, s[36:39], s28 offen lds
    v_mfma_f32_16x16x32_bf16 v[240:243], v[48:51], v[116:119], v[240:243]
    v_mfma_f32_16x16x32_bf16 v[244:247], v[52:55], v[116:119], v[244:247]
    buffer_load_dwordx4 v[144:147], v2, s[16:19], s55 offen sc1
    buffer_load_dwordx4 v[148:151], v2, s[16:19], s48 offen sc1
    s_add_u32 s52, s52, 8192
    s_cmp_eq_u32 s52, 57344
    s_cselect_b32 s52, 0, s52
    s_waitcnt vmcnt(15)
    s_waitcnt lgkmcnt(0)
    v_mfma_f32_16x16x32_bf16 v[184:187], v[40:43], v[120:123], v[184:187]
    v_mfma_f32_16x16x32_bf16 v[188:191], v[44:47], v[120:123], v[188:191]
    ds_read_b64_tr_b16 v[48:49], v22 offset:16384
    ds_read_b64_tr_b16 v[50:51], v22 offset:24576
    ds_read_b64_tr_b16 v[52:53], v23 offset:16384
    ds_read_b64_tr_b16 v[54:55], v23 offset:24576
    v_mfma_f32_16x16x32_bf16 v[216:219], v[40:43], v[124:127], v[216:219]
    v_mfma_f32_16x16x32_bf16 v[220:223], v[44:47], v[124:127], v[220:223]
    s_add_u32 m0, s49, 8192
    s_add_u32 s54, s96, s50
    s_add_u32 s28, s54, 0
    buffer_load_dwordx4 v14, s[32:35], s28 offen lds
    s_add_u32 m0, s49, 9216
    s_add_u32 s28, s54, 7168
    buffer_load_dwordx4 v14, s[32:35], s28 offen lds
    s_waitcnt vmcnt(12)
    v_mfma_f32_16x16x32_bf16 v[192:195], v[40:43], v[128:131], v[192:195]
    v_mfma_f32_16x16x32_bf16 v[196:199], v[44:47], v[128:131], v[196:199]
    s_add_u32 m0, s49, 99328
    s_add_u32 s28, s100, 21504
    buffer_load_dwordx4 v14, s[36:39], s28 offen lds
    v_mfma_f32_16x16x32_bf16 v[224:227], v[40:43], v[132:135], v[224:227]
    v_mfma_f32_16x16x32_bf16 v[228:231], v[44:47], v[132:135], v[228:231]
    s_bitcmp1_b32 s42, 10
    s_cbranch_scc1 Fh_w10
Fh_ok10:
    s_add_u32 s55, s97, s52
    s_add_u32 s48, s55, 147456
    buffer_load_dwordx4 v[152:155], v2, s[16:19], s55 offen sc1
    s_xor_b32 s55, s55, 1024
    buffer_load_dwordx4 v[156:159], v2, s[16:19], s48 offen sc1
    s_xor_b32 s48, s48, 1024
    s_waitcnt lgkmcnt(0)
    v_mfma_f32_16x16x32_bf16 v[200:203], v[48:51], v[120:123], v[200:203]
    v_mfma_f32_16x16x32_bf16 v[204:207], v[52:55], v[120:123], v[204:207]
    ds_read_b64_tr_b16 v[40:41], v20 offset:32768
    ds_read_b64_tr_b16 v[42:43], v20 offset:40960
    ds_read_b64_tr_b16 v[44:45], v21 offset:32768
    ds_read_b64_tr_b16 v[46:47], v21 offset:40960
    v_mfma_f32_16x16x32_bf16 v[232:235], v[48:51], v[124:127], v[232:235]
    v_mfma_f32_16x16x32_bf16 v[236:239], v[52:55], v[124:127], v[236:239]
    s_add_u32 m0, s49, 16384
    s_add_u32 s28, s54, 14336
    buffer_load_dwordx4 v14, s[32:35], s28 offen lds
    s_add_u32 m0, s49, 17408
    s_add_u32 s28, s54, 21504
    buffer_load_dwordx4 v14, s[32:35], s28 offen lds
    s_add_u32 s50, s50, 114688
    s_cmp_eq_u32 s50, 802816
    s_cselect_b32 s50, 0, s50
    v_mfma_f32_16x16x32_bf16 v[208:211], v[48:51], v[128:131], v[208:211]
F_pgG2_5:
    s_cbranch_execz F_ret
    v_mfma_f32_16x16x32_bf16 v[212:215], v[52:55], v[128:131], v[212:215]
    ds_read_b32 v10, v8 offset:1024
    s_setprio 3
    s_waitcnt lgkmcnt(0)
    v_cmp_gt_u32 vcc, 5, v10
    s_cbranch_vccnz F_fs16
F_fs16_ok:
    s_setprio 0
    s_add_u32 m0, s49, 106496
    s_add_u32 s28, s100, 25088
    buffer_load_dwordx4 v14, s[36:39], s28 offen lds
    v_mfma_f32_16x16x32_bf16 v[240:243], v[48:51], v[132:135], v[240:243]
    v_mfma_f32_16x16x32_bf16 v[244:247], v[52:55], v[132:135], v[244:247]
    buffer_load_dwordx4 v[160:163], v2, s[16:19], s55 offen sc1
    buffer_load_dwordx4 v[164:167], v2, s[16:19], s48 offen sc1
    s_add_u32 s52, s52, 8192
    s_cmp_eq_u32 s52, 57344
    s_cselect_b32 s52, 0, s52
    s_waitcnt vmcnt(15)
    v_mfma_f32_16x16x32_bf16 v[184:187], v[40:43], v[136:139], v[184:187]
    v_mfma_f32_16x16x32_bf16 v[188:191], v[44:47], v[136:139], v[188:191]
    ds_read_b64_tr_b16 v[48:49], v22 offset:32768
    ds_read_b64_tr_b16 v[50:51], v22 offset:40960
    ds_read_b64_tr_b16 v[52:53], v23 offset:32768
    ds_read_b64_tr_b16 v[54:55], v23 offset:40960
    v_mfma_f32_16x16x32_bf16 v[216:219], v[40:43], v[140:143], v[216:219]
    v_mfma_f32_16x16x32_bf16 v[220:223], v[44:47], v[140:143], v[220:223]
    s_add_u32 m0, s49, 24576
    s_add_u32 s54, s96, s50
    s_add_u32 s28, s54, 0
    buffer_load_dwordx4 v14, s[32:35], s28 offen lds
    s_add_u32 m0, s49, 25600
    s_add_u32 s28, s54, 7168
    buffer_load_dwordx4 v14, s[32:35], s28 offen lds
    s_waitcnt vmcnt(12)
    v_mfma_f32_16x16x32_bf16 v[192:195], v[40:43], v[144:147], v[192:195]
    v_mfma_f32_16x16x32_bf16 v[196:199], v[44:47], v[144:147], v[196:199]
    s_add_u32 m0, s49, 107520
    s_add_u32 s28, s100, 39424
    buffer_load_dwordx4 v14, s[36:39], s28 offen lds
    v_mfma_f32_16x16x32_bf16 v[224:227], v[40:43], v[148:151], v[224:227]
    v_mfma_f32_16x16x32_bf16 v[228:231], v[44:47], v[148:151], v[228:231]
    s_bitcmp1_b32 s42, 11
    s_cbranch_scc1 Fh_w11
Fh_ok11:
    s_add_u32 s55, s97, s52
    s_add_u32 s48, s55, 147456
    buffer_load_dwordx4 v[168:171], v2, s[16:19], s55 offen sc1
    s_xor_b32 s55, s55, 1024
    buffer_load_dwordx4 v[172:175], v2, s[16:19], s48 offen sc1
    s_xor_b32 s48, s48, 1024
    s_waitcnt lgkmcnt(0)
    v_mfma_f32_16x16x32_bf16 v[200:203], v[48:51], v[136:139], v[200:203]
    v_mfma_f32_16x16x32_bf16 v[204:207], v[52:55], v[136:139], v[204:207]
    ds_read_b64_tr_b16 v[40:41], v20 offset:49152
    ds_read_b64_tr_b16 v[42:43], v20 offset:0
    ds_read_b64_tr_b16 v[44:45], v21 offset:49152
    ds_read_b64_tr_b16 v[46:47], v21 offset:0
    v_mfma_f32_16x16x32_bf16 v[232:235], v[48:51], v[140:143], v[232:235]
    v_mfma_f32_16x16x32_bf16 v[236:239], v[52:55], v[140:143], v[236:239]
    s_add_u32 m0, s49, 32768
    s_add_u32 s28, s54, 14336
    buffer_load_dwordx4 v14, s[32:35], s28 offen lds
    s_add_u32 m0, s49, 33792
    s_add_u32 s28, s54, 21504
    buffer_load_dwordx4 v14, s[32:35], s28 offen lds
    s_add_u32 s50, s50, 114688
    s_cmp_eq_u32 s50, 802816
    s_cselect_b32 s50, 0, s50
    v_mfma_f32_16x16x32_bf16 v[208:211], v[48:51], v[144:147], v[208:211]
    v_mfma_f32_16x16x32_bf16 v[212:215], v[52:55], v[144:147], v[212:215]
    s_add_u32 m0, s49, 114688
    s_add_u32 s28, s100, 32256
    buffer_load_dwordx4 v14, s[36:39], s28 offen lds
    v_mfma_f32_16x16x32_bf16 v[240:243], v[48:51], v[148:151], v[240:243]
    v_mfma_f32_16x16x32_bf16 v[244:247], v[52:55], v[148:151], v[244:247]
    buffer_load_dwordx4 v[176:179], v2, s[16:19], s55 offen sc1
    buffer_load_dwordx4 v[180:183], v2, s[16:19], s48 offen sc1
    s_add_u32 s52, s52, 8192
    s_cmp_eq_u32 s52, 57344
    s_cselect_b32 s52, 0, s52
    s_waitcnt vmcnt(15)
    s_waitcnt lgkmcnt(0)
    v_mfma_f32_16x16x32_bf16 v[184:187], v[40:43], v[152:155], v[184:187]
    v_mfma_f32_16x16x32_bf16 v[188:191], v[44:47], v[152:155], v[188:191]
    ds_read_b64_tr_b16 v[48:49], v22 offset:49152
    ds_read_b64_tr_b16 v[50:51], v22 offset:0
    ds_read_b64_tr_b16 v[52:53], v23 offset:49152
    ds_read_b64_tr_b16 v[54:55], v23 offset:0
    v_mfma_f32_16x16x32_bf16 v[216:219], v[40:43], v[156:159], v[216:219]
    v_mfma_f32_16x16x32_bf16 v[220:223], v[44:47], v[156:159], v[220:223]
    s_add_u32 m0, s49, 40960
    s_add_u32 s54, s96, s50
    s_add_u32 s28, s54, 0
    buffer_load_dwordx4 v14, s[32:35], s28 offen lds
    s_add_u32 m0, s49, 41984
    s_add_u32 s28, s54, 7168
    buffer_load_dwordx4 v14, s[32:35], s28 offen lds
    s_waitcnt vmcnt(12)
    v_mfma_f32_16x16x32_bf16 v[192:195], v[40:43], v[160:163], v[192:195]
    v_mfma_f32_16x16x32_bf16 v[196:199], v[44:47], v[160:163], v[196:199]
    s_add_u32 m0, s49, 115712
    s_add_u32 s28, s100, 46592
    buffer_load_dwordx4 v14, s[36:39], s28 offen lds
    v_mfma_f32_16x16x32_bf16 v[224:227], v[40:43], v[164:167], v[224:227]
    v_mfma_f32_16x16x32_bf16 v[228:231], v[44:47], v[164:167], v[228:231]
    s_bitcmp1_b32 s42, 12
    s_cbranch_scc1 Fh_w12
Fh_ok12:
    s_add_u32 s55, s97, s52
    s_add_u32 s48, s55, 147456
    buffer_load_dwordx4 v[88:91], v2, s[16:19], s55 offen sc1
    s_xor_b32 s55, s55, 1024
    buffer_load_dwordx4 v[92:95], v2, s[16:19], s48 offen sc1
    s_xor_b32 s48, s48, 1024
    ds_read_b64_tr_b16 v[120:121], v24 offset:0
    ds_read_b64_tr_b16 v[122:123], v24 offset:8192
    ds_read_b64_tr_b16 v[124:125], v25 offset:0
    ds_read_b64_tr_b16 v[126:127], v25 offset:8192
    s_waitcnt lgkmcnt(4)
    v_mfma_f32_16x16x32_bf16 v[200:203], v[48:51], v[152:155], v[200:203]
    v_mfma_f32_16x16x32_bf16 v[204:207], v[52:55], v[152:155], v[204:207]
    ds_read_b64_tr_b16 v[40:41], v20 offset:8192
    ds_read_b64_tr_b16 v[42:43], v20 offset:16384
    ds_read_b64_tr_b16 v[44:45], v21 offset:8192
    ds_read_b64_tr_b16 v[46:47], v21 offset:16384
    v_mfma_f32_16x16x32_bf16 v[232:235], v[48:51], v[156:159], v[232:235]
    v_mfma_f32_16x16x32_bf16 v[236:239], v[52:55], v[156:159], v[236:239]
    s_add_u32 m0, s49, 49152
    s_add_u32 s28, s54, 14336
    buffer_load_dwordx4 v14, s[32:35], s28 offen lds
    s_add_u32 m0, s49, 50176
    s_add_u32 s28, s54, 21504
    buffer_load_dwordx4 v14, s[32:35], s28 offen lds
    s_add_u32 s50, s50, 114688
    s_cmp_eq_u32 s50, 802816
    s_cselect_b32 s50, 0, s50
    v_mfma_f32_16x16x32_bf16 v[208:211], v[48:51], v[160:163], v[208:211]
    v_mfma_f32_16x16x32_bf16 v[212:215], v[52:55], v[160:163], v[212:215]
    v_mfma_f32_16x16x32_bf16 v[240:243], v[48:51], v[164:167], v[240:243]
    v_mfma_f32_16x16x32_bf16 v[244:247], v[52:55], v[164:167], v[244:247]
    buffer_load_dwordx4 v[96:99], v2, s[16:19], s55 offen sc1
    buffer_load_dwordx4 v[100:103], v2, s[16:19], s48 offen sc1
    s_add_u32 s52, s52, 8192
    s_cmp_eq_u32 s52, 57344
    s_cselect_b32 s52, 0, s52
    ds_read_b64_tr_b16 v[128:129], v26 offset:0
    ds_read_b64_tr_b16 v[130:131], v26 offset:8192
    ds_read_b64_tr_b16 v[132:133], v27 offset:0
    ds_read_b64_tr_b16 v[134:135], v27 offset:8192
    s_waitcnt vmcnt(14)
    s_waitcnt lgkmcnt(4)
    v_mfma_f32_16x16x32_bf16 v[184:187], v[40:43], v[168:171], v[184:187]
F_pgG2_6:
    s_cbranch_execz F_ret
    v_mfma_f32_16x16x32_bf16 v[188:191], v[44:47], v[168:171], v[188:191]
    ds_read_b64_tr_b16 v[48:49], v22 offset:8192
    ds_read_b64_tr_b16 v[50:51], v22 offset:16384
    ds_read_b64_tr_b16 v[52:53], v23 offset:8192
    ds_read_b64_tr_b16 v[54:55], v23 offset:16384
    v_mfma_f32_16x16x32_bf16 v[216:219], v[40:43], v[172:175], v[216:219]
    v_mfma_f32_16x16x32_bf16 v[220:223], v[44:47], v[172:175], v[220:223]
    s_waitcnt vmcnt(9)
    v_mfma_f32_16x16x32_bf16 v[192:195], v[40:43], v[176:179], v[192:195]
    v_mfma_f32_16x16x32_bf16 v[196:199], v[44:47], v[176:179], v[196:199]
    v_mfma_f32_16x16x32_bf16 v[224:227], v[40:43], v[180:183], v[224:227]
    v_mfma_f32_16x16x32_bf16 v[228:231], v[44:47], v[180:183], v[228:231]
    s_bitcmp1_b32 s42, 13
    s_cbranch_scc1 Fh_w13
Fh_ok13:
    s_add_u32 s55, s97, s52
    s_add_u32 s48, s55, 147456
    buffer_load_dwordx4 v[104:107], v2, s[16:19], s55 offen sc1
    s_xor_b32 s55, s55, 1024
    buffer_load_dwordx4 v[108:111], v2, s[16:19], s48 offen sc1
    s_xor_b32 s48, s48, 1024
    ds_read_b64_tr_b16 v[136:137], v24 offset:16384
    ds_read_b64_tr_b16 v[138:139], v24 offset:24576
    ds_read_b64_tr_b16 v[140:141], v25 offset:16384
    ds_read_b64_tr_b16 v[142:143], v25 offset:24576
    s_waitcnt vmcnt(8)
    ds_add_u32 v8, v7
    s_waitcnt lgkmcnt(5)
    v_mfma_f32_16x16x32_bf16 v[200:203], v[48:51], v[168:171], v[200:203]
    v_mfma_f32_16x16x32_bf16 v[204:207], v[52:55], v[168:171], v[204:207]
    ds_read_b64_tr_b16 v[40:41], v20 offset:24576
    ds_read_b64_tr_b16 v[42:43], v20 offset:32768
    ds_read_b64_tr_b16 v[44:45], v21 offset:24576
    ds_read_b64_tr_b16 v[46:47], v21 offset:32768
    v_mfma_f32_16x16x32_bf16 v[232:235], v[48:51], v[172:175], v[232:235]
    v_mfma_f32_16x16x32_bf16 v[236:239], v[52:55], v[172:175], v[236:239]
    v_mfma_f32_16x16x32_bf16 v[208:211], v[48:51], v[176:179], v[208:211]
    v_mfma_f32_16x16x32_bf16 v[212:215], v[52:55], v[176:179], v[212:215]
    v_mfma_f32_16x16x32_bf16 v[240:243], v[48:51], v[180:183], v[240:243]
    v_mfma_f32_16x16x32_bf16 v[244:247], v[52:55], v[180:183], v[244:247]
    buffer_load_dwordx4 v[112:115], v2, s[16:19], s55 offen sc1
    buffer_load_dwordx4 v[116:119], v2, s[16:19], s48 offen sc1
    s_add_u32 s52, s52, 8192
    s_cmp_eq_u32 s52, 57344
    s_cselect_b32 s52, 0, s52
    ds_read_b64_tr_b16 v[144:145], v26 offset:16384
    ds_read_b64_tr_b16 v[146:147], v26 offset:24576
    ds_read_b64_tr_b16 v[148:149], v27 offset:16384
    ds_read_b64_tr_b16 v[150:151], v27 offset:24576
    s_waitcnt vmcnt(8)
    s_waitcnt lgkmcnt(4)
    v_mfma_f32_16x16x32_bf16 v[184:187], v[40:43], v[88:91], v[184:187]
    v_mfma_f32_16x16x32_bf16 v[188:191], v[44:47], v[88:91], v[188:191]
    ds_read_b64_tr_b16 v[48:49], v22 offset:24576
    ds_read_b64_tr_b16 v[50:51], v22 offset:32768
    ds_read_b64_tr_b16 v[52:53], v23 offset:24576
    ds_read_b64_tr_b16 v[54:55], v23 offset:32768
    v_mfma_f32_16x16x32_bf16 v[216:219], v[40:43], v[92:95], v[216:219]
    v_mfma_f32_16x16x32_bf16 v[220:223], v[44:47], v[92:95], v[220:223]
    s_waitcnt vmcnt(4)
    v_mfma_f32_16x16x32_bf16 v[192:195], v[40:43], v[96:99], v[192:195]
    v_mfma_f32_16x16x32_bf16 v[196:199], v[44:47], v[96:99], v[196:199]
    v_mfma_f32_16x16x32_bf16 v[224:227], v[40:43], v[100:103], v[224:227]
    v_mfma_f32_16x16x32_bf16 v[228:231], v[44:47], v[100:103], v[228:231]
    ds_read_b64_tr_b16 v[152:153], v24 offset:32768
    ds_read_b64_tr_b16 v[154:155], v24 offset:40960
    ds_read_b64_tr_b16 v[156:157], v25 offset:32768
    ds_read_b64_tr_b16 v[158:159], v25 offset:40960
    ds_read_b32 v10, v8 offset:1024
    s_setprio 3
    s_waitcnt lgkmcnt(0)
    v_cmp_gt_u32 vcc, 8, v10
    s_cbranch_vccnz F_fs17
F_fs17_ok:
    s_setprio 0
    v_mfma_f32_16x16x32_bf16 v[200:203], v[48:51], v[88:91], v[200:203]
    v_mfma_f32_16x16x32_bf16 v[204:207], v[52:55], v[88:91], v[204:207]
    ds_read_b64_tr_b16 v[40:41], v20 offset:40960
    ds_read_b64_tr_b16 v[42:43], v20 offset:49152
    ds_read_b64_tr_b16 v[44:45], v21 offset:40960
    ds_read_b64_tr_b16 v[46:47], v21 offset:49152
    buffer_load_dwordx4 v[56:59], v2, s[16:19], s56 offen offset:0 sc1
    buffer_load_dwordx4 v[60:63], v2, s[16:19], s58 offen offset:0 sc1
    v_mfma_f32_16x16x32_bf16 v[232:235], v[48:51], v[92:95], v[232:235]
    v_mfma_f32_16x16x32_bf16 v[236:239], v[52:55], v[92:95], v[236:239]
    buffer_load_dwordx4 v[64:67], v2, s[16:19], s56 offen offset:2048 sc1
    buffer_load_dwordx4 v[68:71], v2, s[16:19], s58 offen offset:2048 sc1
    v_mfma_f32_16x16x32_bf16 v[208:211], v[48:51], v[96:99], v[208:211]
    v_mfma_f32_16x16x32_bf16 v[212:215], v[52:55], v[96:99], v[212:215]
    buffer_load_dwordx4 v[72:75], v2, s[16:19], s57 offen offset:0 sc1
    buffer_load_dwordx4 v[76:79], v2, s[16:19], s59 offen offset:0 sc1
    v_mfma_f32_16x16x32_bf16 v[240:243], v[48:51], v[100:103], v[240:243]
    v_mfma_f32_16x16x32_bf16 v[244:247], v[52:55], v[100:103], v[244:247]
    buffer_load_dwordx4 v[80:83], v2, s[16:19], s57 offen offset:2048 sc1
    buffer_load_dwordx4 v[84:87], v2, s[16:19], s59 offen offset:2048 sc1
    ds_read_b64_tr_b16 v[160:161], v26 offset:32768
    ds_read_b64_tr_b16 v[162:163], v26 offset:40960
    ds_read_b64_tr_b16 v[164:165], v27 offset:32768
    ds_read_b64_tr_b16 v[166:167], v27 offset:40960
    s_waitcnt vmcnt(10)
    s_waitcnt lgkmcnt(4)
    v_mfma_f32_16x16x32_bf16 v[184:187], v[40:43], v[104:107], v[184:187]
    v_mfma_f32_16x16x32_bf16 v[188:191], v[44:47], v[104:107], v[188:191]
    ds_read_b64_tr_b16 v[48:49], v22 offset:40960
    ds_read_b64_tr_b16 v[50:51], v22 offset:49152
    ds_read_b64_tr_b16 v[52:53], v23 offset:40960
    ds_read_b64_tr_b16 v[54:55], v23 offset:49152
    v_mfma_f32_16x16x32_bf16 v[216:219], v[40:43], v[108:111], v[216:219]
    v_mfma_f32_16x16x32_bf16 v[220:223], v[44:47], v[108:111], v[220:223]
    s_waitcnt vmcnt(8)
    v_mfma_f32_16x16x32_bf16 v[192:195], v[40:43], v[112:115], v[192:195]
    v_mfma_f32_16x16x32_bf16 v[196:199], v[44:47], v[112:115], v[196:199]
    v_mfma_f32_16x16x32_bf16 v[224:227], v[40:43], v[116:119], v[224:227]
F_pgG2_7:
    s_cbranch_execz F_ret
    v_mfma_f32_16x16x32_bf16 v[228:231], v[44:47], v[116:119], v[228:231]
    ds_read_b64_tr_b16 v[168:169], v24 offset:49152
    ds_read_b64_tr_b16 v[170:171], v24 offset:57344
    ds_read_b64_tr_b16 v[172:173], v25 offset:49152
    ds_read_b64_tr_b16 v[174:175], v25 offset:57344
    s_waitcnt lgkmcnt(4)
    v_mfma_f32_16x16x32_bf16 v[200:203], v[48:51], v[104:107], v[200:203]
    v_mfma_f32_16x16x32_bf16 v[204:207], v[52:55], v[104:107], v[204:207]
    v_mfma_f32_16x16x32_bf16 v[232:235], v[48:51], v[108:111], v[232:235]
    v_mfma_f32_16x16x32_bf16 v[236:239], v[52:55], v[108:111], v[236:239]
    v_mfma_f32_16x16x32_bf16 v[208:211], v[48:51], v[112:115], v[208:211]
    v_mfma_f32_16x16x32_bf16 v[212:215], v[52:55], v[112:115], v[212:215]
    v_mfma_f32_16x16x32_bf16 v[240:243], v[48:51], v[116:119], v[240:243]
    v_mfma_f32_16x16x32_bf16 v[244:247], v[52:55], v[116:119], v[244:247]
    ds_read_b64_tr_b16 v[176:177], v26 offset:49152
    ds_read_b64_tr_b16 v[178:179], v26 offset:57344
    ds_read_b64_tr_b16 v[180:181], v27 offset:49152
    ds_read_b64_tr_b16 v[182:183], v27 offset:57344
    s_setprio 1
    s_mov_b32 s30, 0x8000
    s_waitcnt lgkmcnt(0)
    v_rcp_f32 v5, v13
    ds_write_b128 v28, v[224:227] offset:8192
    ds_write_b128 v28, v[228:231] offset:9216
    v_lshlrev_b32 v40, 16, v36
    v_and_b32 v41, 0xffff0000, v36
    v_lshlrev_b32 v42, 16, v37
    v_and_b32 v43, 0xffff0000, v37
    v_lshlrev_b32 v44, 16, v38
    v_and_b32 v45, 0xffff0000, v38
    v_lshlrev_b32 v46, 16, v39
    v_and_b32 v47, 0xffff0000, v39
    ds_write_b128 v28, v[232:235] offset:16384
    ds_write_b128 v28, v[236:239] offset:17408
    ds_write_b128 v28, v[240:243] offset:24576
    ds_write_b128 v28, v[244:247] offset:25600
    v_fmac_f32 v216, v40, v5
    v_fmac_f32 v217, v41, v5
    v_fmac_f32 v218, v42, v5
    v_fmac_f32 v219, v43, v5
    v_fmac_f32 v220, v44, v5
    v_fmac_f32 v221, v45, v5
    v_fmac_f32 v222, v46, v5
    v_fmac_f32 v223, v47, v5
    ds_write_b128 v28, v[216:219] offset:0
    ds_write_b128 v28, v[220:223] offset:1024
    ds_add_u32 v8, v7
    v_lshlrev_b32 v40, 16, v32
    v_and_b32 v41, 0xffff0000, v32
    v_lshlrev_b32 v42, 16, v33
    v_and_b32 v43, 0xffff0000, v33
    v_lshlrev_b32 v44, 16, v34
    v_and_b32 v45, 0xffff0000, v34
    v_lshlrev_b32 v46, 16, v35
    v_and_b32 v47, 0xffff0000, v35
    s_waitcnt vmcnt(6)
Fo_chk00:
    v_max3_u32 v3, v56, v57, v58
    v_max3_u32 v4, v60, v61, v62
    v_max3_u32 v3, v3, v59, v63
    v_max_u32 v3, v3, v4
    v_cmp_eq_u32 vcc, -1, v3
    s_cbranch_vccnz Fo_retry00
Fo_go00:
    v_mfma_f32_16x16x32_bf16 v[200:203], v[128:131], v[56:59], v[200:203]
    v_mfma_f32_16x16x32_bf16 v[204:207], v[132:135], v[56:59], v[204:207]
    v_mfma_f32_16x16x32_bf16 v[208:211], v[128:131], v[60:63], v[208:211]
    v_mfma_f32_16x16x32_bf16 v[212:215], v[132:135], v[60:63], v[212:215]
    v_mfma_f32_16x16x32_bf16 v[184:187], v[120:123], v[56:59], v[184:187]
    v_mfma_f32_16x16x32_bf16 v[188:191], v[124:127], v[56:59], v[188:191]
    v_mfma_f32_16x16x32_bf16 v[192:195], v[120:123], v[60:63], v[192:195]
    v_mfma_f32_16x16x32_bf16 v[196:199], v[124:127], v[60:63], v[196:199]
    s_waitcnt vmcnt(4)
Fo_chk01:
    v_max3_u32 v3, v64, v65, v66
    v_max3_u32 v4, v68, v69, v70
    v_max3_u32 v3, v3, v67, v71
    v_max_u32 v3, v3, v4
    v_cmp_eq_u32 vcc, -1, v3
    s_cbranch_vccnz Fo_retry01
Fo_go01:
    v_mfma_f32_16x16x32_bf16 v[200:203], v[144:147], v[64:67], v[200:203]
    v_mfma_f32_16x16x32_bf16 v[204:207], v[148:151], v[64:67], v[204:207]
    v_mfma_f32_16x16x32_bf16 v[208:211], v[144:147], v[68:71], v[208:211]
    v_mfma_f32_16x16x32_bf16 v[212:215], v[148:151], v[68:71], v[212:215]
    v_mfma_f32_16x16x32_bf16 v[184:187], v[136:139], v[64:67], v[184:187]
    v_mfma_f32_16x16x32_bf16 v[188:191], v[140:143], v[64:67], v[188:191]
    v_mfma_f32_16x16x32_bf16 v[192:195], v[136:139], v[68:71], v[192:195]
    v_mfma_f32_16x16x32_bf16 v[196:199], v[140:143], v[68:71], v[196:199]
    s_waitcnt vmcnt(2)
Fo_chk02:
    v_max3_u32 v3, v72, v73, v74
    v_max3_u32 v4, v76, v77, v78
    v_max3_u32 v3, v3, v75, v79
    v_max_u32 v3, v3, v4
    v_cmp_eq_u32 vcc, -1, v3
    s_cbranch_vccnz Fo_retry02
Fo_go02:
    v_mfma_f32_16x16x32_bf16 v[200:203], v[160:163], v[72:75], v[200:203]
    v_mfma_f32_16x16x32_bf16 v[204:207], v[164:167], v[72:75], v[204:207]
    v_mfma_f32_16x16x32_bf16 v[208:211], v[160:163], v[76:79], v[208:211]
    v_mfma_f32_16x16x32_bf16 v[212:215], v[164:167], v[76:79], v[212:215]
    v_mfma_f32_16x16x32_bf16 v[184:187], v[152:155], v[72:75], v[184:187]
    v_mfma_f32_16x16x32_bf16 v[188:191], v[156:159], v[72:75], v[188:191]
    v_mfma_f32_16x16x32_bf16 v[192:195], v[152:155], v[76:79], v[192:195]
    v_mfma_f32_16x16x32_bf16 v[196:199], v[156:159], v[76:79], v[196:199]
    s_waitcnt vmcnt(0)
Fo_chk03:
    v_max3_u32 v3, v80, v81, v82
    v_max3_u32 v4, v84, v85, v86
    v_max3_u32 v3, v3, v83, v87
    v_max_u32 v3, v3, v4
    v_cmp_eq_u32 vcc, -1, v3
    s_cbranch_vccnz Fo_retry03
Fo_go03:
    v_mfma_f32_16x16x32_bf16 v[200:203], v[176:179], v[80:83], v[200:203]
    v_mfma_f32_16x16x32_bf16 v[204:207], v[180:183], v[80:83], v[204:207]
    v_mfma_f32_16x16x32_bf16 v[208:211], v[176:179], v[84:87], v[208:211]
    v_mfma_f32_16x16x32_bf16 v[212:215], v[180:183], v[84:87], v[212:215]
    v_mfma_f32_16x16x32_bf16 v[184:187], v[168:171], v[80:83], v[184:187]
    v_mfma_f32_16x16x32_bf16 v[188:191], v[172:175], v[80:83], v[188:191]
    v_mfma_f32_16x16x32_bf16 v[192:195], v[168:171], v[84:87], v[192:195]
    v_mfma_f32_16x16x32_bf16 v[196:199], v[172:175], v[84:87], v[196:199]
    s_nop 0
    ds_write_b128 v28, v[200:203] offset:40960
    ds_write_b128 v28, v[204:207] offset:41984
    ds_write_b128 v28, v[208:211] offset:49152
    ds_write_b128 v28, v[212:215] offset:50176
    s_nop 1
    ds_write_b128 v28, v[192:195] offset:32768
    ds_write_b128 v28, v[196:199] offset:33792
    ds_add_u32 v8, v7
    ds_read_b32 v10, v9 offset:0
    s_waitcnt lgkmcnt(0)
    v_cmp_gt_u32 vcc, 6, v10
    s_cbranch_vccnz F_fs18
F_fs18_ok:
    ds_read_b128 v[88:91], v29 offset:32768
    ds_read_b128 v[92:95], v29 offset:33792
    ds_read_b128 v[96:99], v30 offset:40960
    ds_read_b128 v[100:103], v30 offset:41984
    ds_read_b128 v[104:107], v31 offset:49152
    ds_read_b128 v[108:111], v31 offset:50176
    s_waitcnt lgkmcnt(4)
    v_add_f32 v184, v184, v88
    v_add_f32 v185, v185, v89
    v_add_f32 v186, v186, v90
    v_add_f32 v187, v187, v91
    v_add_f32 v188, v188, v92
    v_add_f32 v189, v189, v93
    v_add_f32 v190, v190, v94
    v_add_f32 v191, v191, v95
    s_waitcnt lgkmcnt(2)
    v_add_f32 v184, v184, v96
    v_add_f32 v185, v185, v97
    v_add_f32 v186, v186, v98
    v_add_f32 v187, v187, v99
    v_add_f32 v188, v188, v100
    v_add_f32 v189, v189, v101
    v_add_f32 v190, v190, v102
    v_add_f32 v191, v191, v103
    s_waitcnt lgkmcnt(0)
    v_add_f32 v184, v184, v104
    v_add_f32 v185, v185, v105
    v_add_f32 v186, v186, v106
    v_add_f32 v187, v187, v107
    v_add_f32 v188, v188, v108
    v_add_f32 v189, v189, v109
    v_add_f32 v190, v190, v110
    v_add_f32 v191, v191, v111
    v_fma_f32 v184, v184, v12, v40
    v_fma_f32 v185, v185, v12, v41
    v_fma_f32 v186, v186, v12, v42
    v_fma_f32 v187, v187, v12, v43
    v_fma_f32 v188, v188, v12, v44
    v_fma_f32 v189, v189, v12, v45
    v_fma_f32 v190, v190, v12, v46
    v_fma_f32 v191, v191, v12, v47
    v_cvt_pk_bf16_f32 v192, v184, v185
F_pgG2_8:
    s_cbranch_execz F_ret
    v_cvt_pk_bf16_f32 v194, v188, v189
    v_cvt_pk_bf16_f32 v193, v186, v187
    v_cvt_pk_bf16_f32 v195, v190, v191
    v_permlane16_swap_b32 v192, v194
    s_nop 0
    v_permlane16_swap_b32 v193, v195
    buffer_store_dwordx4 v[192:195], v15, s[44:47], 0 offen sc1
    s_endpgm
F_spin1:
    s_mov_b32 s31, 0x8000
F_spin1_r:
    s_sleep 2
    buffer_load_dword v10, v224, s[24:27], 0 offen sc1
    s_sub_u32 s31, s31, 1
    s_waitcnt vmcnt(0)
    v_cmp_ne_u32 vcc, 1, v10
    s_cmp_eq_u32 s31, 0
    s_cbranch_scc1 F_go
    s_cbranch_vccnz F_spin1_r
    s_branch F_go
Fq_slow:
    s_mov_b32 s28, 2097152
    v_mov_b32 v3, 0xff800000
Fq_maxloop:
    buffer_load_dwordx4 v[192:195], v2, s[16:19], s28 offen sc1
    buffer_load_dwordx4 v[196:199], v2, s[16:19], s28 offen offset:1024 sc1
    s_waitcnt vmcnt(0)
    v_mfma_f32_32x32x16_bf16 v[160:175], v[192:195], v[208:211], 0
    v_mfma_f32_32x32x16_bf16 v[160:175], v[196:199], v[212:215], v[160:175]
    s_add_u32 s28, s28, 4096
    s_nop 10
    v_max3_f32 v3, v160, v161, v3
    v_max3_f32 v3, v162, v163, v3
    v_max3_f32 v3, v164, v165, v3
    v_max3_f32 v3, v166, v167, v3
    v_max3_f32 v3, v168, v169, v3
    v_max3_f32 v3, v170, v171, v3
    v_max3_f32 v3, v172, v173, v3
    v_max3_f32 v3, v174, v175, v3
    s_cmp_lt_u32 s28, 2359296
    s_cbranch_scc1 Fq_maxloop
    v_mov_b32 v4, v3
    s_nop 1
    v_permlane32_swap_b32 v3, v4
    v_max_f32 v3, v3, v4
    v_cmp_gt_u32 vcc, 32, v1
    v_xor_b32 v3, 0x80000000, v3
    v_and_b32 v4, 0xffff0000, v3
    v_sub_f32 v3, v3, v4
    v_and_b32 v5, 0xffff0000, v3
    v_sub_f32 v3, v3, v5
    v_lshrrev_b32 v4, 16, v4
    v_or_b32 v4, v4, v5
    v_lshrrev_b32 v3, 16, v3
    v_cndmask_b32 v214, v4, v214, vcc
    v_cndmask_b32 v215, v3, v215, vcc
    s_branch Fq_fast
F_fs2:
    s_mov_b32 s31, 0x400000
F_fs2_r:
    s_sleep 1
    ds_read_b32 v10, v9 offset:1024
    s_sub_u32 s31, s31, 1
    s_waitcnt lgkmcnt(0)
    v_cmp_le_u32 vcc, 1, v10
    s_cmp_eq_u32 s31, 0
    s_cbranch_scc1 F_fs2_ok
    s_cmp_eq_u64 vcc, -1
    s_cbranch_scc0 F_fs2_r
    s_branch F_fs2_ok
F_fs3:
    s_bitcmp0_b32 vcc_lo, s93
    s_cbranch_scc1 F_fs3_ok
    s_mov_b32 s31, 0x400000
F_fs3_r:
    s_sleep 1
    ds_read_b32 v10, v9 offset:0
    s_sub_u32 s31, s31, 1
    s_waitcnt lgkmcnt(0)
    v_cmp_le_u32 vcc, 2, v10
    s_cmp_eq_u32 s31, 0
    s_cbranch_scc1 F_fs3_ok
    s_bitcmp1_b32 vcc_lo, s93
    s_cbranch_scc0 F_fs3_r
    s_branch F_fs3_ok
F_fs4:
    s_bitcmp0_b32 vcc_lo, s93
    s_cbranch_scc1 F_fs4_ok
    s_mov_b32 s31, 0x400000
F_fs4_r:
    s_sleep 1
    ds_read_b32 v10, v9 offset:0
    s_sub_u32 s31, s31, 1
    s_waitcnt lgkmcnt(0)
    v_cmp_le_u32 vcc, 3, v10
    s_cmp_eq_u32 s31, 0
    s_cbranch_scc1 F_fs4_ok
    s_bitcmp1_b32 vcc_lo, s93
    s_cbranch_scc0 F_fs4_r
    s_branch F_fs4_ok
F_fs5:
    s_mov_b32 s31, 0x400000
F_fs5_r:
    s_sleep 1
    ds_read_b32 v10, v9 offset:1024
    s_sub_u32 s31, s31, 1
    s_waitcnt lgkmcnt(0)
    v_cmp_le_u32 vcc, 6, v10
    s_cmp_eq_u32 s31, 0
    s_cbranch_scc1 F_fs5_ok
    s_cmp_eq_u64 vcc, -1
    s_cbranch_scc0 F_fs5_r
    s_branch F_fs5_ok
F_fs6:
    s_mov_b32 s31, 0x400000
F_fs6_r:
    s_sleep 1
    ds_read_b32 v10, v9 offset:1024
    s_sub_u32 s31, s31, 1
    s_waitcnt lgkmcnt(0)
    v_cmp_le_u32 vcc, 7, v10
    s_cmp_eq_u32 s31, 0
    s_cbranch_scc1 F_fs6_ok
    s_cmp_eq_u64 vcc, -1
    s_cbranch_scc0 F_fs6_r
    s_branch F_fs6_ok
F_fs7:
    s_mov_b32 s31, 0x400000
F_fs7_r:
    s_sleep 0
    ds_read_b32 v10, v9 offset:1024
    s_sub_u32 s31, s31, 1
    s_waitcnt lgkmcnt(0)
    v_cmp_le_u32 vcc, 9, v10
    s_cmp_eq_u32 s31, 0
    s_cbranch_scc1 F_fs7_ok
    s_cmp_eq_u64 vcc, -1
    s_cbranch_scc0 F_fs7_r
    s_branch F_fs7_ok
F_fs8:
    s_mov_b32 s31, 0x400000
F_fs8_r:
    s_sleep 1
    ds_read_b32 v10, v9 offset:0
    s_sub_u32 s31, s31, 1
    s_waitcnt lgkmcnt(0)
    v_cmp_le_u32 vcc, 4, v10
    s_cmp_eq_u32 s31, 0
    s_cbranch_scc1 F_fs8_ok
    s_cmp_eq_u64 vcc, -1
    s_cbranch_scc0 F_fs8_r
    s_branch F_fs8_ok
F_fs9:
    s_mov_b32 s31, 0x400000
F_fs9_r:
    s_sleep 1
    ds_read_b32 v10, v9 offset:1024
    s_sub_u32 s31, s31, 1
    s_waitcnt lgkmcnt(0)
    v_cmp_le_u32 vcc, 10, v10
    s_cmp_eq_u32 s31, 0
    s_cbranch_scc1 F_fs9_ok
    s_cmp_eq_u64 vcc, -1
    s_cbranch_scc0 F_fs9_r
    s_branch F_fs9_ok
F_fs10:
    s_mov_b32 s31, 0x400000
F_fs10_r:
    s_sleep 1
    ds_read_b32 v10, v9 offset:0
    s_sub_u32 s31, s31, 1
    s_waitcnt lgkmcnt(0)
    v_cmp_le_u32 vcc, 5, v10
    s_cmp_eq_u32 s31, 0
    s_cbranch_scc1 F_fs10_ok
    s_cmp_eq_u64 vcc, -1
    s_cbranch_scc0 F_fs10_r
    s_branch F_fs10_ok
Fo_retry10:
    s_cmp_eq_u32 s30, 0
    s_cbranch_scc1 Fo_go10
    s_sub_u32 s30, s30, 1
    s_sleep 2
    buffer_load_dwordx4 v[80:83], v11, s[16:19], s48 offen offset:0 sc1
    buffer_load_dwordx4 v[84:87], v11, s[16:19], s50 offen offset:0 sc1
    buffer_load_dwordx4 v[88:91], v11, s[16:19], s48 offen offset:2048 sc1
    buffer_load_dwordx4 v[92:95], v11, s[16:19], s50 offen offset:2048 sc1
    buffer_load_dwordx4 v[96:99], v11, s[16:19], s49 offen offset:0 sc1
    buffer_load_dwordx4 v[100:103], v11, s[16:19], s51 offen offset:0 sc1
    buffer_load_dwordx4 v[104:107], v11, s[16:19], s49 offen offset:2048 sc1
    buffer_load_dwordx4 v[108:111], v11, s[16:19], s51 offen offset:2048 sc1
    s_waitcnt vmcnt(0)
    s_branch Fo_chk10
Fo_retry11:
    s_cmp_eq_u32 s30, 0
    s_cbranch_scc1 Fo_go11
    s_sub_u32 s30, s30, 1
    s_sleep 2
    buffer_load_dwordx4 v[88:91], v11, s[16:19], s48 offen offset:2048 sc1
    buffer_load_dwordx4 v[92:95], v11, s[16:19], s50 offen offset:2048 sc1
    buffer_load_dwordx4 v[96:99], v11, s[16:19], s49 offen offset:0 sc1
    buffer_load_dwordx4 v[100:103], v11, s[16:19], s51 offen offset:0 sc1
    buffer_load_dwordx4 v[104:107], v11, s[16:19], s49 offen offset:2048 sc1
    buffer_load_dwordx4 v[108:111], v11, s[16:19], s51 offen offset:2048 sc1
    s_waitcnt vmcnt(0)
    s_branch Fo_chk11
Fo_retry12:
    s_cmp_eq_u32 s30, 0
    s_cbranch_scc1 Fo_go12
    s_sub_u32 s30, s30, 1
    s_sleep 2
    buffer_load_dwordx4 v[96:99], v11, s[16:19], s49 offen offset:0 sc1
    buffer_load_dwordx4 v[100:103], v11, s[16:19], s51 offen offset:0 sc1
    buffer_load_dwordx4 v[104:107], v11, s[16:19], s49 offen offset:2048 sc1
    buffer_load_dwordx4 v[108:111], v11, s[16:19], s51 offen offset:2048 sc1
    s_waitcnt vmcnt(0)
    s_branch Fo_chk12
Fo_retry13:
    s_cmp_eq_u32 s30, 0
    s_cbranch_scc1 Fo_go13
    s_sub_u32 s30, s30, 1
    s_sleep 2
    buffer_load_dwordx4 v[104:107], v11, s[16:19], s49 offen offset:2048 sc1
    buffer_load_dwordx4 v[108:111], v11, s[16:19], s51 offen offset:2048 sc1
    s_waitcnt vmcnt(0)
    s_branch Fo_chk13
F_fs11:
    s_mov_b32 s31, 0x400000
F_fs11_r:
    s_sleep 0
    ds_read_b32 v10, v9 offset:1024
    s_sub_u32 s31, s31, 1
    s_waitcnt lgkmcnt(0)
F_pgR_0:
    s_cbranch_execz F_ret
    v_cmp_le_u32 vcc, 11, v10
    s_cmp_eq_u32 s31, 0
    s_cbranch_scc1 F_fs11_ok
    s_cmp_eq_u64 vcc, -1
    s_cbranch_scc0 F_fs11_r
    s_branch F_fs11_ok
Fc_retry:
    s_cmp_eq_u32 s31, 0
    s_cbranch_scc1 Fc_go
    s_sub_u32 s31, s31, 1
    s_sleep 2
    buffer_load_dwordx2 v[50:51], v46, s[16:19], s57 offen sc1
    s_waitcnt vmcnt(0)
    s_branch Fc_chk
Fh_poll:
    s_mov_b32 s31, 0x8000
    s_setprio 3
    s_ff1_i32_b32 vcc_lo, s30
Fh_again:
    s_mov_b32 exec_hi, 0
    s_mov_b32 exec_lo, s30
    buffer_load_dword v17, v16, s[16:19], s40 offen sc1
    s_mov_b64 exec, -1
    s_sub_u32 s31, s31, 1
    s_waitcnt vmcnt(0)
    v_cmp_ne_u32 s[42:43], 1, v17
    s_cmp_eq_u32 s31, 0
    s_cbranch_scc1 Fh_done
    s_and_b32 s30, s30, s42
    s_bitcmp0_b32 s42, vcc_lo
    s_cbranch_scc1 Fh_done
    s_sleep 4
    s_branch Fh_again
Fh_done:
    s_setprio 0
    s_setpc_b64 s[28:29]
Fh_w1:
    s_movk_i32 s30, 126
    s_call_b64 s[28:29], Fh_poll
    s_branch Fh_ok1
Fh_w2:
    s_movk_i32 s30, 124
    s_call_b64 s[28:29], Fh_poll
    s_branch Fh_ok2
Fh_w3:
    s_movk_i32 s30, 120
    s_call_b64 s[28:29], Fh_poll
    s_branch Fh_ok3
Fh_w4:
    s_movk_i32 s30, 112
    s_call_b64 s[28:29], Fh_poll
    s_branch Fh_ok4
Fh_w5:
    s_movk_i32 s30, 96
    s_call_b64 s[28:29], Fh_poll
    s_branch Fh_ok5
Fh_w6:
    s_movk_i32 s30, 64
    s_call_b64 s[28:29], Fh_poll
    s_branch Fh_ok6
Fh_w7:
    s_movk_i32 s30, 16256
    s_call_b64 s[28:29], Fh_poll
    s_branch Fh_ok7
Fh_w8:
    s_movk_i32 s30, 16128
    s_call_b64 s[28:29], Fh_poll
    s_branch Fh_ok8
Fh_w9:
    s_movk_i32 s30, 15872
    s_call_b64 s[28:29], Fh_poll
    s_branch Fh_ok9
Fh_w10:
    s_movk_i32 s30, 15360
    s_call_b64 s[28:29], Fh_poll
    s_branch Fh_ok10
Fh_w11:
    s_movk_i32 s30, 14336
    s_call_b64 s[28:29], Fh_poll
    s_branch Fh_ok11
Fh_w12:
    s_movk_i32 s30, 12288
    s_call_b64 s[28:29], Fh_poll
    s_branch Fh_ok12
Fh_w13:
    s_movk_i32 s30, 8192
    s_call_b64 s[28:29], Fh_poll
    s_branch Fh_ok13
F_fs12:
    s_mov_b32 s31, 0x400000
F_fs12_r:
    s_sleep 2
    ds_read_b32 v10, v9 offset:0
    s_sub_u32 s31, s31, 1
    s_waitcnt lgkmcnt(0)
    v_cmp_le_u32 vcc, 1, v10
    s_cmp_eq_u32 s31, 0
    s_cbranch_scc1 F_fs12_ok
    s_cmp_eq_u64 vcc, -1
    s_cbranch_scc0 F_fs12_r
    s_branch F_fs12_ok
F_fs13:
    s_mov_b32 s31, 0x400000
F_fs13_r:
    s_sleep 2
    ds_read_b32 v10, v9 offset:1024
    s_sub_u32 s31, s31, 1
    s_waitcnt lgkmcnt(0)
    v_cmp_le_u32 vcc, 2, v10
    s_cmp_eq_u32 s31, 0
    s_cbranch_scc1 F_fs13_ok
    s_cmp_eq_u64 vcc, -1
    s_cbranch_scc0 F_fs13_r
    s_branch F_fs13_ok
F_fs14:
    s_mov_b32 s31, 0x400000
F_fs14_r:
    s_sleep 2
    ds_read_b32 v10, v8 offset:1024
    s_sub_u32 s31, s31, 1
    s_waitcnt lgkmcnt(0)
    v_cmp_le_u32 vcc, 3, v10
    s_cmp_eq_u32 s31, 0
    s_cbranch_scc1 F_fs14_ok
    s_cmp_eq_u64 vcc, -1
    s_cbranch_scc0 F_fs14_r
    s_branch F_fs14_ok
F_fs15:
    s_mov_b32 s31, 0x400000
F_fs15_r:
    s_sleep 2
    ds_read_b32 v10, v8 offset:1024
    s_sub_u32 s31, s31, 1
    s_waitcnt lgkmcnt(0)
    v_cmp_le_u32 vcc, 4, v10
    s_cmp_eq_u32 s31, 0
    s_cbranch_scc1 F_fs15_ok
    s_cmp_eq_u64 vcc, -1
    s_cbranch_scc0 F_fs15_r
    s_branch F_fs15_ok
F_fs16:
    s_mov_b32 s31, 0x400000
F_fs16_r:
    s_sleep 2
    ds_read_b32 v10, v8 offset:1024
    s_sub_u32 s31, s31, 1
    s_waitcnt lgkmcnt(0)
    v_cmp_le_u32 vcc, 5, v10
    s_cmp_eq_u32 s31, 0
    s_cbranch_scc1 F_fs16_ok
    s_cmp_eq_u64 vcc, -1
    s_cbranch_scc0 F_fs16_r
    s_branch F_fs16_ok
F_fs17:
    s_mov_b32 s31, 0x400000
F_fs17_r:
    s_sleep 1
    ds_read_b32 v10, v8 offset:1024
    s_sub_u32 s31, s31, 1
    s_waitcnt lgkmcnt(0)
    v_cmp_le_u32 vcc, 8, v10
    s_cmp_eq_u32 s31, 0
    s_cbranch_scc1 F_fs17_ok
    s_cmp_eq_u64 vcc, -1
    s_cbranch_scc0 F_fs17_r
    s_branch F_fs17_ok
Fo_retry00:
    s_cmp_eq_u32 s30, 0
    s_cbranch_scc1 Fo_go00
    s_sub_u32 s30, s30, 1
    s_sleep 2
    buffer_load_dwordx4 v[56:59], v2, s[16:19], s56 offen offset:0 sc1
    buffer_load_dwordx4 v[60:63], v2, s[16:19], s58 offen offset:0 sc1
    buffer_load_dwordx4 v[64:67], v2, s[16:19], s56 offen offset:2048 sc1
    buffer_load_dwordx4 v[68:71], v2, s[16:19], s58 offen offset:2048 sc1
    buffer_load_dwordx4 v[72:75], v2, s[16:19], s57 offen offset:0 sc1
    buffer_load_dwordx4 v[76:79], v2, s[16:19], s59 offen offset:0 sc1
    buffer_load_dwordx4 v[80:83], v2, s[16:19], s57 offen offset:2048 sc1
    buffer_load_dwordx4 v[84:87], v2, s[16:19], s59 offen offset:2048 sc1
    s_waitcnt vmcnt(0)
    s_branch Fo_chk00
Fo_retry01:
    s_cmp_eq_u32 s30, 0
    s_cbranch_scc1 Fo_go01
    s_sub_u32 s30, s30, 1
    s_sleep 2
    buffer_load_dwordx4 v[64:67], v2, s[16:19], s56 offen offset:2048 sc1
    buffer_load_dwordx4 v[68:71], v2, s[16:19], s58 offen offset:2048 sc1
    buffer_load_dwordx4 v[72:75], v2, s[16:19], s57 offen offset:0 sc1
    buffer_load_dwordx4 v[76:79], v2, s[16:19], s59 offen offset:0 sc1
    buffer_load_dwordx4 v[80:83], v2, s[16:19], s57 offen offset:2048 sc1
    buffer_load_dwordx4 v[84:87], v2, s[16:19], s59 offen offset:2048 sc1
    s_waitcnt vmcnt(0)
    s_branch Fo_chk01
Fo_retry02:
    s_cmp_eq_u32 s30, 0
    s_cbranch_scc1 Fo_go02
    s_sub_u32 s30, s30, 1
    s_sleep 2
    buffer_load_dwordx4 v[72:75], v2, s[16:19], s57 offen offset:0 sc1
    buffer_load_dwordx4 v[76:79], v2, s[16:19], s59 offen offset:0 sc1
    buffer_load_dwordx4 v[80:83], v2, s[16:19], s57 offen offset:2048 sc1
    buffer_load_dwordx4 v[84:87], v2, s[16:19], s59 offen offset:2048 sc1
    s_waitcnt vmcnt(0)
    s_branch Fo_chk02
Fo_retry03:
    s_cmp_eq_u32 s30, 0
    s_cbranch_scc1 Fo_go03
    s_sub_u32 s30, s30, 1
    s_sleep 2
    buffer_load_dwordx4 v[80:83], v2, s[16:19], s57 offen offset:2048 sc1
    buffer_load_dwordx4 v[84:87], v2, s[16:19], s59 offen offset:2048 sc1
    s_waitcnt vmcnt(0)
    s_branch Fo_chk03
F_fs18:
    s_mov_b32 s31, 0x400000
F_fs18_r:
    s_sleep 0
    ds_read_b32 v10, v9 offset:0
    s_sub_u32 s31, s31, 1
    s_waitcnt lgkmcnt(0)
    v_cmp_le_u32 vcc, 6, v10
    s_cmp_eq_u32 s31, 0
    s_cbranch_scc1 F_fs18_ok
    s_cmp_eq_u64 vcc, -1
    s_cbranch_scc0 F_fs18_r
    s_branch F_fs18_ok
F_fs33:
    s_mov_b32 s31, 0x400000
F_fs33_r:
    s_sleep 4
    ds_read_b32 v10, v9 offset:1024
    s_sub_u32 s31, s31, 1
    s_waitcnt lgkmcnt(0)
    v_cmp_le_u32 vcc, 2, v10
    s_cmp_eq_u32 s31, 0
    s_cbranch_scc1 F_fs33_ok
    s_cmp_eq_u64 vcc, -1
    s_cbranch_scc0 F_fs33_r
    s_branch F_fs33_ok
F_fs34:
    s_mov_b32 s31, 0x400000
F_fs34_r:
    s_sleep 8
    ds_read_b32 v10, v8 offset:1024
    s_sub_u32 s31, s31, 1
    s_waitcnt lgkmcnt(0)
    v_cmp_le_u32 vcc, 3, v10
    s_cmp_eq_u32 s31, 0
    s_cbranch_scc1 F_fs34_ok
    s_cmp_eq_u64 vcc, -1
    s_cbranch_scc0 F_fs34_r
    s_branch F_fs34_ok
F_fs35:
    s_mov_b32 s31, 0x400000
F_fs35_r:
    s_sleep 8
    ds_read_b32 v10, v8 offset:1024
    s_sub_u32 s31, s31, 1
    s_waitcnt lgkmcnt(0)
    v_cmp_le_u32 vcc, 3, v10
    s_cmp_eq_u32 s31, 0
    s_cbranch_scc1 F_fs35_ok
    s_cmp_eq_u64 vcc, -1
    s_cbranch_scc0 F_fs35_r
    s_branch F_fs35_ok
F_fs36:
    s_mov_b32 s31, 0x400000
F_fs36_r:
F_pgR_1:
    s_cbranch_execz F_ret
    s_sleep 8
    ds_read_b32 v10, v8 offset:1024
    s_sub_u32 s31, s31, 1
    s_waitcnt lgkmcnt(0)
    v_cmp_le_u32 vcc, 3, v10
    s_cmp_eq_u32 s31, 0
    s_cbranch_scc1 F_fs36_ok
    s_cmp_eq_u64 vcc, -1
    s_cbranch_scc0 F_fs36_r
    s_branch F_fs36_ok
F_spin37:
    s_mov_b32 s31, 0x8000
F_spin37_r:
    s_sleep 2
    buffer_load_dword v10, v224, s[24:27], 0 offen sc1
    s_sub_u32 s31, s31, 1
    s_waitcnt vmcnt(0)
    v_cmp_ne_u32 vcc, 1, v10
    s_cmp_eq_u32 s31, 0
    s_cbranch_scc1 F_lgo
    s_cbranch_vccnz F_spin37_r
    s_branch F_lgo
F_l3:
    s_bitcmp1_b32 s93, 0
    s_cbranch_scc1 F_lv
    s_waitcnt vmcnt(6)
    s_barrier
    ds_read_b128 v[84:87], v36 offset:0
    ds_read_b64_tr_b16 v[140:141], v32 offset:0
    ds_read_b64_tr_b16 v[142:143], v32 offset:224
    ds_read_b128 v[88:91], v38 offset:0
    ds_read_b64_tr_b16 v[144:145], v34 offset:0
    ds_read_b64_tr_b16 v[146:147], v34 offset:224
    s_add_u32 m0, s59, 65536
    s_mul_i32 s56, s100, 3584
    s_mov_b32 exec_hi, 0xffffff
    buffer_load_dwordx4 v29, s[8:11], s56 offen lds
    s_mov_b32 exec_hi, -1
    s_add_u32 m0, s97, 65536
    s_lshl_b32 s56, s100, 7
    buffer_load_dwordx4 v30, s[4:7], s56 offen lds
    s_add_u32 s100, s100, 1
    s_cmp_eq_u32 s100, 7
    s_cselect_b32 s100, 0, s100
    s_waitcnt vmcnt(6)
    s_barrier
    ds_read_b128 v[92:95], v36 offset:16384
    ds_read_b64_tr_b16 v[148:149], v32 offset:16384
    ds_read_b64_tr_b16 v[150:151], v32 offset:16608
    ds_read_b128 v[96:99], v38 offset:16384
    ds_read_b64_tr_b16 v[152:153], v34 offset:16384
    ds_read_b64_tr_b16 v[154:155], v34 offset:16608
    s_add_u32 m0, s59, 81920
    s_mul_i32 s56, s100, 3584
    s_mov_b32 exec_hi, 0xffffff
    buffer_load_dwordx4 v29, s[8:11], s56 offen lds
    s_mov_b32 exec_hi, -1
    s_add_u32 m0, s97, 81920
    s_lshl_b32 s56, s100, 7
    buffer_load_dwordx4 v30, s[4:7], s56 offen lds
    s_add_u32 s100, s100, 1
    s_cmp_eq_u32 s100, 7
    s_cselect_b32 s100, 0, s100
    s_waitcnt lgkmcnt(6)
    v_mfma_f32_32x32x16_bf16 v[204:219], v[140:143], v[84:87], 0
    v_lshlrev_b32 v3, 16, v84
    v_and_b32 v4, s50, v84
    v_fmac_f32 v233, v3, v3
    v_fmac_f32 v235, v4, v4
    v_mfma_f32_32x32x16_bf16 v[204:219], v[144:147], v[88:91], v[204:219]
    v_lshlrev_b32 v5, 16, v85
    v_and_b32 v6, s50, v85
    v_fmac_f32 v233, v5, v5
    v_fmac_f32 v235, v6, v6
    v_mfma_f32_16x16x32_bf16 v[224:227], v[228:231], v[84:87], 0
    s_cmp_eq_u32 s94, 0
    v_lshlrev_b32 v3, 16, v86
    v_and_b32 v4, s50, v86
    v_fmac_f32 v233, v3, v3
    v_fmac_f32 v235, v4, v4
    s_cbranch_scc0 F_cs19
    v_mfma_f32_16x16x32_bf16 v[220:223], v[228:231], v[140:143], v[220:223]
    v_mfma_f32_16x16x32_bf16 v[220:223], v[228:231], v[144:147], v[220:223]
F_cs19:
    v_lshlrev_b32 v5, 16, v87
    v_and_b32 v6, s50, v87
    v_fmac_f32 v233, v5, v5
    v_fmac_f32 v235, v6, v6
    s_waitcnt vmcnt(6)
    s_barrier
    ds_read_b128 v[100:103], v36 offset:32768
    ds_read_b64_tr_b16 v[156:157], v32 offset:32768
    ds_read_b64_tr_b16 v[158:159], v32 offset:32992
    ds_read_b128 v[104:107], v38 offset:32768
    ds_read_b64_tr_b16 v[160:161], v34 offset:32768
    ds_read_b64_tr_b16 v[162:163], v34 offset:32992
    s_add_u32 m0, s59, 98304
    s_mul_i32 s56, s100, 3584
    s_mov_b32 exec_hi, 0xffffff
    buffer_load_dwordx4 v29, s[8:11], s56 offen lds
    s_mov_b32 exec_hi, -1
    s_add_u32 m0, s97, 98304
    s_lshl_b32 s56, s100, 7
    buffer_load_dwordx4 v30, s[4:7], s56 offen lds
    s_add_u32 s100, s100, 1
    s_cmp_eq_u32 s100, 7
    s_cselect_b32 s100, 0, s100
    s_waitcnt lgkmcnt(6)
    v_mfma_f32_32x32x16_bf16 v[204:219], v[148:151], v[92:95], v[204:219]
    v_lshlrev_b32 v3, 16, v92
    v_and_b32 v4, s50, v92
    v_fmac_f32 v233, v3, v3
    v_fmac_f32 v235, v4, v4
    v_mfma_f32_32x32x16_bf16 v[204:219], v[152:155], v[96:99], v[204:219]
    v_lshlrev_b32 v5, 16, v93
    v_and_b32 v6, s50, v93
    v_fmac_f32 v233, v5, v5
    v_fmac_f32 v235, v6, v6
    v_mfma_f32_16x16x32_bf16 v[224:227], v[228:231], v[92:95], v[224:227]
    s_cmp_eq_u32 s94, 1
    v_lshlrev_b32 v3, 16, v94
    v_and_b32 v4, s50, v94
    v_fmac_f32 v233, v3, v3
    v_fmac_f32 v235, v4, v4
    s_cbranch_scc0 F_cs20
    v_mfma_f32_16x16x32_bf16 v[220:223], v[228:231], v[148:151], v[220:223]
    v_mfma_f32_16x16x32_bf16 v[220:223], v[228:231], v[152:155], v[220:223]
F_cs20:
    v_lshlrev_b32 v5, 16, v95
    v_and_b32 v6, s50, v95
    v_fmac_f32 v233, v5, v5
    v_fmac_f32 v235, v6, v6
    s_waitcnt vmcnt(6)
    s_barrier
    ds_read_b128 v[108:111], v36 offset:49152
    ds_read_b64_tr_b16 v[164:165], v32 offset:49152
    ds_read_b64_tr_b16 v[166:167], v32 offset:49376
    ds_read_b128 v[112:115], v38 offset:49152
    ds_read_b64_tr_b16 v[168:169], v34 offset:49152
    ds_read_b64_tr_b16 v[170:171], v34 offset:49376
    buffer_store_dwordx4 v[24:27], v2, s[16:19], s40 offen sc1
    s_mov_b64 exec, 0xff
    buffer_store_dwordx4 v[24:27], v2, s[16:19], s51 offen sc1
    s_mov_b64 exec, 0x7f
    buffer_store_dword v21, v20, s[16:19], 0 offen sc1
    s_mov_b64 exec, -1
    s_waitcnt lgkmcnt(6)
    v_mfma_f32_32x32x16_bf16 v[204:219], v[156:159], v[100:103], v[204:219]
    v_lshlrev_b32 v3, 16, v100
    v_and_b32 v4, s50, v100
    v_fmac_f32 v233, v3, v3
    v_fmac_f32 v235, v4, v4
    v_mfma_f32_32x32x16_bf16 v[204:219], v[160:163], v[104:107], v[204:219]
F_pgL3_0:
    s_cbranch_execz F_ret
    v_lshlrev_b32 v5, 16, v101
    v_and_b32 v6, s50, v101
    v_fmac_f32 v233, v5, v5
    v_fmac_f32 v235, v6, v6
    v_mfma_f32_16x16x32_bf16 v[224:227], v[228:231], v[100:103], v[224:227]
    s_cmp_eq_u32 s94, 0
    v_lshlrev_b32 v3, 16, v102
    v_and_b32 v4, s50, v102
    v_fmac_f32 v233, v3, v3
    v_fmac_f32 v235, v4, v4
    s_cbranch_scc0 F_cs21
    v_mfma_f32_16x16x32_bf16 v[220:223], v[228:231], v[156:159], v[220:223]
    v_mfma_f32_16x16x32_bf16 v[220:223], v[228:231], v[160:163], v[220:223]
F_cs21:
    v_lshlrev_b32 v5, 16, v103
    v_and_b32 v6, s50, v103
    v_fmac_f32 v233, v5, v5
    v_fmac_f32 v235, v6, v6
    s_waitcnt vmcnt(7)
    s_barrier
    ds_read_b128 v[116:119], v37 offset:0
    ds_read_b64_tr_b16 v[172:173], v33 offset:0
    ds_read_b64_tr_b16 v[174:175], v33 offset:224
    ds_read_b128 v[120:123], v39 offset:0
    ds_read_b64_tr_b16 v[176:177], v35 offset:0
    ds_read_b64_tr_b16 v[178:179], v35 offset:224
    s_mul_i32 s57, s96, 8
    buffer_load_dwordx4 v[140:143], v15, s[12:15], s57 offen
    s_add_u32 s57, s57, s96
    buffer_load_dwordx4 v[144:147], v15, s[12:15], s57 offen
    s_add_u32 s57, s57, s96
    s_waitcnt lgkmcnt(6)
    v_mfma_f32_32x32x16_bf16 v[204:219], v[164:167], v[108:111], v[204:219]
    v_lshlrev_b32 v3, 16, v108
    v_and_b32 v4, s50, v108
    v_fmac_f32 v233, v3, v3
    v_fmac_f32 v235, v4, v4
    v_mfma_f32_32x32x16_bf16 v[204:219], v[168:171], v[112:115], v[204:219]
    v_lshlrev_b32 v5, 16, v109
    v_and_b32 v6, s50, v109
    v_fmac_f32 v233, v5, v5
    v_fmac_f32 v235, v6, v6
    v_mfma_f32_16x16x32_bf16 v[224:227], v[228:231], v[108:111], v[224:227]
    s_cmp_eq_u32 s94, 1
    v_lshlrev_b32 v3, 16, v110
    v_and_b32 v4, s50, v110
    v_fmac_f32 v233, v3, v3
    v_fmac_f32 v235, v4, v4
    s_cbranch_scc0 F_cs22
    v_mfma_f32_16x16x32_bf16 v[220:223], v[228:231], v[164:167], v[220:223]
    v_mfma_f32_16x16x32_bf16 v[220:223], v[228:231], v[168:171], v[220:223]
F_cs22:
    v_lshlrev_b32 v5, 16, v111
    v_and_b32 v6, s50, v111
    v_fmac_f32 v233, v5, v5
    v_fmac_f32 v235, v6, v6
    s_waitcnt vmcnt(7)
    s_barrier
    ds_read_b128 v[124:127], v37 offset:16384
    ds_read_b64_tr_b16 v[180:181], v33 offset:16384
    ds_read_b64_tr_b16 v[182:183], v33 offset:16608
    ds_read_b128 v[128:131], v39 offset:16384
    ds_read_b64_tr_b16 v[184:185], v35 offset:16384
    ds_read_b64_tr_b16 v[186:187], v35 offset:16608
    buffer_load_dwordx4 v[148:151], v15, s[12:15], s57 offen
    s_add_u32 s57, s57, s96
    buffer_load_dwordx4 v[152:155], v15, s[12:15], s57 offen
    s_add_u32 s57, s57, s96
    s_waitcnt lgkmcnt(6)
    v_mfma_f32_32x32x16_bf16 v[204:219], v[172:175], v[116:119], v[204:219]
    v_lshlrev_b32 v3, 16, v116
    v_and_b32 v4, s50, v116
    v_fmac_f32 v233, v3, v3
    v_fmac_f32 v235, v4, v4
    v_mfma_f32_32x32x16_bf16 v[204:219], v[176:179], v[120:123], v[204:219]
    v_lshlrev_b32 v5, 16, v117
    v_and_b32 v6, s50, v117
    v_fmac_f32 v233, v5, v5
    v_fmac_f32 v235, v6, v6
    v_mfma_f32_16x16x32_bf16 v[224:227], v[228:231], v[116:119], v[224:227]
    s_cmp_eq_u32 s94, 0
    v_lshlrev_b32 v3, 16, v118
    v_and_b32 v4, s50, v118
    v_fmac_f32 v233, v3, v3
    v_fmac_f32 v235, v4, v4
    s_cbranch_scc0 F_cs23
    v_mfma_f32_16x16x32_bf16 v[220:223], v[228:231], v[172:175], v[220:223]
    v_mfma_f32_16x16x32_bf16 v[220:223], v[228:231], v[176:179], v[220:223]
F_cs23:
    v_lshlrev_b32 v5, 16, v119
    v_and_b32 v6, s50, v119
    v_fmac_f32 v233, v5, v5
    v_fmac_f32 v235, v6, v6
    s_waitcnt vmcnt(7)
    s_barrier
    ds_read_b128 v[132:135], v37 offset:32768
    ds_read_b64_tr_b16 v[188:189], v33 offset:32768
    ds_read_b64_tr_b16 v[190:191], v33 offset:32992
    ds_read_b128 v[136:139], v39 offset:32768
    ds_read_b64_tr_b16 v[192:193], v35 offset:32768
    ds_read_b64_tr_b16 v[194:195], v35 offset:32992
    buffer_load_dwordx4 v[156:159], v15, s[12:15], s57 offen
    s_add_u32 s57, s57, s96
    buffer_load_dwordx4 v[160:163], v15, s[12:15], s57 offen
    s_mov_b32 s57, 0
    s_waitcnt lgkmcnt(6)
    v_mfma_f32_32x32x16_bf16 v[204:219], v[180:183], v[124:127], v[204:219]
    v_lshlrev_b32 v3, 16, v124
    v_and_b32 v4, s50, v124
    v_fmac_f32 v233, v3, v3
    v_fmac_f32 v235, v4, v4
    v_mfma_f32_32x32x16_bf16 v[204:219], v[184:187], v[128:131], v[204:219]
    v_lshlrev_b32 v5, 16, v125
    v_and_b32 v6, s50, v125
    v_fmac_f32 v233, v5, v5
    v_fmac_f32 v235, v6, v6
    v_mfma_f32_16x16x32_bf16 v[224:227], v[228:231], v[124:127], v[224:227]
    s_cmp_eq_u32 s94, 1
    v_lshlrev_b32 v3, 16, v126
    v_and_b32 v4, s50, v126
    v_fmac_f32 v233, v3, v3
    v_fmac_f32 v235, v4, v4
    s_cbranch_scc0 F_cs24
    v_mfma_f32_16x16x32_bf16 v[220:223], v[228:231], v[180:183], v[220:223]
    v_mfma_f32_16x16x32_bf16 v[220:223], v[228:231], v[184:187], v[220:223]
F_cs24:
    v_lshlrev_b32 v5, 16, v127
    v_and_b32 v6, s50, v127
    v_fmac_f32 v233, v5, v5
    v_fmac_f32 v235, v6, v6
    s_waitcnt lgkmcnt(0)
    v_mfma_f32_32x32x16_bf16 v[204:219], v[188:191], v[132:135], v[204:219]
    v_lshlrev_b32 v3, 16, v132
    v_and_b32 v4, s50, v132
    v_fmac_f32 v233, v3, v3
    v_fmac_f32 v235, v4, v4
    v_mfma_f32_32x32x16_bf16 v[204:219], v[192:195], v[136:139], v[204:219]
    v_lshlrev_b32 v5, 16, v133
    v_and_b32 v6, s50, v133
    v_fmac_f32 v233, v5, v5
    v_fmac_f32 v235, v6, v6
    v_mfma_f32_16x16x32_bf16 v[224:227], v[228:231], v[132:135], v[224:227]
    s_cmp_eq_u32 s94, 0
    v_lshlrev_b32 v3, 16, v134
    v_and_b32 v4, s50, v134
    v_fmac_f32 v233, v3, v3
    v_fmac_f32 v235, v4, v4
    s_cbranch_scc0 F_cs25
    v_mfma_f32_16x16x32_bf16 v[220:223], v[228:231], v[188:191], v[220:223]
    v_mfma_f32_16x16x32_bf16 v[220:223], v[228:231], v[192:195], v[220:223]
F_cs25:
    v_lshlrev_b32 v5, 16, v135
    v_and_b32 v6, s50, v135
    v_fmac_f32 v233, v5, v5
    v_fmac_f32 v235, v6, v6
    v_add_f32 v233, v233, v235
    v_mov_b32 v235, v233
    s_cmp_lt_u32 s93, 2
    s_nop 0
    v_permlane32_swap_b32 v233, v235
    v_add_f32 v233, v233, v235
    v_mov_b32 v232, v224
    ds_write_b64 v45, v[232:233]
    ds_write_b32 v47, v220
    s_cbranch_scc0 F_lh0
    ds_write_b128 v48, v[212:215]
    ds_write_b128 v48, v[216:219] offset:1024
    v_cmp_gt_u32 vcc, 32, v1
    s_lshl_b32 s56, s52, 12
    s_add_u32 s56, s56, 2097152
    s_waitcnt lgkmcnt(0)
    s_barrier
    ds_read_b128 v[68:71], v44
    ds_read_b128 v[72:75], v44 offset:16
    ds_read_b128 v[76:79], v46
    ds_read_b128 v[52:55], v49
    ds_read_b128 v[56:59], v49 offset:1024
    s_waitcnt lgkmcnt(3)
    v_add_f32 v68, v68, v70
    v_add_f32 v69, v69, v71
    v_add_f32 v72, v72, v74
    v_add_f32 v73, v73, v75
    v_add_f32 v232, v68, v72
    v_add_f32 v233, v69, v73
    v_mul_f32 v232, 0xbb124925, v232
    v_mul_f32 v3, 0x3b124925, v233
    v_cvt_pk_bf16_f32 v4, v232, v232
    v_fma_f32 v3, -v232, v232, v3
    v_and_b32 v4, 0xffff0000, v4
    v_max_f32 v3, 0, v3
    v_sub_f32 v4, v232, v4
    v_add_f32 v3, 0x3727c5ac, v3
    v_cvt_pk_bf16_f32 v24, v232, v4
    v_rsq_f32 v233, v3
    s_waitcnt lgkmcnt(2)
    v_add_f32 v76, v76, v77
    v_add_f32 v78, v78, v79
    v_cndmask_b32 v18, 0, v24, vcc
    v_add_f32 v76, v76, v78
    v_cndmask_b32 v19, 0, v24, vcc
    v_cvt_pk_bf16_f32 v222, v76, v76
    v_and_b32 v3, 0xffff0000, v222
    v_sub_f32 v3, v76, v3
    v_cvt_pk_bf16_f32 v223, v3, v3
    s_nop 1
    v_mfma_f32_32x32x8_bf16 v[204:219], v[222:223], v[18:19], v[204:219]
F_pgL3_1:
    s_cbranch_execz F_ret
    v_mov_b32 v25, v24
    v_mul_f32 v26, 0x3e8b97f6, v233
    v_mul_f32 v27, v233, v233
    s_lshl_b32 s28, s52, 9
    s_add_u32 s28, s28, 2457600
    s_mov_b32 exec_hi, 0
    buffer_store_dwordx4 v[24:27], v2, s[16:19], s28 offen sc1
    s_mov_b32 exec_hi, -1
    s_waitcnt lgkmcnt(0)
    s_nop 2
    v_add_f32 v52, v52, v204
    v_add_f32 v53, v53, v205
    v_add_f32 v54, v54, v206
    v_add_f32 v55, v55, v207
    v_add_f32 v56, v56, v208
    v_add_f32 v57, v57, v209
    v_add_f32 v58, v58, v210
    v_add_f32 v59, v59, v211
    v_mul_f32 v52, v52, v233
    v_mul_f32 v53, v53, v233
    v_mul_f32 v54, v54, v233
    v_mul_f32 v55, v55, v233
    v_mul_f32 v56, v56, v233
    v_mul_f32 v57, v57, v233
    v_mul_f32 v58, v58, v233
    v_mul_f32 v59, v59, v233
    v_cvt_pk_bf16_f32 v68, v52, v53
    v_cvt_pk_bf16_f32 v69, v54, v55
    v_cvt_pk_bf16_f32 v70, v56, v57
    v_cvt_pk_bf16_f32 v71, v58, v59
    buffer_store_dwordx4 v[68:71], v2, s[16:19], s56 offen sc1
    v_mov_b32 v3, 0
    v_dot2c_f32_bf16 v3, v68, v68
    v_dot2c_f32_bf16 v3, v69, v69
    v_dot2c_f32_bf16 v3, v70, v70
    v_dot2c_f32_bf16 v3, v71, v71
    s_nop 2
    v_mov_b32 v4, v3
    s_nop 1
    v_permlane32_swap_b32 v3, v4
    v_add_f32 v3, v3, v4
    s_nop 1
    v_max_f32_dpp v3, v3, v3 quad_perm:[1,0,3,2] row_mask:0xf bank_mask:0xf
    s_nop 1
    v_max_f32_dpp v3, v3, v3 quad_perm:[2,3,0,1] row_mask:0xf bank_mask:0xf
    s_nop 1
    v_max_f32_dpp v3, v3, v3 row_half_mirror row_mask:0xf bank_mask:0xf
    s_nop 1
    v_max_f32_dpp v3, v3, v3 row_mirror row_mask:0xf bank_mask:0xf
    s_lshl_b32 s28, s52, 3
    s_add_u32 s28, s28, 2359296
    v_mov_b32 v4, v3
    s_nop 1
    v_permlane16_swap_b32 v3, v4
    v_max_f32 v3, v3, v4
    s_mov_b64 exec, 1
    buffer_store_dword v3, off, s[16:19], s28 sc1
    s_mov_b64 exec, -1
    s_branch F_kvdone
F_lh0:
    ds_write_b128 v48, v[204:207]
    ds_write_b128 v48, v[208:211] offset:1024
    v_cmp_gt_u32 vcc, 32, v1
    s_lshl_b32 s56, s52, 12
    s_add_u32 s56, s56, 2098176
    s_waitcnt lgkmcnt(0)
    s_barrier
    ds_read_b128 v[68:71], v44
    ds_read_b128 v[72:75], v44 offset:16
    ds_read_b128 v[76:79], v46
    ds_read_b128 v[52:55], v49
    ds_read_b128 v[56:59], v49 offset:1024
    s_waitcnt lgkmcnt(3)
    v_add_f32 v68, v68, v70
    v_add_f32 v69, v69, v71
    v_add_f32 v72, v72, v74
    v_add_f32 v73, v73, v75
    v_add_f32 v232, v68, v72
    v_add_f32 v233, v69, v73
    v_mul_f32 v232, 0xbb124925, v232
    v_mul_f32 v3, 0x3b124925, v233
    v_cvt_pk_bf16_f32 v4, v232, v232
    v_fma_f32 v3, -v232, v232, v3
    v_and_b32 v4, 0xffff0000, v4
    v_max_f32 v3, 0, v3
    v_sub_f32 v4, v232, v4
    v_add_f32 v3, 0x3727c5ac, v3
    v_cvt_pk_bf16_f32 v24, v232, v4
    v_rsq_f32 v233, v3
    s_waitcnt lgkmcnt(2)
    v_add_f32 v76, v76, v77
    v_add_f32 v78, v78, v79
    v_cndmask_b32 v18, 0, v24, vcc
    v_add_f32 v76, v76, v78
    v_cndmask_b32 v19, 0, v24, vcc
    v_cvt_pk_bf16_f32 v222, v76, v76
    v_and_b32 v3, 0xffff0000, v222
    v_sub_f32 v3, v76, v3
    v_cvt_pk_bf16_f32 v223, v3, v3
    s_nop 1
    v_mfma_f32_32x32x8_bf16 v[204:219], v[222:223], v[18:19], v[204:219]
    s_waitcnt lgkmcnt(0)
    s_nop 10
    v_add_f32 v52, v52, v212
    v_add_f32 v53, v53, v213
    v_add_f32 v54, v54, v214
    v_add_f32 v55, v55, v215
    v_add_f32 v56, v56, v216
    v_add_f32 v57, v57, v217
    v_add_f32 v58, v58, v218
    v_add_f32 v59, v59, v219
    v_mul_f32 v52, v52, v233
    v_mul_f32 v53, v53, v233
    v_mul_f32 v54, v54, v233
    v_mul_f32 v55, v55, v233
    v_mul_f32 v56, v56, v233
    v_mul_f32 v57, v57, v233
    v_mul_f32 v58, v58, v233
    v_mul_f32 v59, v59, v233
    v_cvt_pk_bf16_f32 v68, v52, v53
    v_cvt_pk_bf16_f32 v69, v54, v55
    v_cvt_pk_bf16_f32 v70, v56, v57
    v_cvt_pk_bf16_f32 v71, v58, v59
    v_mov_b32 v4, 0x3f803f80
    v_mov_b32 v5, 0x3f80
    v_cndmask_b32 v70, v4, v70, vcc
    v_cndmask_b32 v71, v5, v71, vcc
    buffer_store_dwordx4 v[68:71], v2, s[16:19], s56 offen sc1
    v_mov_b32 v3, 0
    v_dot2c_f32_bf16 v3, v68, v68
    v_dot2c_f32_bf16 v3, v69, v69
    v_dot2c_f32_bf16 v3, v70, v70
    v_dot2c_f32_bf16 v3, v71, v71
    s_nop 2
    v_mov_b32 v4, v3
    s_nop 1
    v_permlane32_swap_b32 v3, v4
    v_add_f32 v3, v3, v4
    s_nop 1
    v_max_f32_dpp v3, v3, v3 quad_perm:[1,0,3,2] row_mask:0xf bank_mask:0xf
    s_nop 1
    v_max_f32_dpp v3, v3, v3 quad_perm:[2,3,0,1] row_mask:0xf bank_mask:0xf
    s_nop 1
    v_max_f32_dpp v3, v3, v3 row_half_mirror row_mask:0xf bank_mask:0xf
    s_nop 1
    v_max_f32_dpp v3, v3, v3 row_mirror row_mask:0xf bank_mask:0xf
    s_lshl_b32 s28, s52, 3
    s_add_u32 s28, s28, 2359300
    v_mov_b32 v4, v3
    s_nop 1
    v_permlane16_swap_b32 v3, v4
    v_max_f32 v3, v3, v4
    s_mov_b64 exec, 1
    buffer_store_dword v3, off, s[16:19], s28 sc1
    s_mov_b64 exec, -1
    s_branch F_kvdone
F_lv:
    s_waitcnt vmcnt(6)
    s_barrier
    ds_read_b128 v[84:87], v36 offset:0
    ds_read_b64_tr_b16 v[140:141], v32 offset:0
    ds_read_b64_tr_b16 v[142:143], v32 offset:224
    ds_read_b128 v[88:91], v38 offset:0
    ds_read_b64_tr_b16 v[144:145], v34 offset:0
    ds_read_b64_tr_b16 v[146:147], v34 offset:224
    s_add_u32 m0, s59, 65536
    s_mul_i32 s56, s100, 3584
    s_mov_b32 exec_hi, 0xffffff
    buffer_load_dwordx4 v29, s[8:11], s56 offen lds
    s_mov_b32 exec_hi, -1
    s_add_u32 m0, s97, 65536
    s_lshl_b32 s56, s100, 7
    buffer_load_dwordx4 v30, s[4:7], s56 offen lds
    s_add_u32 s100, s100, 1
    s_cmp_eq_u32 s100, 7
    s_cselect_b32 s100, 0, s100
    s_waitcnt vmcnt(6)
    s_barrier
    ds_read_b128 v[92:95], v36 offset:16384
    ds_read_b64_tr_b16 v[148:149], v32 offset:16384
    ds_read_b64_tr_b16 v[150:151], v32 offset:16608
    ds_read_b128 v[96:99], v38 offset:16384
    ds_read_b64_tr_b16 v[152:153], v34 offset:16384
    ds_read_b64_tr_b16 v[154:155], v34 offset:16608
    s_add_u32 m0, s59, 81920
    s_mul_i32 s56, s100, 3584
    s_mov_b32 exec_hi, 0xffffff
    buffer_load_dwordx4 v29, s[8:11], s56 offen lds
    s_mov_b32 exec_hi, -1
    s_add_u32 m0, s97, 81920
    s_lshl_b32 s56, s100, 7
    buffer_load_dwordx4 v30, s[4:7], s56 offen lds
    s_add_u32 s100, s100, 1
    s_cmp_eq_u32 s100, 7
    s_cselect_b32 s100, 0, s100
    s_waitcnt lgkmcnt(6)
    v_mfma_f32_32x32x16_bf16 v[204:219], v[84:87], v[140:143], 0
    v_lshlrev_b32 v3, 16, v84
    v_and_b32 v4, s50, v84
    v_fmac_f32 v233, v3, v3
    v_fmac_f32 v235, v4, v4
    v_mfma_f32_32x32x16_bf16 v[204:219], v[88:91], v[144:147], v[204:219]
F_pgL3_2:
    s_cbranch_execz F_ret
    v_lshlrev_b32 v5, 16, v85
    v_and_b32 v6, s50, v85
    v_fmac_f32 v233, v5, v5
    v_fmac_f32 v235, v6, v6
    v_mfma_f32_16x16x32_bf16 v[224:227], v[228:231], v[84:87], 0
    s_cmp_eq_u32 s94, 0
    v_lshlrev_b32 v3, 16, v86
    v_and_b32 v4, s50, v86
    v_fmac_f32 v233, v3, v3
    v_fmac_f32 v235, v4, v4
    s_cbranch_scc0 F_cs26
    v_mfma_f32_16x16x32_bf16 v[220:223], v[228:231], v[140:143], v[220:223]
    v_mfma_f32_16x16x32_bf16 v[220:223], v[228:231], v[144:147], v[220:223]
F_cs26:
    v_lshlrev_b32 v5, 16, v87
    v_and_b32 v6, s50, v87
    v_fmac_f32 v233, v5, v5
    v_fmac_f32 v235, v6, v6
    s_waitcnt vmcnt(6)
    s_barrier
    ds_read_b128 v[100:103], v36 offset:32768
    ds_read_b64_tr_b16 v[156:157], v32 offset:32768
    ds_read_b64_tr_b16 v[158:159], v32 offset:32992
    ds_read_b128 v[104:107], v38 offset:32768
    ds_read_b64_tr_b16 v[160:161], v34 offset:32768
    ds_read_b64_tr_b16 v[162:163], v34 offset:32992
    s_add_u32 m0, s59, 98304
    s_mul_i32 s56, s100, 3584
    s_mov_b32 exec_hi, 0xffffff
    buffer_load_dwordx4 v29, s[8:11], s56 offen lds
    s_mov_b32 exec_hi, -1
    s_add_u32 m0, s97, 98304
    s_lshl_b32 s56, s100, 7
    buffer_load_dwordx4 v30, s[4:7], s56 offen lds
    s_add_u32 s100, s100, 1
    s_cmp_eq_u32 s100, 7
    s_cselect_b32 s100, 0, s100
    s_waitcnt lgkmcnt(6)
    v_mfma_f32_32x32x16_bf16 v[204:219], v[92:95], v[148:151], v[204:219]
    v_lshlrev_b32 v3, 16, v92
    v_and_b32 v4, s50, v92
    v_fmac_f32 v233, v3, v3
    v_fmac_f32 v235, v4, v4
    v_mfma_f32_32x32x16_bf16 v[204:219], v[96:99], v[152:155], v[204:219]
    v_lshlrev_b32 v5, 16, v93
    v_and_b32 v6, s50, v93
    v_fmac_f32 v233, v5, v5
    v_fmac_f32 v235, v6, v6
    v_mfma_f32_16x16x32_bf16 v[224:227], v[228:231], v[92:95], v[224:227]
    s_cmp_eq_u32 s94, 1
    v_lshlrev_b32 v3, 16, v94
    v_and_b32 v4, s50, v94
    v_fmac_f32 v233, v3, v3
    v_fmac_f32 v235, v4, v4
    s_cbranch_scc0 F_cs27
    v_mfma_f32_16x16x32_bf16 v[220:223], v[228:231], v[148:151], v[220:223]
    v_mfma_f32_16x16x32_bf16 v[220:223], v[228:231], v[152:155], v[220:223]
F_cs27:
    v_lshlrev_b32 v5, 16, v95
    v_and_b32 v6, s50, v95
    v_fmac_f32 v233, v5, v5
    v_fmac_f32 v235, v6, v6
    s_waitcnt vmcnt(6)
    s_barrier
    ds_read_b128 v[108:111], v36 offset:49152
    ds_read_b64_tr_b16 v[164:165], v32 offset:49152
    ds_read_b64_tr_b16 v[166:167], v32 offset:49376
    ds_read_b128 v[112:115], v38 offset:49152
    ds_read_b64_tr_b16 v[168:169], v34 offset:49152
    ds_read_b64_tr_b16 v[170:171], v34 offset:49376
    buffer_store_dwordx4 v[24:27], v2, s[16:19], s40 offen sc1
    s_mov_b64 exec, 0xff
    buffer_store_dwordx4 v[24:27], v2, s[16:19], s51 offen sc1
    s_mov_b64 exec, 0x7f
    buffer_store_dword v21, v20, s[16:19], 0 offen sc1
    s_mov_b64 exec, -1
    s_waitcnt lgkmcnt(6)
    v_mfma_f32_32x32x16_bf16 v[204:219], v[100:103], v[156:159], v[204:219]
    v_lshlrev_b32 v3, 16, v100
    v_and_b32 v4, s50, v100
    v_fmac_f32 v233, v3, v3
    v_fmac_f32 v235, v4, v4
    v_mfma_f32_32x32x16_bf16 v[204:219], v[104:107], v[160:163], v[204:219]
    v_lshlrev_b32 v5, 16, v101
    v_and_b32 v6, s50, v101
    v_fmac_f32 v233, v5, v5
    v_fmac_f32 v235, v6, v6
    v_mfma_f32_16x16x32_bf16 v[224:227], v[228:231], v[100:103], v[224:227]
    s_cmp_eq_u32 s94, 0
    v_lshlrev_b32 v3, 16, v102
    v_and_b32 v4, s50, v102
    v_fmac_f32 v233, v3, v3
    v_fmac_f32 v235, v4, v4
    s_cbranch_scc0 F_cs28
    v_mfma_f32_16x16x32_bf16 v[220:223], v[228:231], v[156:159], v[220:223]
    v_mfma_f32_16x16x32_bf16 v[220:223], v[228:231], v[160:163], v[220:223]
F_cs28:
    v_lshlrev_b32 v5, 16, v103
    v_and_b32 v6, s50, v103
    v_fmac_f32 v233, v5, v5
    v_fmac_f32 v235, v6, v6
    s_waitcnt vmcnt(7)
    s_barrier
    ds_read_b128 v[116:119], v37 offset:0
    ds_read_b64_tr_b16 v[172:173], v33 offset:0
    ds_read_b64_tr_b16 v[174:175], v33 offset:224
    ds_read_b128 v[120:123], v39 offset:0
    ds_read_b64_tr_b16 v[176:177], v35 offset:0
    ds_read_b64_tr_b16 v[178:179], v35 offset:224
    s_mul_i32 s57, s96, 8
    buffer_load_dwordx4 v[140:143], v15, s[12:15], s57 offen
    s_add_u32 s57, s57, s96
    buffer_load_dwordx4 v[144:147], v15, s[12:15], s57 offen
    s_add_u32 s57, s57, s96
    s_waitcnt lgkmcnt(6)
    v_mfma_f32_32x32x16_bf16 v[204:219], v[108:111], v[164:167], v[204:219]
    v_lshlrev_b32 v3, 16, v108
    v_and_b32 v4, s50, v108
    v_fmac_f32 v233, v3, v3
    v_fmac_f32 v235, v4, v4
    v_mfma_f32_32x32x16_bf16 v[204:219], v[112:115], v[168:171], v[204:219]
    v_lshlrev_b32 v5, 16, v109
    v_and_b32 v6, s50, v109
    v_fmac_f32 v233, v5, v5
    v_fmac_f32 v235, v6, v6
    v_mfma_f32_16x16x32_bf16 v[224:227], v[228:231], v[108:111], v[224:227]
    s_cmp_eq_u32 s94, 1
    v_lshlrev_b32 v3, 16, v110
    v_and_b32 v4, s50, v110
    v_fmac_f32 v233, v3, v3
    v_fmac_f32 v235, v4, v4
    s_cbranch_scc0 F_cs29
    v_mfma_f32_16x16x32_bf16 v[220:223], v[228:231], v[164:167], v[220:223]
    v_mfma_f32_16x16x32_bf16 v[220:223], v[228:231], v[168:171], v[220:223]
F_cs29:
    v_lshlrev_b32 v5, 16, v111
    v_and_b32 v6, s50, v111
    v_fmac_f32 v233, v5, v5
    v_fmac_f32 v235, v6, v6
    s_waitcnt vmcnt(7)
    s_barrier
    ds_read_b128 v[124:127], v37 offset:16384
    ds_read_b64_tr_b16 v[180:181], v33 offset:16384
    ds_read_b64_tr_b16 v[182:183], v33 offset:16608
    ds_read_b128 v[128:131], v39 offset:16384
    ds_read_b64_tr_b16 v[184:185], v35 offset:16384
    ds_read_b64_tr_b16 v[186:187], v35 offset:16608
    buffer_load_dwordx4 v[148:151], v15, s[12:15], s57 offen
    s_add_u32 s57, s57, s96
    buffer_load_dwordx4 v[152:155], v15, s[12:15], s57 offen
    s_add_u32 s57, s57, s96
    s_waitcnt lgkmcnt(6)
    v_mfma_f32_32x32x16_bf16 v[204:219], v[116:119], v[172:175], v[204:219]
    v_lshlrev_b32 v3, 16, v116
    v_and_b32 v4, s50, v116
    v_fmac_f32 v233, v3, v3
    v_fmac_f32 v235, v4, v4
    v_mfma_f32_32x32x16_bf16 v[204:219], v[120:123], v[176:179], v[204:219]
    v_lshlrev_b32 v5, 16, v117
    v_and_b32 v6, s50, v117
    v_fmac_f32 v233, v5, v5
    v_fmac_f32 v235, v6, v6
    v_mfma_f32_16x16x32_bf16 v[224:227], v[228:231], v[116:119], v[224:227]
    s_cmp_eq_u32 s94, 0
    v_lshlrev_b32 v3, 16, v118
    v_and_b32 v4, s50, v118
    v_fmac_f32 v233, v3, v3
    v_fmac_f32 v235, v4, v4
    s_cbranch_scc0 F_cs30
    v_mfma_f32_16x16x32_bf16 v[220:223], v[228:231], v[172:175], v[220:223]
    v_mfma_f32_16x16x32_bf16 v[220:223], v[228:231], v[176:179], v[220:223]
F_cs30:
    v_lshlrev_b32 v5, 16, v119
    v_and_b32 v6, s50, v119
    v_fmac_f32 v233, v5, v5
    v_fmac_f32 v235, v6, v6
    s_waitcnt vmcnt(7)
    s_barrier
    ds_read_b128 v[132:135], v37 offset:32768
    ds_read_b64_tr_b16 v[188:189], v33 offset:32768
    ds_read_b64_tr_b16 v[190:191], v33 offset:32992
    ds_read_b128 v[136:139], v39 offset:32768
    ds_read_b64_tr_b16 v[192:193], v35 offset:32768
    ds_read_b64_tr_b16 v[194:195], v35 offset:32992
    buffer_load_dwordx4 v[156:159], v15, s[12:15], s57 offen
    s_add_u32 s57, s57, s96
    buffer_load_dwordx4 v[160:163], v15, s[12:15], s57 offen
    s_mov_b32 s57, 0
    s_waitcnt lgkmcnt(6)
    v_mfma_f32_32x32x16_bf16 v[204:219], v[124:127], v[180:183], v[204:219]
    v_lshlrev_b32 v3, 16, v124
    v_and_b32 v4, s50, v124
    v_fmac_f32 v233, v3, v3
    v_fmac_f32 v235, v4, v4
    v_mfma_f32_32x32x16_bf16 v[204:219], v[128:131], v[184:187], v[204:219]
    v_lshlrev_b32 v5, 16, v125
    v_and_b32 v6, s50, v125
    v_fmac_f32 v233, v5, v5
    v_fmac_f32 v235, v6, v6
    v_mfma_f32_16x16x32_bf16 v[224:227], v[228:231], v[124:127], v[224:227]
    s_cmp_eq_u32 s94, 1
    v_lshlrev_b32 v3, 16, v126
    v_and_b32 v4, s50, v126
    v_fmac_f32 v233, v3, v3
    v_fmac_f32 v235, v4, v4
    s_cbranch_scc0 F_cs31
    v_mfma_f32_16x16x32_bf16 v[220:223], v[228:231], v[180:183], v[220:223]
F_pgL3_3:
    s_cbranch_execz F_ret
    v_mfma_f32_16x16x32_bf16 v[220:223], v[228:231], v[184:187], v[220:223]
F_cs31:
    v_lshlrev_b32 v5, 16, v127
    v_and_b32 v6, s50, v127
    v_fmac_f32 v233, v5, v5
    v_fmac_f32 v235, v6, v6
    s_waitcnt lgkmcnt(0)
    v_mfma_f32_32x32x16_bf16 v[204:219], v[132:135], v[188:191], v[204:219]
    v_lshlrev_b32 v3, 16, v132
    v_and_b32 v4, s50, v132
    v_fmac_f32 v233, v3, v3
    v_fmac_f32 v235, v4, v4
    v_mfma_f32_32x32x16_bf16 v[204:219], v[136:139], v[192:195], v[204:219]
    v_lshlrev_b32 v5, 16, v133
    v_and_b32 v6, s50, v133
    v_fmac_f32 v233, v5, v5
    v_fmac_f32 v235, v6, v6
    v_mfma_f32_16x16x32_bf16 v[224:227], v[228:231], v[132:135], v[224:227]
    s_cmp_eq_u32 s94, 0
    v_lshlrev_b32 v3, 16, v134
    v_and_b32 v4, s50, v134
    v_fmac_f32 v233, v3, v3
    v_fmac_f32 v235, v4, v4
    s_cbranch_scc0 F_cs32
    v_mfma_f32_16x16x32_bf16 v[220:223], v[228:231], v[188:191], v[220:223]
    v_mfma_f32_16x16x32_bf16 v[220:223], v[228:231], v[192:195], v[220:223]
F_cs32:
    v_lshlrev_b32 v5, 16, v135
    v_and_b32 v6, s50, v135
    v_fmac_f32 v233, v5, v5
    v_fmac_f32 v235, v6, v6
    v_add_f32 v233, v233, v235
    v_mov_b32 v235, v233
    s_cmp_lt_u32 s93, 2
    s_nop 0
    v_permlane32_swap_b32 v233, v235
    v_add_f32 v233, v233, v235
    v_mov_b32 v232, v224
    ds_write_b64 v45, v[232:233]
    ds_write_b32 v47, v220
    s_cbranch_scc0 F_lh1
    ds_write_b128 v48, v[212:215]
    ds_write_b128 v48, v[216:219] offset:1024
    v_cmp_gt_u32 vcc, 32, v1
    s_lshl_b32 s56, s52, 12
    s_add_u32 s56, s56, 2099200
    s_waitcnt lgkmcnt(0)
    s_barrier
    ds_read_b128 v[68:71], v44
    ds_read_b128 v[72:75], v44 offset:16
    ds_read_b128 v[76:79], v46
    ds_read_b128 v[52:55], v49
    ds_read_b128 v[56:59], v49 offset:1024
    s_waitcnt lgkmcnt(3)
    v_add_f32 v68, v68, v70
    v_add_f32 v69, v69, v71
    v_add_f32 v72, v72, v74
    v_add_f32 v73, v73, v75
    v_add_f32 v232, v68, v72
    v_add_f32 v233, v69, v73
    v_mul_f32 v232, 0xbb124925, v232
    v_mul_f32 v3, 0x3b124925, v233
    v_cvt_pk_bf16_f32 v4, v232, v232
    v_fma_f32 v3, -v232, v232, v3
    v_and_b32 v4, 0xffff0000, v4
    v_max_f32 v3, 0, v3
    v_sub_f32 v4, v232, v4
    v_add_f32 v3, 0x3727c5ac, v3
    v_cvt_pk_bf16_f32 v24, v232, v4
    v_rsq_f32 v233, v3
    s_waitcnt lgkmcnt(2)
    v_add_f32 v76, v76, v77
    v_add_f32 v78, v78, v79
    v_cndmask_b32 v18, 0, v24, vcc
    v_add_f32 v76, v76, v78
    v_cndmask_b32 v19, 0, v24, vcc
    ds_write_b32 v50, v233
    ds_read_b128 v[60:63], v51 offset:0
    ds_read_b128 v[64:67], v51 offset:32
    v_cvt_pk_bf16_f32 v222, v76, v76
    v_and_b32 v3, 0xffff0000, v222
    v_sub_f32 v3, v76, v3
    v_cvt_pk_bf16_f32 v223, v3, v3
    s_nop 1
    v_mfma_f32_32x32x8_bf16 v[204:219], v[18:19], v[222:223], v[204:219]
    v_and_b32 v4, 31, v1
    v_cmp_eq_u32 vcc, 28, v4
    v_mov_b32 v3, 0x3f803f80
    s_nop 0
    v_cndmask_b32 v5, 0, v3, vcc
    v_cmp_gt_u32 vcc, 28, v4
    s_waitcnt lgkmcnt(0)
    s_nop 4
    v_add_f32 v52, v52, v204
    v_add_f32 v53, v53, v205
    v_add_f32 v54, v54, v206
    v_add_f32 v55, v55, v207
    v_add_f32 v56, v56, v208
    v_add_f32 v57, v57, v209
    v_add_f32 v58, v58, v210
    v_add_f32 v59, v59, v211
    v_mul_f32 v52, v52, v60
    v_mul_f32 v53, v53, v61
    v_mul_f32 v54, v54, v62
    v_mul_f32 v55, v55, v63
    v_mul_f32 v56, v56, v64
    v_mul_f32 v57, v57, v65
    v_mul_f32 v58, v58, v66
    v_mul_f32 v59, v59, v67
    v_cvt_pk_bf16_f32 v68, v52, v53
    v_cvt_pk_bf16_f32 v69, v54, v55
    v_cvt_pk_bf16_f32 v70, v56, v57
    v_cvt_pk_bf16_f32 v71, v58, v59
    v_cndmask_b32 v68, v5, v68, vcc
    v_cndmask_b32 v69, v5, v69, vcc
    v_cndmask_b32 v70, v5, v70, vcc
    v_cndmask_b32 v71, v5, v71, vcc
    buffer_store_dwordx4 v[68:71], v2, s[16:19], s56 offen sc1
    s_branch F_kvdone
F_lh1:
    ds_write_b128 v48, v[204:207]
    ds_write_b128 v48, v[208:211] offset:1024
    v_cmp_gt_u32 vcc, 32, v1
    s_lshl_b32 s56, s52, 12
    s_add_u32 s56, s56, 2100224
    s_waitcnt lgkmcnt(0)
    s_barrier
    ds_read_b128 v[68:71], v44
    ds_read_b128 v[72:75], v44 offset:16
    ds_read_b128 v[76:79], v46
    ds_read_b128 v[52:55], v49
    ds_read_b128 v[56:59], v49 offset:1024
    s_waitcnt lgkmcnt(3)
    v_add_f32 v68, v68, v70
    v_add_f32 v69, v69, v71
    v_add_f32 v72, v72, v74
    v_add_f32 v73, v73, v75
    v_add_f32 v232, v68, v72
    v_add_f32 v233, v69, v73
    v_mul_f32 v232, 0xbb124925, v232
    v_mul_f32 v3, 0x3b124925, v233
    v_cvt_pk_bf16_f32 v4, v232, v232
    v_fma_f32 v3, -v232, v232, v3
    v_and_b32 v4, 0xffff0000, v4
    v_max_f32 v3, 0, v3
    v_sub_f32 v4, v232, v4
    v_add_f32 v3, 0x3727c5ac, v3
    v_cvt_pk_bf16_f32 v24, v232, v4
    v_rsq_f32 v233, v3
    s_waitcnt lgkmcnt(2)
    v_add_f32 v76, v76, v77
    v_add_f32 v78, v78, v79
F_pgL3_4:
    s_cbranch_execz F_ret
    v_cndmask_b32 v18, 0, v24, vcc
    v_add_f32 v76, v76, v78
    v_cndmask_b32 v19, 0, v24, vcc
    ds_write_b32 v50, v233
    ds_read_b128 v[60:63], v51 offset:64
    ds_read_b128 v[64:67], v51 offset:96
    v_cvt_pk_bf16_f32 v222, v76, v76
    v_and_b32 v3, 0xffff0000, v222
    v_sub_f32 v3, v76, v3
    v_cvt_pk_bf16_f32 v223, v3, v3
    s_nop 1
    v_mfma_f32_32x32x8_bf16 v[204:219], v[18:19], v[222:223], v[204:219]
    v_and_b32 v4, 31, v1
    v_cmp_eq_u32 vcc, 28, v4
    v_mov_b32 v3, 0x3f803f80
    s_nop 0
    v_cndmask_b32 v5, 0, v3, vcc
    v_cmp_gt_u32 vcc, 28, v4
    s_waitcnt lgkmcnt(0)
    s_nop 4
    v_add_f32 v52, v52, v212
    v_add_f32 v53, v53, v213
    v_add_f32 v54, v54, v214
    v_add_f32 v55, v55, v215
    v_add_f32 v56, v56, v216
    v_add_f32 v57, v57, v217
    v_add_f32 v58, v58, v218
    v_add_f32 v59, v59, v219
    v_mul_f32 v52, v52, v60
    v_mul_f32 v53, v53, v61
    v_mul_f32 v54, v54, v62
    v_mul_f32 v55, v55, v63
    v_mul_f32 v56, v56, v64
    v_mul_f32 v57, v57, v65
    v_mul_f32 v58, v58, v66
    v_mul_f32 v59, v59, v67
    v_cvt_pk_bf16_f32 v68, v52, v53
    v_cvt_pk_bf16_f32 v69, v54, v55
    v_cvt_pk_bf16_f32 v70, v56, v57
    v_cvt_pk_bf16_f32 v71, v58, v59
    v_cndmask_b32 v68, v5, v68, vcc
    v_cndmask_b32 v69, v5, v69, vcc
    v_cndmask_b32 v70, v5, v70, vcc
    v_cndmask_b32 v71, v5, v71, vcc
    buffer_store_dwordx4 v[68:71], v2, s[16:19], s56 offen sc1
F_kvdone:
    s_barrier
    buffer_load_dwordx4 v[164:167], v15, s[12:15], s57 offen
    s_add_u32 s57, s57, s96
    buffer_load_dwordx4 v[168:171], v15, s[12:15], s57 offen
    s_add_u32 s57, s57, s96
    s_mov_b64 exec, 0
    s_cmp_eq_u32 s93, 1
    s_cbranch_scc1 F_cll3_1
    s_cmp_eq_u32 s93, 2
    s_cbranch_scc1 F_cll3_2
    s_cmp_eq_u32 s93, 3
    s_cbranch_scc1 F_cll3_3
    s_call_b64 s[28:29], F_pgL3_5
    s_branch F_cll3
F_cll3_1:
    s_call_b64 s[28:29], F_pgL3_6
    s_branch F_cll3
F_cll3_2:
    s_call_b64 s[28:29], F_pgL3_7
    s_branch F_cll3
F_cll3_3:
    s_call_b64 s[28:29], F_pgL3_8
F_cll3:
    s_mov_b64 exec, -1
    s_waitcnt vmcnt(2)
    s_barrier
    s_cmp_eq_u32 s92, 0
    s_cbranch_scc0 F_na
    s_lshl1_add_u32 s28, s90, s3
    s_lshl_b32 s28, s28, 3
    v_mov_b32 v4, 1
    s_mov_b64 exec, 1
    buffer_store_dword v4, off, s[24:27], s28 sc1
    s_mov_b64 exec, -1
F_na:
    s_cmp_eq_u32 s3, 0
    s_cselect_b32 s28, 1, -1
    s_mul_i32 s28, s28, 57344
    v_add_u32 v30, s28, v30
    s_xor_b32 s97, s97, 0x2000
    s_barrier
    buffer_load_dwordx4 v[172:175], v15, s[12:15], s57 offen
    s_add_u32 s57, s57, s96
    buffer_load_dwordx4 v[176:179], v15, s[12:15], s57 offen
    s_add_u32 s57, s57, s96
    buffer_load_dwordx4 v[180:183], v15, s[12:15], s57 offen
    s_add_u32 s57, s57, s96
    buffer_load_dwordx4 v[184:187], v15, s[12:15], s57 offen
    s_add_u32 s57, s57, s96
    buffer_load_dwordx4 v[188:191], v15, s[12:15], s57 offen
    s_add_u32 s57, s57, s96
    buffer_load_dwordx4 v[192:195], v15, s[12:15], s57 offen
    s_add_u32 s57, s57, s96
    s_add_u32 m0, s98, 114688
    s_mul_i32 s58, s100, 57344
    s_mov_b32 exec_hi, 0
    buffer_load_dwordx4 v28, s[20:23], s58 offen lds
    s_mov_b32 exec_hi, -1
    s_add_u32 s100, s100, 1
    s_cmp_eq_u32 s100, 7
    s_cselect_b32 s100, 0, s100
    s_add_u32 m0, s98, 118784
    s_mul_i32 s58, s100, 57344
    s_mov_b32 exec_hi, 0
    buffer_load_dwordx4 v28, s[20:23], s58 offen lds
    s_mov_b32 exec_hi, -1
    s_add_u32 s100, s100, 1
    s_cmp_eq_u32 s100, 7
    s_cselect_b32 s100, 0, s100
    s_add_u32 m0, s98, 122880
    s_mul_i32 s58, s100, 57344
    s_mov_b32 exec_hi, 0
    buffer_load_dwordx4 v28, s[20:23], s58 offen lds
    s_mov_b32 exec_hi, -1
    s_add_u32 s100, s100, 1
    s_cmp_eq_u32 s100, 7
    s_cselect_b32 s100, 0, s100
    s_add_u32 m0, s98, 126976
    s_mul_i32 s58, s100, 57344
    s_mov_b32 exec_hi, 0
    buffer_load_dwordx4 v28, s[20:23], s58 offen lds
    s_mov_b32 exec_hi, -1
    s_add_u32 s100, s100, 1
    s_cmp_eq_u32 s100, 7
    s_cselect_b32 s100, 0, s100
    s_add_u32 m0, s98, 131072
    s_mul_i32 s58, s100, 57344
    s_mov_b32 exec_hi, 0
    buffer_load_dwordx4 v28, s[20:23], s58 offen lds
    s_mov_b32 exec_hi, -1
    s_add_u32 s100, s100, 1
    s_cmp_eq_u32 s100, 7
    s_cselect_b32 s100, 0, s100
    s_add_u32 m0, s98, 135168
    s_mul_i32 s58, s100, 57344
    s_mov_b32 exec_hi, 0
    buffer_load_dwordx4 v28, s[20:23], s58 offen lds
    s_mov_b32 exec_hi, -1
    s_add_u32 s100, s100, 1
    s_cmp_eq_u32 s100, 7
    s_cselect_b32 s100, 0, s100
    s_add_u32 m0, s98, 139264
    s_mul_i32 s58, s100, 57344
    s_mov_b32 exec_hi, 0
    buffer_load_dwordx4 v28, s[20:23], s58 offen lds
    s_mov_b32 exec_hi, -1
    s_add_u32 s100, s100, 1
    s_cmp_eq_u32 s100, 7
    s_cselect_b32 s100, 0, s100
    v_mfma_f32_16x16x32_bf16 v[196:199], v[200:203], v[140:143], 0
    v_mfma_f32_16x16x32_bf16 v[196:199], v[200:203], v[144:147], v[196:199]
    v_mfma_f32_16x16x32_bf16 v[196:199], v[200:203], v[148:151], v[196:199]
    v_mfma_f32_16x16x32_bf16 v[196:199], v[200:203], v[152:155], v[196:199]
    v_mfma_f32_16x16x32_bf16 v[196:199], v[200:203], v[156:159], v[196:199]
    v_mfma_f32_16x16x32_bf16 v[196:199], v[200:203], v[160:163], v[196:199]
    s_waitcnt vmcnt(14)
    v_mfma_f32_16x16x32_bf16 v[196:199], v[200:203], v[164:167], v[196:199]
    s_waitcnt vmcnt(13)
    v_mfma_f32_16x16x32_bf16 v[196:199], v[200:203], v[168:171], v[196:199]
    s_waitcnt vmcnt(12)
    v_mfma_f32_16x16x32_bf16 v[196:199], v[200:203], v[172:175], v[196:199]
    s_waitcnt vmcnt(11)
    v_mfma_f32_16x16x32_bf16 v[196:199], v[200:203], v[176:179], v[196:199]
    s_waitcnt vmcnt(10)
    v_mfma_f32_16x16x32_bf16 v[196:199], v[200:203], v[180:183], v[196:199]
    s_waitcnt vmcnt(9)
    v_mfma_f32_16x16x32_bf16 v[196:199], v[200:203], v[184:187], v[196:199]
    s_waitcnt vmcnt(8)
    v_mfma_f32_16x16x32_bf16 v[196:199], v[200:203], v[188:191], v[196:199]
    s_waitcnt vmcnt(7)
    v_mfma_f32_16x16x32_bf16 v[196:199], v[200:203], v[192:195], v[196:199]
    s_nop 7
    ds_write_b128 v49, v[196:199]
    s_lshl_b32 s29, s93, 10
    v_lshrrev_b32 v4, 5, v1
    v_and_b32 v3, 31, v1
    v_lshlrev_b32 v3, 5, v3
    v_add_u32 v249, 162304, v3
    s_lshl_b32 s28, s93, 3
    v_lshl_add_u32 v3, v4, 2, s28
    v_add_u32 v248, v249, v3
    v_bfe_u32 v5, v1, 2, 2
    v_lshl_add_u32 v5, v4, 3, v5
    v_bfe_u32 v3, v1, 4, 1
    v_and_b32 v4, 3, v1
    v_lshl_add_u32 v3, v3, 2, v4
    v_min_u32 v3, 6, v3
    v_lshlrev_b32 v3, 3, v3
    v_lshl_add_u32 v3, v5, 6, v3
    s_and_b32 s28, s101, 1
    s_lshl3_add_u32 s28, s28, 114688
    v_add_u32 v244, s28, v3
    v_add_u32 v247, s29, v244
    v_mov_b32 v220, 0
    v_mov_b32 v221, 0
    s_waitcnt lgkmcnt(0)
    s_barrier
    s_cmp_eq_u32 s92, 3
    s_cbranch_scc0 F_nocf
    v_lshlrev_b32 v3, 3, v1
    v_add_u32 v3, 147456, v3
    ds_read_b64 v[52:53], v3 offset:0
F_pgL3_5:
    s_cbranch_execz F_ret
    ds_read_b64 v[54:55], v3 offset:2048
    ds_read_b64 v[56:57], v3 offset:4096
    ds_read_b64 v[58:59], v3 offset:6144
    ds_read_b64 v[60:61], v3 offset:8192
    ds_read_b64 v[62:63], v3 offset:10240
    ds_read_b64 v[64:65], v3 offset:12288
    ds_read_b64 v[66:67], v3 offset:14336
    v_bfe_u32 v4, v1, 1, 4
    v_lshlrev_b32 v4, 6, v4
    v_lshrrev_b32 v5, 5, v1
    v_lshl_add_u32 v4, v5, 5, v4
    v_and_b32 v5, 1, v1
    v_lshl_add_u32 v4, v5, 4, v4
    s_waitcnt lgkmcnt(0)
    v_add_f32 v52, v52, v60
    v_add_f32 v53, v53, v61
    v_add_f32 v54, v54, v62
    v_add_f32 v55, v55, v63
    v_add_f32 v56, v56, v64
    v_add_f32 v57, v57, v65
    v_add_f32 v58, v58, v66
    v_add_f32 v59, v59, v67
    v_add_f32 v52, v52, v56
    v_add_f32 v53, v53, v57
    v_add_f32 v54, v54, v58
    v_add_f32 v55, v55, v59
    v_add_f32 v52, v52, v54
    v_add_f32 v53, v53, v55
    v_cvt_pk_bf16_f32 v56, v52, v52
    v_and_b32 v3, 0xffff0000, v56
    v_sub_f32 v3, v52, v3
    v_cvt_pk_bf16_f32 v57, v3, v3
    v_cvt_pk_bf16_f32 v58, v53, v53
    v_and_b32 v5, 0xffff0000, v58
    v_sub_f32 v5, v53, v5
    v_cvt_pk_bf16_f32 v59, v5, v5
    buffer_store_dwordx4 v[56:59], v4, s[16:19], s49 offen sc1
F_nocf:
    s_barrier
    s_add_u32 m0, s97, 0
    s_lshl_b32 s56, s100, 7
    buffer_load_dwordx4 v30, s[4:7], s56 offen lds
    s_add_u32 s100, s100, 1
    s_cmp_eq_u32 s100, 7
    s_cselect_b32 s100, 0, s100
    s_add_u32 m0, s97, 16384
    s_lshl_b32 s56, s100, 7
    buffer_load_dwordx4 v30, s[4:7], s56 offen lds
    s_add_u32 s100, s100, 1
    s_cmp_eq_u32 s100, 7
    s_cselect_b32 s100, 0, s100
    s_add_u32 m0, s97, 32768
    s_lshl_b32 s56, s100, 7
    buffer_load_dwordx4 v30, s[4:7], s56 offen lds
    s_add_u32 s100, s100, 1
    s_cmp_eq_u32 s100, 7
    s_cselect_b32 s100, 0, s100
    s_add_u32 m0, s97, 49152
    s_lshl_b32 s56, s100, 7
    buffer_load_dwordx4 v30, s[4:7], s56 offen lds
    s_add_u32 s100, s100, 1
    s_cmp_eq_u32 s100, 7
    s_cselect_b32 s100, 0, s100
    s_add_u32 m0, s97, 65536
    s_lshl_b32 s56, s100, 7
    buffer_load_dwordx4 v30, s[4:7], s56 offen lds
    s_add_u32 s100, s100, 1
    s_cmp_eq_u32 s100, 7
    s_cselect_b32 s100, 0, s100
    s_add_u32 m0, s97, 81920
    s_lshl_b32 s56, s100, 7
    buffer_load_dwordx4 v30, s[4:7], s56 offen lds
    s_add_u32 s100, s100, 1
    s_cmp_eq_u32 s100, 7
    s_cselect_b32 s100, 0, s100
    s_add_u32 m0, s97, 98304
    s_lshl_b32 s56, s100, 7
    buffer_load_dwordx4 v30, s[4:7], s56 offen lds
    s_add_u32 s100, s100, 1
    s_cmp_eq_u32 s100, 7
    s_cselect_b32 s100, 0, s100
    s_xor_b32 s28, s94, 1
    v_mov_b32 v7, s28
    ds_write_b32 v8, v7
    s_cmp_eq_u32 s94, 0
    s_cbranch_scc0 F_la
    s_mov_b64 exec, 0
    s_cmp_eq_u32 s93, 1
    s_cbranch_scc1 F_cll1_1
    s_cmp_eq_u32 s93, 2
    s_cbranch_scc1 F_cll1_2
    s_cmp_eq_u32 s93, 3
    s_cbranch_scc1 F_cll1_3
    s_call_b64 s[28:29], F_pgG2_8
    s_call_b64 s[28:29], F_pgA2_0
    s_call_b64 s[28:29], F_pgA2_4
    s_branch F_cll1
F_cll1_1:
    s_call_b64 s[28:29], F_pgR_0
    s_call_b64 s[28:29], F_pgA2_1
    s_branch F_cll1
F_cll1_2:
    s_call_b64 s[28:29], F_pgR_1
    s_call_b64 s[28:29], F_pgA2_2
    s_branch F_cll1
F_cll1_3:
    s_call_b64 s[28:29], F_pgG1_8
    s_call_b64 s[28:29], F_pgA2_3
F_cll1:
    s_mov_b64 exec, -1
    s_waitcnt vmcnt(0) lgkmcnt(0)
    s_barrier
    ds_read_b64_tr_b16 v[128:129], v247 offset:0
    ds_read_b64_tr_b16 v[130:131], v247 offset:256
    ds_read_b64_tr_b16 v[132:133], v247 offset:4096
    ds_read_b64_tr_b16 v[134:135], v247 offset:4352
    ds_read_b64_tr_b16 v[136:137], v247 offset:8192
    ds_read_b64_tr_b16 v[138:139], v247 offset:8448
    ds_read_b64_tr_b16 v[140:141], v247 offset:12288
    ds_read_b64_tr_b16 v[142:143], v247 offset:12544
    ds_read_b64_tr_b16 v[144:145], v247 offset:16384
    ds_read_b64_tr_b16 v[146:147], v247 offset:16640
    ds_read_b64_tr_b16 v[148:149], v247 offset:20480
    ds_read_b64_tr_b16 v[150:151], v247 offset:20736
    ds_read_b64_tr_b16 v[152:153], v247 offset:24576
    ds_read_b64_tr_b16 v[154:155], v247 offset:24832
    s_waitcnt lgkmcnt(12)
    v_lshlrev_b32 v3, 16, v128
    v_and_b32 v4, 0xffff0000, v128
    v_add_f32 v220, v220, v3
    v_add_f32 v221, v221, v4
    v_lshlrev_b32 v3, 16, v129
    v_and_b32 v4, 0xffff0000, v129
    v_add_f32 v220, v220, v3
    v_add_f32 v221, v221, v4
    v_lshlrev_b32 v3, 16, v130
    v_and_b32 v4, 0xffff0000, v130
    v_add_f32 v220, v220, v3
    v_add_f32 v221, v221, v4
    v_lshlrev_b32 v3, 16, v131
    v_and_b32 v4, 0xffff0000, v131
    v_add_f32 v220, v220, v3
    v_add_f32 v221, v221, v4
    s_waitcnt lgkmcnt(10)
    v_lshlrev_b32 v3, 16, v132
    v_and_b32 v4, 0xffff0000, v132
    v_add_f32 v220, v220, v3
    v_add_f32 v221, v221, v4
    v_lshlrev_b32 v3, 16, v133
    v_and_b32 v4, 0xffff0000, v133
    v_add_f32 v220, v220, v3
    v_add_f32 v221, v221, v4
    v_lshlrev_b32 v3, 16, v134
    v_and_b32 v4, 0xffff0000, v134
    v_add_f32 v220, v220, v3
    v_add_f32 v221, v221, v4
    v_lshlrev_b32 v3, 16, v135
    v_and_b32 v4, 0xffff0000, v135
    v_add_f32 v220, v220, v3
    v_add_f32 v221, v221, v4
    s_waitcnt lgkmcnt(8)
    v_lshlrev_b32 v3, 16, v136
    v_and_b32 v4, 0xffff0000, v136
    v_add_f32 v220, v220, v3
    v_add_f32 v221, v221, v4
    v_lshlrev_b32 v3, 16, v137
    v_and_b32 v4, 0xffff0000, v137
    v_add_f32 v220, v220, v3
    v_add_f32 v221, v221, v4
    v_lshlrev_b32 v3, 16, v138
    v_and_b32 v4, 0xffff0000, v138
    v_add_f32 v220, v220, v3
    v_add_f32 v221, v221, v4
    v_lshlrev_b32 v3, 16, v139
    v_and_b32 v4, 0xffff0000, v139
    v_add_f32 v220, v220, v3
    v_add_f32 v221, v221, v4
    s_waitcnt lgkmcnt(6)
    v_lshlrev_b32 v3, 16, v140
    v_and_b32 v4, 0xffff0000, v140
    v_add_f32 v220, v220, v3
    v_add_f32 v221, v221, v4
    v_lshlrev_b32 v3, 16, v141
    v_and_b32 v4, 0xffff0000, v141
    v_add_f32 v220, v220, v3
    v_add_f32 v221, v221, v4
    v_lshlrev_b32 v3, 16, v142
    v_and_b32 v4, 0xffff0000, v142
    v_add_f32 v220, v220, v3
    v_add_f32 v221, v221, v4
    v_lshlrev_b32 v3, 16, v143
    v_and_b32 v4, 0xffff0000, v143
    v_add_f32 v220, v220, v3
    v_add_f32 v221, v221, v4
    s_waitcnt lgkmcnt(4)
    v_lshlrev_b32 v3, 16, v144
    v_and_b32 v4, 0xffff0000, v144
    v_add_f32 v220, v220, v3
    v_add_f32 v221, v221, v4
    v_lshlrev_b32 v3, 16, v145
    v_and_b32 v4, 0xffff0000, v145
    v_add_f32 v220, v220, v3
    v_add_f32 v221, v221, v4
    v_lshlrev_b32 v3, 16, v146
    v_and_b32 v4, 0xffff0000, v146
    v_add_f32 v220, v220, v3
    v_add_f32 v221, v221, v4
    v_lshlrev_b32 v3, 16, v147
    v_and_b32 v4, 0xffff0000, v147
    v_add_f32 v220, v220, v3
F_pgL3_6:
    s_cbranch_execz F_ret
    v_add_f32 v221, v221, v4
    s_waitcnt lgkmcnt(2)
    v_lshlrev_b32 v3, 16, v148
    v_and_b32 v4, 0xffff0000, v148
    v_add_f32 v220, v220, v3
    v_add_f32 v221, v221, v4
    v_lshlrev_b32 v3, 16, v149
    v_and_b32 v4, 0xffff0000, v149
    v_add_f32 v220, v220, v3
    v_add_f32 v221, v221, v4
    v_lshlrev_b32 v3, 16, v150
    v_and_b32 v4, 0xffff0000, v150
    v_add_f32 v220, v220, v3
    v_add_f32 v221, v221, v4
    v_lshlrev_b32 v3, 16, v151
    v_and_b32 v4, 0xffff0000, v151
    v_add_f32 v220, v220, v3
    v_add_f32 v221, v221, v4
    s_waitcnt lgkmcnt(0)
    v_lshlrev_b32 v3, 16, v152
    v_and_b32 v4, 0xffff0000, v152
    v_add_f32 v220, v220, v3
    v_add_f32 v221, v221, v4
    v_lshlrev_b32 v3, 16, v153
    v_and_b32 v4, 0xffff0000, v153
    v_add_f32 v220, v220, v3
    v_add_f32 v221, v221, v4
    v_lshlrev_b32 v3, 16, v154
    v_and_b32 v4, 0xffff0000, v154
    v_add_f32 v220, v220, v3
    v_add_f32 v221, v221, v4
    v_lshlrev_b32 v3, 16, v155
    v_and_b32 v4, 0xffff0000, v155
    v_add_f32 v220, v220, v3
    v_add_f32 v221, v221, v4
    v_add_f32 v220, v220, v221
    ds_write_b32 v248, v220
    s_waitcnt lgkmcnt(0)
    s_barrier
    s_mov_b64 exec, 0
    s_cmp_eq_u32 s93, 1
    s_cbranch_scc1 F_cll2_1
    s_cmp_eq_u32 s93, 2
    s_cbranch_scc1 F_cll2_2
    s_cmp_eq_u32 s93, 3
    s_cbranch_scc1 F_cll2_3
    s_call_b64 s[28:29], F_pgA2_5
    s_call_b64 s[28:29], F_pgA2_9
    s_call_b64 s[28:29], F_pgA2_13
    s_branch F_cll2
F_cll2_1:
    s_call_b64 s[28:29], F_pgA2_6
    s_call_b64 s[28:29], F_pgA2_10
    s_branch F_cll2
F_cll2_2:
    s_call_b64 s[28:29], F_pgA2_7
    s_call_b64 s[28:29], F_pgA2_11
    s_branch F_cll2
F_cll2_3:
    s_call_b64 s[28:29], F_pgA2_8
    s_call_b64 s[28:29], F_pgA2_12
F_cll2:
    s_mov_b64 exec, -1
    s_lshl_b32 s99, s93, 16
    s_add_u32 s99, s99, 2097152
    s_lshl1_add_u32 s41, s90, s91
    s_lshl_b32 s41, s41, 13
    s_add_u32 s41, s41, 28672
    s_and_b32 s41, s41, 0xffff
    s_setprio 3
    s_lshl_b32 s49, s93, 11
    s_add_u32 s49, s49, 32768
    ds_read_b32 v10, v9 offset:1024
    s_waitcnt lgkmcnt(0)
    v_cmp_gt_u32 vcc, 2, v10
    s_cbranch_vccnz F_fs33
F_fs33_ok:
    s_add_u32 m0, s49, 106496
    s_add_u32 s28, s99, s41
    buffer_load_dwordx4 v2, s[16:19], s28 offen offset:0 sc1 lds
    s_add_u32 m0, s49, 106496
    s_add_u32 s28, s99, s41
    buffer_load_dwordx4 v2, s[16:19], s28 offen offset:1024 sc1 lds
    s_add_u32 m0, s49, 112640
    s_add_u32 s28, s99, s41
    buffer_load_dwordx4 v2, s[16:19], s28 offen offset:2048 sc1 lds
    s_add_u32 m0, s49, 112640
    s_add_u32 s28, s99, s41
    buffer_load_dwordx4 v2, s[16:19], s28 offen offset:3072 sc1 lds
    s_add_u32 s41, s41, 4096
    s_and_b32 s41, s41, 0xffff
    s_add_u32 m0, s49, 4294934528
    s_add_u32 s28, s99, s41
    buffer_load_dwordx4 v2, s[16:19], s28 offen offset:0 sc1 lds
    s_add_u32 m0, s49, 4294934528
    s_add_u32 s28, s99, s41
    buffer_load_dwordx4 v2, s[16:19], s28 offen offset:1024 sc1 lds
    s_add_u32 m0, s49, 4294940672
    s_add_u32 s28, s99, s41
    buffer_load_dwordx4 v2, s[16:19], s28 offen offset:2048 sc1 lds
    s_add_u32 m0, s49, 4294940672
    s_add_u32 s28, s99, s41
    buffer_load_dwordx4 v2, s[16:19], s28 offen offset:3072 sc1 lds
    s_add_u32 s41, s41, 4096
    s_and_b32 s41, s41, 0xffff
    s_add_u32 m0, s49, 4294950912
    s_add_u32 s28, s99, s41
    buffer_load_dwordx4 v2, s[16:19], s28 offen offset:0 sc1 lds
    s_add_u32 m0, s49, 4294950912
    s_add_u32 s28, s99, s41
    buffer_load_dwordx4 v2, s[16:19], s28 offen offset:1024 sc1 lds
    s_add_u32 m0, s49, 4294957056
    s_add_u32 s28, s99, s41
    buffer_load_dwordx4 v2, s[16:19], s28 offen offset:2048 sc1 lds
    s_add_u32 m0, s49, 4294957056
    s_add_u32 s28, s99, s41
    buffer_load_dwordx4 v2, s[16:19], s28 offen offset:3072 sc1 lds
    s_add_u32 s41, s41, 4096
    s_and_b32 s41, s41, 0xffff
    s_add_u32 m0, s49, 57344
    s_add_u32 s28, s99, s41
    buffer_load_dwordx4 v2, s[16:19], s28 offen offset:0 sc1 lds
    s_add_u32 m0, s49, 57344
    s_add_u32 s28, s99, s41
    buffer_load_dwordx4 v2, s[16:19], s28 offen offset:1024 sc1 lds
    s_add_u32 m0, s49, 63488
    s_add_u32 s28, s99, s41
    buffer_load_dwordx4 v2, s[16:19], s28 offen offset:2048 sc1 lds
    s_add_u32 m0, s49, 63488
    s_add_u32 s28, s99, s41
    buffer_load_dwordx4 v2, s[16:19], s28 offen offset:3072 sc1 lds
    s_add_u32 s41, s41, 4096
    s_and_b32 s41, s41, 0xffff
    s_add_u32 m0, s49, 73728
    s_add_u32 s28, s99, s41
    buffer_load_dwordx4 v2, s[16:19], s28 offen offset:0 sc1 lds
    s_add_u32 m0, s49, 73728
    s_add_u32 s28, s99, s41
    buffer_load_dwordx4 v2, s[16:19], s28 offen offset:1024 sc1 lds
    s_add_u32 m0, s49, 79872
    s_add_u32 s28, s99, s41
    buffer_load_dwordx4 v2, s[16:19], s28 offen offset:2048 sc1 lds
    s_add_u32 m0, s49, 79872
    s_add_u32 s28, s99, s41
    buffer_load_dwordx4 v2, s[16:19], s28 offen offset:3072 sc1 lds
    s_add_u32 s41, s41, 4096
    s_and_b32 s41, s41, 0xffff
    s_add_u32 m0, s49, 90112
    s_add_u32 s28, s99, s41
    buffer_load_dwordx4 v2, s[16:19], s28 offen offset:0 sc1 lds
    s_add_u32 m0, s49, 90112
    s_add_u32 s28, s99, s41
    buffer_load_dwordx4 v2, s[16:19], s28 offen offset:1024 sc1 lds
    s_add_u32 m0, s49, 96256
    s_add_u32 s28, s99, s41
    buffer_load_dwordx4 v2, s[16:19], s28 offen offset:2048 sc1 lds
    s_add_u32 m0, s49, 96256
    s_add_u32 s28, s99, s41
    buffer_load_dwordx4 v2, s[16:19], s28 offen offset:3072 sc1 lds
    s_add_u32 s41, s41, 4096
    s_and_b32 s41, s41, 0xffff
    s_waitcnt vmcnt(0)
    ds_add_u32 v8, v7
    s_and_b32 s28, s90, 3
    s_lshl2_add_u32 s28, s28, s92
    s_mul_i32 s28, s28, 25088
    v_lshlrev_b32 v3, 7, v1
    s_mov_b32 exec_lo, 0xffffffff
    s_mov_b32 exec_hi, 0x1ffff
    buffer_load_dword v4, v3, s[36:39], s28 offen
    s_add_u32 s28, s28, 6272
    buffer_load_dword v4, v3, s[36:39], s28 offen
    s_add_u32 s28, s28, 6272
    buffer_load_dword v4, v3, s[36:39], s28 offen
    s_add_u32 s28, s28, 6272
    buffer_load_dword v4, v3, s[36:39], s28 offen
    s_add_u32 s28, s28, 6272
    s_mov_b64 exec, -1
    ds_read_b32 v10, v8 offset:1024
    s_waitcnt lgkmcnt(0)
    v_cmp_gt_u32 vcc, 3, v10
    s_cbranch_vccnz F_fs34
F_fs34_ok:
    s_add_u32 m0, s49, 106496
    s_add_u32 s28, s99, s41
    buffer_load_dwordx4 v2, s[16:19], s28 offen offset:0 sc1 lds
    s_add_u32 m0, s49, 106496
    s_add_u32 s28, s99, s41
F_pgL3_7:
    s_cbranch_execz F_ret
    buffer_load_dwordx4 v2, s[16:19], s28 offen offset:1024 sc1 lds
    s_add_u32 m0, s49, 112640
    s_add_u32 s28, s99, s41
    buffer_load_dwordx4 v2, s[16:19], s28 offen offset:2048 sc1 lds
    s_add_u32 m0, s49, 112640
    s_add_u32 s28, s99, s41
    buffer_load_dwordx4 v2, s[16:19], s28 offen offset:3072 sc1 lds
    s_add_u32 s41, s41, 4096
    s_and_b32 s41, s41, 0xffff
    ds_read_b32 v10, v8 offset:1024
    s_waitcnt lgkmcnt(0)
    v_cmp_gt_u32 vcc, 3, v10
    s_cbranch_vccnz F_fs35
F_fs35_ok:
    s_add_u32 m0, s49, 4294934528
    s_add_u32 s28, s99, s41
    buffer_load_dwordx4 v2, s[16:19], s28 offen offset:0 sc1 lds
    s_add_u32 m0, s49, 4294934528
    s_add_u32 s28, s99, s41
    buffer_load_dwordx4 v2, s[16:19], s28 offen offset:1024 sc1 lds
    s_add_u32 m0, s49, 4294940672
    s_add_u32 s28, s99, s41
    buffer_load_dwordx4 v2, s[16:19], s28 offen offset:2048 sc1 lds
    s_add_u32 m0, s49, 4294940672
    s_add_u32 s28, s99, s41
    buffer_load_dwordx4 v2, s[16:19], s28 offen offset:3072 sc1 lds
    s_add_u32 s41, s41, 4096
    s_and_b32 s41, s41, 0xffff
    ds_read_b32 v10, v8 offset:1024
    s_waitcnt lgkmcnt(0)
    v_cmp_gt_u32 vcc, 3, v10
    s_cbranch_vccnz F_fs36
F_fs36_ok:
    s_add_u32 m0, s49, 4294950912
    s_add_u32 s28, s99, s41
    buffer_load_dwordx4 v2, s[16:19], s28 offen offset:0 sc1 lds
    s_add_u32 m0, s49, 4294950912
    s_add_u32 s28, s99, s41
    buffer_load_dwordx4 v2, s[16:19], s28 offen offset:1024 sc1 lds
    s_add_u32 m0, s49, 4294957056
    s_add_u32 s28, s99, s41
    buffer_load_dwordx4 v2, s[16:19], s28 offen offset:2048 sc1 lds
    s_add_u32 m0, s49, 4294957056
    s_add_u32 s28, s99, s41
    buffer_load_dwordx4 v2, s[16:19], s28 offen offset:3072 sc1 lds
    s_add_u32 s41, s41, 4096
    s_and_b32 s41, s41, 0xffff
    s_waitcnt vmcnt(0)
    ds_add_u32 v8, v7
    s_waitcnt lgkmcnt(0)
    s_branch F_fin
F_la:
    v_and_b32 v224, 31, v1
    v_lshlrev_b32 v224, 3, v224
    buffer_load_dword v10, v224, s[24:27], 0 offen sc1
    v_and_b32 v3, 31, v1
    v_lshrrev_b32 v4, 5, v1
    v_bfe_u32 v5, v1, 1, 3
    v_xor_b32 v5, v4, v5
    v_lshlrev_b32 v5, 4, v5
    v_lshl_add_u32 v5, v3, 7, v5
    s_lshl_b32 s28, s93, 12
    s_add_u32 s28, s28, 0
    v_add_u32 v236, s28, v5
    v_xor_b32 v237, 0x20, v236
    v_xor_b32 v238, 0x40, v236
    v_xor_b32 v239, 0x60, v236
    v_xor_b32 v240, 0x10000, v236
    v_xor_b32 v241, 0x10020, v236
    v_xor_b32 v242, 0x10040, v236
    v_xor_b32 v243, 0x10060, v236
    s_lshl_b32 s28, s93, 7
    s_add_u32 s28, s28, 161792
    v_lshl_add_u32 v250, v3, 2, s28
    s_and_b32 s29, s93, 1
    s_lshl_b32 s28, s29, 8
    s_add_u32 s28, s28, 161792
    v_lshl_add_u32 v251, v3, 2, s28
    s_lshl_b32 s28, s29, 14
    s_add_u32 s30, s28, 9728
    v_lshl_add_u32 v15, v3, 4, s30
    s_lshr_b32 s30, s93, 1
    s_lshl_b32 s40, s30, 13
    s_add_u32 s28, s28, s40
    v_add_u32 v14, s28, v2
    s_lshl_b32 s28, s93, 11
    v_add_u32 v11, s28, v2
    v_add_u32 v245, 139264, v11
    v_add_u32 v246, 139264, v2
    s_lshl1_add_u32 s29, s90, s29
    s_mul_i32 s40, s29, 294912
    s_lshl_b32 s28, s101, 11
    s_add_u32 s40, s40, s28
    s_add_u32 s40, s40, 3260416
    s_mov_b32 s42, -1
    s_sub_u32 s43, s30, 1
    s_lshl_b32 s28, s93, 16
    s_add_u32 s28, s28, 2097152
    v_add_u32 v0, s28, v2
    s_lshl1_add_u32 s41, s90, s91
    s_and_b32 s41, s41, 7
    s_lshl_b32 s41, s41, 13
    s_waitcnt vmcnt(0) lgkmcnt(0)
    s_barrier
    ds_read_b128 v[160:163], v236 offset:0
    ds_read_b64_tr_b16 v[176:177], v244 offset:0
    ds_read_b64_tr_b16 v[178:179], v244 offset:256
    ds_read_b128 v[164:167], v237 offset:0
    ds_read_b64_tr_b16 v[180:181], v244 offset:1024
    ds_read_b64_tr_b16 v[182:183], v244 offset:1280
    ds_read_b128 v[168:171], v238 offset:0
    ds_read_b64_tr_b16 v[184:185], v244 offset:2048
    ds_read_b64_tr_b16 v[186:187], v244 offset:2304
    ds_read_b128 v[172:175], v239 offset:0
    ds_read_b64_tr_b16 v[188:189], v244 offset:3072
    ds_read_b64_tr_b16 v[190:191], v244 offset:3328
    v_cmp_ne_u32 vcc, 1, v10
    s_cbranch_vccnz F_spin37
F_lgo:
    s_lshl2_add_u32 s28, s90, s93
    s_lshl_b32 s28, s28, 9
    s_add_u32 s28, s28, 2457600
    v_lshlrev_b32 v224, 1, v224
    buffer_load_dwordx4 v[216:219], v224, s[16:19], s28 offen sc1
    s_mov_b32 s29, 2359296
    v_lshlrev_b32 v224, 3, v1
    buffer_load_dwordx2 v[224:225], v224, s[16:19], s29 offen sc1
    buffer_load_dwordx4 v[16:19], v0, s[16:19], s41 offen offset:0 sc1
    buffer_load_dwordx4 v[20:23], v0, s[16:19], s41 offen offset:1024 sc1
    buffer_load_dwordx4 v[24:27], v0, s[16:19], s41 offen offset:2048 sc1
    buffer_load_dwordx4 v[28:31], v0, s[16:19], s41 offen offset:3072 sc1
    s_add_u32 s41, s41, 4096
    s_and_b32 s41, s41, 0xffff
    buffer_load_dwordx4 v[32:35], v0, s[16:19], s41 offen offset:0 sc1
    buffer_load_dwordx4 v[36:39], v0, s[16:19], s41 offen offset:1024 sc1
    buffer_load_dwordx4 v[40:43], v0, s[16:19], s41 offen offset:2048 sc1
    buffer_load_dwordx4 v[44:47], v0, s[16:19], s41 offen offset:3072 sc1
F_pgL3_8:
    s_cbranch_execz F_ret
    s_add_u32 s41, s41, 4096
    s_and_b32 s41, s41, 0xffff
    buffer_load_dwordx4 v[48:51], v0, s[16:19], s41 offen offset:0 sc1
    buffer_load_dwordx4 v[52:55], v0, s[16:19], s41 offen offset:1024 sc1
    buffer_load_dwordx4 v[56:59], v0, s[16:19], s41 offen offset:2048 sc1
    buffer_load_dwordx4 v[60:63], v0, s[16:19], s41 offen offset:3072 sc1
    s_add_u32 s41, s41, 4096
    s_and_b32 s41, s41, 0xffff
    s_waitcnt lgkmcnt(9)
    v_mfma_f32_32x32x16_bf16 v[192:207], v[176:179], v[160:163], 0
    ds_read_b128 v[160:163], v236 offset:16384
    ds_read_b64_tr_b16 v[176:177], v244 offset:4096
    ds_read_b64_tr_b16 v[178:179], v244 offset:4352
    s_waitcnt lgkmcnt(9)
    v_mfma_f32_32x32x16_bf16 v[192:207], v[180:183], v[164:167], v[192:207]
    ds_read_b128 v[164:167], v237 offset:16384
    ds_read_b64_tr_b16 v[180:181], v244 offset:5120
    ds_read_b64_tr_b16 v[182:183], v244 offset:5376
    s_waitcnt lgkmcnt(9)
    v_mfma_f32_32x32x16_bf16 v[192:207], v[184:187], v[168:171], v[192:207]
    ds_read_b128 v[168:171], v238 offset:16384
    ds_read_b64_tr_b16 v[184:185], v244 offset:6144
    ds_read_b64_tr_b16 v[186:187], v244 offset:6400
    s_waitcnt lgkmcnt(9)
    v_mfma_f32_32x32x16_bf16 v[192:207], v[188:191], v[172:175], v[192:207]
    ds_read_b128 v[172:175], v239 offset:16384
    ds_read_b64_tr_b16 v[188:189], v244 offset:7168
    ds_read_b64_tr_b16 v[190:191], v244 offset:7424
    s_waitcnt lgkmcnt(9)
    v_mfma_f32_32x32x16_bf16 v[192:207], v[176:179], v[160:163], v[192:207]
    ds_read_b128 v[160:163], v236 offset:32768
    ds_read_b64_tr_b16 v[176:177], v244 offset:8192
    ds_read_b64_tr_b16 v[178:179], v244 offset:8448
    s_waitcnt lgkmcnt(9)
    v_mfma_f32_32x32x16_bf16 v[192:207], v[180:183], v[164:167], v[192:207]
    ds_read_b128 v[164:167], v237 offset:32768
    ds_read_b64_tr_b16 v[180:181], v244 offset:9216
    ds_read_b64_tr_b16 v[182:183], v244 offset:9472
    s_waitcnt lgkmcnt(9)
    v_mfma_f32_32x32x16_bf16 v[192:207], v[184:187], v[168:171], v[192:207]
    ds_read_b128 v[168:171], v238 offset:32768
    ds_read_b64_tr_b16 v[184:185], v244 offset:10240
    ds_read_b64_tr_b16 v[186:187], v244 offset:10496
    s_waitcnt lgkmcnt(9)
    v_mfma_f32_32x32x16_bf16 v[192:207], v[188:191], v[172:175], v[192:207]
    ds_read_b128 v[172:175], v239 offset:32768
    ds_read_b64_tr_b16 v[188:189], v244 offset:11264
    ds_read_b64_tr_b16 v[190:191], v244 offset:11520
    s_waitcnt lgkmcnt(9)
    v_mfma_f32_32x32x16_bf16 v[192:207], v[176:179], v[160:163], v[192:207]
    ds_read_b128 v[160:163], v236 offset:49152
    ds_read_b64_tr_b16 v[176:177], v244 offset:12288
    ds_read_b64_tr_b16 v[178:179], v244 offset:12544
    s_waitcnt lgkmcnt(9)
    v_mfma_f32_32x32x16_bf16 v[192:207], v[180:183], v[164:167], v[192:207]
    ds_read_b128 v[164:167], v237 offset:49152
    ds_read_b64_tr_b16 v[180:181], v244 offset:13312
    ds_read_b64_tr_b16 v[182:183], v244 offset:13568
    s_waitcnt lgkmcnt(9)
    v_mfma_f32_32x32x16_bf16 v[192:207], v[184:187], v[168:171], v[192:207]
    ds_read_b128 v[168:171], v238 offset:49152
    ds_read_b64_tr_b16 v[184:185], v244 offset:14336
    ds_read_b64_tr_b16 v[186:187], v244 offset:14592
    s_waitcnt lgkmcnt(9)
    v_mfma_f32_32x32x16_bf16 v[192:207], v[188:191], v[172:175], v[192:207]
    ds_read_b128 v[172:175], v239 offset:49152
    ds_read_b64_tr_b16 v[188:189], v244 offset:15360
    ds_read_b64_tr_b16 v[190:191], v244 offset:15616
    s_waitcnt lgkmcnt(9)
    v_mfma_f32_32x32x16_bf16 v[192:207], v[176:179], v[160:163], v[192:207]
    ds_read_b128 v[160:163], v240 offset:0
    ds_read_b64_tr_b16 v[176:177], v244 offset:16384
    ds_read_b64_tr_b16 v[178:179], v244 offset:16640
    s_waitcnt lgkmcnt(9)
    v_mfma_f32_32x32x16_bf16 v[192:207], v[180:183], v[164:167], v[192:207]
    ds_read_b128 v[164:167], v241 offset:0
    ds_read_b64_tr_b16 v[180:181], v244 offset:17408
    ds_read_b64_tr_b16 v[182:183], v244 offset:17664
    s_waitcnt lgkmcnt(9)
    v_mfma_f32_32x32x16_bf16 v[192:207], v[184:187], v[168:171], v[192:207]
    ds_read_b128 v[168:171], v242 offset:0
    ds_read_b64_tr_b16 v[184:185], v244 offset:18432
    ds_read_b64_tr_b16 v[186:187], v244 offset:18688
    s_waitcnt lgkmcnt(9)
    v_mfma_f32_32x32x16_bf16 v[192:207], v[188:191], v[172:175], v[192:207]
    ds_read_b128 v[172:175], v243 offset:0
    ds_read_b64_tr_b16 v[188:189], v244 offset:19456
    ds_read_b64_tr_b16 v[190:191], v244 offset:19712
    s_waitcnt lgkmcnt(9)
    v_mfma_f32_32x32x16_bf16 v[192:207], v[176:179], v[160:163], v[192:207]
    ds_read_b128 v[160:163], v240 offset:16384
    ds_read_b64_tr_b16 v[176:177], v244 offset:20480
    ds_read_b64_tr_b16 v[178:179], v244 offset:20736
    s_waitcnt lgkmcnt(9)
    v_mfma_f32_32x32x16_bf16 v[192:207], v[180:183], v[164:167], v[192:207]
    ds_read_b128 v[164:167], v241 offset:16384
    ds_read_b64_tr_b16 v[180:181], v244 offset:21504
    ds_read_b64_tr_b16 v[182:183], v244 offset:21760
    s_waitcnt lgkmcnt(9)
    v_mfma_f32_32x32x16_bf16 v[192:207], v[184:187], v[168:171], v[192:207]
    ds_read_b128 v[168:171], v242 offset:16384
    ds_read_b64_tr_b16 v[184:185], v244 offset:22528
    ds_read_b64_tr_b16 v[186:187], v244 offset:22784
    s_waitcnt lgkmcnt(9)
    v_mfma_f32_32x32x16_bf16 v[192:207], v[188:191], v[172:175], v[192:207]
    ds_read_b128 v[172:175], v243 offset:16384
    ds_read_b64_tr_b16 v[188:189], v244 offset:23552
    ds_read_b64_tr_b16 v[190:191], v244 offset:23808
    s_waitcnt lgkmcnt(9)
    v_mfma_f32_32x32x16_bf16 v[192:207], v[176:179], v[160:163], v[192:207]
    ds_read_b128 v[160:163], v240 offset:32768
    ds_read_b64_tr_b16 v[176:177], v244 offset:24576
    ds_read_b64_tr_b16 v[178:179], v244 offset:24832
    s_waitcnt lgkmcnt(9)
    v_mfma_f32_32x32x16_bf16 v[192:207], v[180:183], v[164:167], v[192:207]
    ds_read_b128 v[164:167], v241 offset:32768
    ds_read_b64_tr_b16 v[180:181], v244 offset:25600
    ds_read_b64_tr_b16 v[182:183], v244 offset:25856
    s_waitcnt lgkmcnt(9)
    v_mfma_f32_32x32x16_bf16 v[192:207], v[184:187], v[168:171], v[192:207]
    ds_read_b128 v[168:171], v242 offset:32768
    ds_read_b64_tr_b16 v[184:185], v244 offset:26624
    ds_read_b64_tr_b16 v[186:187], v244 offset:26880
    s_waitcnt lgkmcnt(9)
    v_mfma_f32_32x32x16_bf16 v[192:207], v[188:191], v[172:175], v[192:207]
    ds_read_b128 v[172:175], v243 offset:32768
    ds_read_b64_tr_b16 v[188:189], v244 offset:27648
    ds_read_b64_tr_b16 v[190:191], v244 offset:27904
    s_waitcnt lgkmcnt(9)
    v_mfma_f32_32x32x16_bf16 v[192:207], v[176:179], v[160:163], v[192:207]
    s_waitcnt lgkmcnt(6)
    v_mfma_f32_32x32x16_bf16 v[192:207], v[180:183], v[164:167], v[192:207]
    s_waitcnt lgkmcnt(3)
    v_mfma_f32_32x32x16_bf16 v[192:207], v[184:187], v[168:171], v[192:207]
    s_waitcnt lgkmcnt(0)
    v_mfma_f32_32x32x16_bf16 v[192:207], v[188:191], v[172:175], v[192:207]
    s_barrier
    ds_read_b128 v[208:211], v249 offset:0
    ds_read_b128 v[212:215], v249 offset:16
    s_branch F_qfin
F_last:
.section .rodata,"a"
.p2align 6
.amdhsa_kernel parallel_sum__grouped_kv_mqa__glu_gated_bilinear__prompt_kernel
  .amdhsa_next_free_vgpr 256
  .amdhsa_next_free_sgpr 102
  .amdhsa_accum_offset 256
  .amdhsa_group_segment_fixed_size 0
  .amdhsa_kernarg_size 96
  .amdhsa_user_sgpr_count 2
  .amdhsa_user_sgpr_kernarg_segment_ptr 1
  .amdhsa_system_sgpr_workgroup_id_x 1
.end_amdhsa_kernel
```
